```python
import torch

def _softmax(x, axis=-1):
    return torch.softmax(x, dim=axis)
def _gelu(x):
    return torch.nn.functional.gelu(x, approximate="tanh")
def _silu(x):
    return torch.nn.functional.silu(x)
def _sigmoid(x):
    return torch.sigmoid(x)
def _layernorm(x, axis=-1, eps=1e-5):
    m = x.mean(dim=axis, keepdim=True)
    v = x.var(dim=axis, keepdim=True, unbiased=False)
    return (x - m) / torch.sqrt(v + eps)
def _scatter_add(tgt, idx, src, axis=0):
    return tgt.clone().index_add_(axis, idx, src)
def _segment_sum(src, seg, n):
    out = torch.zeros((n,) + src.shape[1:], dtype=src.dtype)
    return out.index_add_(0, seg, src)
def _pad(x, pw):
    flat = tuple(v for pair in reversed(pw) for v in pair)
    return torch.nn.functional.pad(x, flat)

kernel_name = 'concat_heads__mha_block__spectral_gfnet__prompt'

def setup_inputs():

    _w = (lambda a: (lambda t: t.to(torch.bfloat16) if t.is_floating_point() else t)(torch.as_tensor(a)))
    def _A_setup():
        B, S, D, H = 1, 2048, 448, 16
        return {
            "x": _w((lambda *s: torch.randn(*s, dtype=torch.bfloat16) * 0.2)(B, S, D)),
            "wqkv": _w((lambda *s: torch.randn(*s, dtype=torch.bfloat16) * 0.2)(D, 3 * D)),
            "wo": _w((lambda *s: torch.randn(*s, dtype=torch.bfloat16) * 0.05)(D, D)),
        }
    _A_in = _A_setup()

    def _B_setup():
        B, S, D = 1, 2048, 448
        Df = D // 2 + 1
        return {
            "x": _w((lambda *s: torch.randn(*s, dtype=torch.bfloat16) * 0.05)(B, S, D)),
            "w_r": _w((lambda *s: torch.randn(*s, dtype=torch.bfloat16) * 6.4)(S, Df) * 0.02),
            "w_i": _w((lambda *s: torch.randn(*s, dtype=torch.bfloat16) * 6.4)(S, Df) * 0.02),
        }
    _B_in = _B_setup()

    return {
        "A_x": _A_in["x"],
        "A_wqkv": _A_in["wqkv"],
        "A_wo": _A_in["wo"],
        "B_x": _B_in["x"],
        "B_w_r": _B_in["w_r"],
        "B_w_i": _B_in["w_i"],
    }

def reference(A_x, A_wqkv, A_wo, B_x, B_w_r, B_w_i):
    def _A_ref(x, wqkv, wo):
        B, S, D = x.shape
        H = 16
        Dh = D // H
        qkv = (lambda x, *d: x.permute(*d))((x @ wqkv).reshape(B, S, 3, H, Dh), 2, 0, 3, 1, 4)
        q, k, v = qkv[0], qkv[1], qkv[2]
        scores = torch.einsum("bhqd,bhkd->bhqk", q, k) * (Dh ** -0.5)
        p = _softmax(scores, axis=-1)
        o = torch.einsum("bhqk,bhkd->bhqd", p, v)
        return (lambda x, *d: x.permute(*d))(o, 0, 2, 1, 3).reshape(B, S, D) @ wo

    def _B_ref(x, w_r, w_i):
        B, S, D = x.shape
        X = (lambda x, axes=(-2,-1): torch.fft.rfft2(x.float(), dim=axes))(x, axes=(-2, -1))
        W = w_r + 1j * w_i
        X = X * W
        y = (lambda x, s, axes=(-2,-1): torch.fft.irfft2(x, s=s, dim=axes).to(torch.bfloat16))(X, (S, D), axes=(-2, -1))
        return y

    a = _A_ref(A_x, A_wqkv, A_wo)
    b = _B_ref(B_x, B_w_r, B_w_i)
    return torch.concatenate([a, b], axis=-1)
```

```asm
; @launch grid=(256,1,1) block=(768,1,1) lds=163840
.amdgcn_target "amdgcn-amd-amdhsa--gfx950"
.text
.globl concat_heads__mha_block__spectral_gfnet__prompt_kernel
.p2align 8
.type concat_heads__mha_block__spectral_gfnet__prompt_kernel,@function
concat_heads__mha_block__spectral_gfnet__prompt_kernel:
    s_cmp_ge_u32 s2, 256
    s_cbranch_scc1 L1_end
    v_mov_b32 v101, 0
    v_mov_b32 v102, 0
    v_mov_b32 v103, 0
    v_mov_b32 v104, 0
    s_load_dwordx4 s[4:7], s[0:1], 0
    s_load_dwordx2 s[8:9], s[0:1], 24
    s_load_dwordx4 s[12:15], s[0:1], 32
    s_load_dwordx2 s[10:11], s[0:1], 64
    s_getpc_b64 s[16:17]
    s_add_u32 s16, s16, ftab@rel32@lo+4
    s_addc_u32 s17, s17, ftab@rel32@hi+12
    s_and_b32 s20, s2, 7
    s_lshr_b32 s20, s20, 1
    s_and_b32 s21, s2, 1
    s_lshl_b32 s21, s21, 3
    s_lshr_b32 s48, s2, 3
    s_and_b32 s48, s48, 7
    s_add_u32 s21, s21, s48
    s_lshr_b32 s22, s2, 6
    v_lshrrev_b32 v4, 6, v0
    v_and_b32 v1, 63, v0
    v_readfirstlane_b32 s58, v4
    v_and_b32 v2, 15, v0
    v_lshrrev_b32 v3, 4, v1
    s_and_b32 s23, s58, 3
    s_lshl_b32 s61, s23, 12
    s_cmp_lt_u32 s58, 4
    s_cbranch_scc1 L1_comp
    s_cmp_ge_u32 s58, 8
    s_cbranch_scc1 L1_aux
    s_cmp_eq_u32 s20, 3
    s_cselect_b64 s[54:55], -1, 0
    s_mov_b32 s44, 2688
    s_cselect_b32 s44, 896, s44
    s_mul_i32 s48, s20, 896
    s_cselect_b32 s48, 0, s48
    s_mul_i32 s49, s22, 224
    s_and_b32 s49, s49, 0xffffffc0
    s_add_u32 s48, s48, s49
    s_lshl_b32 s45, s44, 2
    s_mul_i32 s57, s44, 52
    s_mul_i32 s49, s23, s44
    s_lshl_b32 s49, s49, 4
    s_add_u32 s46, s48, s49
    s_lshl_b32 s47, s23, 12
    s_add_u32 s47, s47, 16384
    s_lshl_b32 s61, s23, 12
    s_and_b32 s48, s21, 7
    s_lshl_b32 s49, s22, 1
    s_add_u32 s48, s48, s49
    s_sub_u32 s49, s48, 7
    s_cmp_ge_u32 s48, 7
    s_cselect_b32 s48, s49, s48
    s_lshl_b32 s62, s48, 7
    s_mul_i32 s48, s48, s44
    s_lshl_b32 s48, s48, 6
    s_add_u32 s46, s46, s48
    s_mul_i32 s63, s44, 448
    s_lshl_b32 s48, s21, 7
    s_lshl_b32 s49, s23, 5
    s_add_u32 s48, s48, s49
    s_and_b32 s49, s21, 3
    s_lshl_b32 s49, s49, 8
    s_lshr_b32 s50, s21, 2
    s_lshl_b32 s50, s50, 3
    s_add_u32 s49, s49, s50
    s_lshl_b32 s50, s23, 1
    s_add_u32 s49, s49, s50
    s_cmp_eq_u32 s20, 3
    s_cselect_b32 s48, s49, s48
    s_mov_b32 s49, 7168
    s_cselect_b32 s49, 917504, s49
    s_mov_b32 s50, 14336
    s_cselect_b32 s50, 896, s50
    v_lshrrev_b32 v4, 3, v1
    v_lshlrev_b32 v5, 5, v4
    v_cndmask_b32 v5, v4, v5, s[54:55]
    v_add_u32 v5, s48, v5
    v_mul_u32_u24 v5, 896, v5
    v_and_b32 v6, 7, v1
    v_lshrrev_b32 v7, 1, v4
    v_xor_b32 v6, v6, v7
    v_xor_b32 v7, 4, v6
    v_lshl_add_u32 v12, v6, 4, v5
    v_lshl_add_u32 v13, v7, 4, v5
    v_add_u32 v13, s50, v13
    v_add_u32 v14, s49, v12
    v_add_u32 v15, s49, v13
    v_mul_lo_u32 v7, v3, s44
    v_lshlrev_b32 v8, 1, v3
    v_xor_b32 v8, v8, v2
    v_lshl_add_u32 v16, v8, 4, v7
    v_xor_b32 v8, 8, v8
    v_lshl_add_u32 v17, v8, 4, v7
    s_waitcnt lgkmcnt(0)
    s_cmp_eq_u32 s20, 3
    s_cselect_b32 s24, s8, s4
    s_cselect_b32 s25, s9, s5
    s_cselect_b32 s28, s16, s6
    s_cselect_b32 s29, s17, s7
    s_mov_b32 s30, 1204224
    s_cselect_b32 s30, 401408, s30
    s_and_b32 s25, s25, 0xffff
    s_and_b32 s29, s29, 0xffff
    s_mov_b32 s26, 1835008
    s_mov_b32 s27, 0x20000
    s_mov_b32 s31, 0x20000
    s_add_u32 m0, s61, 0
    s_nop 0
    buffer_load_dwordx4 v12, s[24:27], s62 offen lds
    s_add_u32 m0, s61, 1024
    s_nop 0
    buffer_load_dwordx4 v13, s[24:27], s62 offen lds
    s_add_u32 m0, s61, 2048
    s_nop 0
    buffer_load_dwordx4 v14, s[24:27], s62 offen lds
    s_add_u32 m0, s61, 3072
    s_nop 0
    buffer_load_dwordx4 v15, s[24:27], s62 offen lds
    s_add_u32 s62, s62, 128
    s_cmp_eq_u32 s62, 896
    s_cselect_b32 s62, 0, s62
    s_cselect_b32 s66, s63, 0
    s_add_u32 m0, s47, 0
    s_nop 0
    buffer_load_dwordx4 v16, s[28:31], s46 offen lds
    s_add_u32 s46, s46, s45
    s_add_u32 m0, s47, 2048
    s_nop 0
    buffer_load_dwordx4 v16, s[28:31], s46 offen lds
    s_add_u32 s46, s46, s45
    s_add_u32 m0, s47, 1024
    s_nop 0
    buffer_load_dwordx4 v17, s[28:31], s46 offen lds
    s_add_u32 s46, s46, s45
    s_add_u32 m0, s47, 3072
    s_nop 0
    buffer_load_dwordx4 v17, s[28:31], s46 offen lds
    s_add_u32 s46, s46, s57
    s_sub_u32 s46, s46, s66
    s_add_u32 m0, s61, 32768
    s_nop 0
    buffer_load_dwordx4 v12, s[24:27], s62 offen lds
    s_add_u32 m0, s61, 33792
    s_nop 0
    buffer_load_dwordx4 v13, s[24:27], s62 offen lds
    s_add_u32 m0, s61, 34816
    s_nop 0
    buffer_load_dwordx4 v14, s[24:27], s62 offen lds
    s_add_u32 m0, s61, 35840
    s_nop 0
    buffer_load_dwordx4 v15, s[24:27], s62 offen lds
    s_add_u32 s62, s62, 128
    s_cmp_eq_u32 s62, 896
    s_cselect_b32 s62, 0, s62
    s_cselect_b32 s66, s63, 0
    s_add_u32 m0, s47, 32768
    s_nop 0
    buffer_load_dwordx4 v16, s[28:31], s46 offen lds
    s_add_u32 s46, s46, s45
    s_add_u32 m0, s47, 34816
    s_nop 0
    buffer_load_dwordx4 v16, s[28:31], s46 offen lds
    s_add_u32 s46, s46, s45
    s_add_u32 m0, s47, 33792
    s_nop 0
    buffer_load_dwordx4 v17, s[28:31], s46 offen lds
    s_add_u32 s46, s46, s45
    s_add_u32 m0, s47, 35840
    s_nop 0
    buffer_load_dwordx4 v17, s[28:31], s46 offen lds
    s_add_u32 s46, s46, s57
    s_sub_u32 s46, s46, s66
    s_add_u32 m0, s61, 65536
    s_nop 0
    buffer_load_dwordx4 v12, s[24:27], s62 offen lds
    s_add_u32 m0, s61, 66560
    s_nop 0
    buffer_load_dwordx4 v13, s[24:27], s62 offen lds
    s_add_u32 m0, s61, 67584
    s_nop 0
    buffer_load_dwordx4 v14, s[24:27], s62 offen lds
    s_add_u32 m0, s61, 68608
    s_nop 0
    buffer_load_dwordx4 v15, s[24:27], s62 offen lds
    s_add_u32 s62, s62, 128
    s_cmp_eq_u32 s62, 896
    s_cselect_b32 s62, 0, s62
    s_cselect_b32 s66, s63, 0
    s_add_u32 m0, s47, 65536
    s_nop 0
    buffer_load_dwordx4 v16, s[28:31], s46 offen lds
    s_add_u32 s46, s46, s45
    s_add_u32 m0, s47, 67584
    s_nop 0
    buffer_load_dwordx4 v16, s[28:31], s46 offen lds
    s_add_u32 s46, s46, s45
    s_add_u32 m0, s47, 66560
    s_nop 0
    buffer_load_dwordx4 v17, s[28:31], s46 offen lds
    s_add_u32 s46, s46, s45
    s_add_u32 m0, s47, 68608
    s_nop 0
    buffer_load_dwordx4 v17, s[28:31], s46 offen lds
    s_add_u32 s46, s46, s57
    s_sub_u32 s46, s46, s66
    s_waitcnt vmcnt(16)
    s_barrier
    s_add_u32 m0, s61, 98304
    s_nop 0
    buffer_load_dwordx4 v12, s[24:27], s62 offen lds
    s_add_u32 m0, s61, 99328
    s_nop 0
    buffer_load_dwordx4 v13, s[24:27], s62 offen lds
    s_add_u32 m0, s61, 100352
    s_nop 0
    buffer_load_dwordx4 v14, s[24:27], s62 offen lds
    s_add_u32 m0, s61, 101376
    s_nop 0
    buffer_load_dwordx4 v15, s[24:27], s62 offen lds
    s_add_u32 s62, s62, 128
    s_cmp_eq_u32 s62, 896
    s_cselect_b32 s62, 0, s62
    s_cselect_b32 s66, s63, 0
    s_add_u32 m0, s47, 98304
    s_nop 0
    buffer_load_dwordx4 v16, s[28:31], s46 offen lds
    s_add_u32 s46, s46, s45
    s_add_u32 m0, s47, 100352
    s_nop 0
    buffer_load_dwordx4 v16, s[28:31], s46 offen lds
    s_add_u32 s46, s46, s45
    s_add_u32 m0, s47, 99328
    s_nop 0
    buffer_load_dwordx4 v17, s[28:31], s46 offen lds
    s_add_u32 s46, s46, s45
    s_add_u32 m0, s47, 101376
    s_nop 0
    buffer_load_dwordx4 v17, s[28:31], s46 offen lds
    s_add_u32 s46, s46, s57
    s_sub_u32 s46, s46, s66
    s_waitcnt vmcnt(16)
    s_barrier
    s_add_u32 m0, s61, 131072
    s_nop 0
    buffer_load_dwordx4 v12, s[24:27], s62 offen lds
    s_add_u32 m0, s61, 132096
    s_nop 0
    buffer_load_dwordx4 v13, s[24:27], s62 offen lds
    s_add_u32 m0, s61, 133120
    s_nop 0
    buffer_load_dwordx4 v14, s[24:27], s62 offen lds
    s_add_u32 m0, s61, 134144
    s_nop 0
    buffer_load_dwordx4 v15, s[24:27], s62 offen lds
    s_add_u32 s62, s62, 128
    s_cmp_eq_u32 s62, 896
    s_cselect_b32 s62, 0, s62
    s_cselect_b32 s66, s63, 0
    s_add_u32 m0, s47, 131072
    s_nop 0
    buffer_load_dwordx4 v16, s[28:31], s46 offen lds
    s_add_u32 s46, s46, s45
    s_add_u32 m0, s47, 133120
    s_nop 0
    buffer_load_dwordx4 v16, s[28:31], s46 offen lds
    s_add_u32 s46, s46, s45
    s_add_u32 m0, s47, 132096
    s_nop 0
    buffer_load_dwordx4 v17, s[28:31], s46 offen lds
    s_add_u32 s46, s46, s45
    s_add_u32 m0, s47, 134144
    s_nop 0
    buffer_load_dwordx4 v17, s[28:31], s46 offen lds
    s_add_u32 s46, s46, s57
    s_sub_u32 s46, s46, s66
    s_waitcnt vmcnt(16)
    s_barrier
    s_add_u32 m0, s61, 0
    s_nop 0
    buffer_load_dwordx4 v12, s[24:27], s62 offen lds
    s_add_u32 m0, s61, 1024
    s_nop 0
    buffer_load_dwordx4 v13, s[24:27], s62 offen lds
    s_add_u32 m0, s61, 2048
    s_nop 0
    buffer_load_dwordx4 v14, s[24:27], s62 offen lds
    s_add_u32 m0, s61, 3072
    s_nop 0
    buffer_load_dwordx4 v15, s[24:27], s62 offen lds
    s_add_u32 s62, s62, 128
    s_cmp_eq_u32 s62, 896
    s_cselect_b32 s62, 0, s62
    s_cselect_b32 s66, s63, 0
    s_add_u32 m0, s47, 0
    s_nop 0
    buffer_load_dwordx4 v16, s[28:31], s46 offen lds
    s_add_u32 s46, s46, s45
    s_add_u32 m0, s47, 2048
    s_nop 0
    buffer_load_dwordx4 v16, s[28:31], s46 offen lds
    s_add_u32 s46, s46, s45
    s_add_u32 m0, s47, 1024
    s_nop 0
    buffer_load_dwordx4 v17, s[28:31], s46 offen lds
    s_add_u32 s46, s46, s45
    s_add_u32 m0, s47, 3072
    s_nop 0
    buffer_load_dwordx4 v17, s[28:31], s46 offen lds
    s_add_u32 s46, s46, s57
    s_sub_u32 s46, s46, s66
    s_waitcnt vmcnt(16)
    s_barrier
    s_add_u32 m0, s61, 32768
    s_nop 0
    buffer_load_dwordx4 v12, s[24:27], s62 offen lds
    s_add_u32 m0, s61, 33792
    s_nop 0
    buffer_load_dwordx4 v13, s[24:27], s62 offen lds
    s_add_u32 m0, s61, 34816
    s_nop 0
    buffer_load_dwordx4 v14, s[24:27], s62 offen lds
    s_add_u32 m0, s61, 35840
    s_nop 0
    buffer_load_dwordx4 v15, s[24:27], s62 offen lds
    s_add_u32 s62, s62, 128
    s_cmp_eq_u32 s62, 896
    s_cselect_b32 s62, 0, s62
    s_cselect_b32 s66, s63, 0
    s_add_u32 m0, s47, 32768
    s_nop 0
    buffer_load_dwordx4 v16, s[28:31], s46 offen lds
    s_add_u32 s46, s46, s45
    s_add_u32 m0, s47, 34816
    s_nop 0
    buffer_load_dwordx4 v16, s[28:31], s46 offen lds
    s_add_u32 s46, s46, s45
    s_add_u32 m0, s47, 33792
    s_nop 0
    buffer_load_dwordx4 v17, s[28:31], s46 offen lds
    s_add_u32 s46, s46, s45
    s_add_u32 m0, s47, 35840
    s_nop 0
    buffer_load_dwordx4 v17, s[28:31], s46 offen lds
    s_add_u32 s46, s46, s57
    s_sub_u32 s46, s46, s66
    s_waitcnt vmcnt(16)
    s_barrier
    s_waitcnt vmcnt(8)
    s_barrier
    s_waitcnt vmcnt(0)
    s_barrier
    s_cmp_lg_u32 s20, 3
    s_cbranch_scc1 L1_nbl
    s_barrier
L1_nbl:
    s_branch L2_entry
L1_aux:
    s_load_dwordx2 s[18:19], s[0:1], 56
    s_memrealtime s[94:95]
    s_waitcnt lgkmcnt(0)
    s_mov_b32 s24, s18
    s_and_b32 s25, s19, 0xffff
    s_mov_b32 s26, 256
    s_mov_b32 s27, 0x20000
    v_mov_b32 v4, 0
    s_cmp_lg_u32 s58, 8
    s_cbranch_scc1 L1_nn
    s_cmp_lg_u32 s2, 0
    s_cbranch_scc1 L1_nn
    s_or_b32 s94, s94, 1
    v_mov_b32 v5, s94
    s_mov_b64 exec, 1
    buffer_store_dword v5, v4, s[24:27], 0 offen sc1
    s_mov_b64 exec, -1
L1_nn:
    s_getpc_b64 s[68:69]
    s_add_u32 s68, s68, concat_heads__mha_block__spectral_gfnet__prompt_kernel@rel32@lo+4
    s_addc_u32 s69, s69, concat_heads__mha_block__spectral_gfnet__prompt_kernel@rel32@hi+12
    s_mov_b32 s28, s68
    s_and_b32 s29, s69, 0xffff
    s_mov_b32 s30, L_code_end-concat_heads__mha_block__spectral_gfnet__prompt_kernel
    s_mov_b32 s31, 0x20000
    s_bfe_u32 s59, s2, 0x30003
    s_lshl_b32 s59, s59, 2
    s_add_u32 s59, s59, s23
    s_lshl_b32 s59, s59, 10
    v_lshlrev_b32 v10, 4, v1
    buffer_load_dwordx4 v[32:35], v10, s[28:31], s59 offen
    s_barrier
    s_barrier
    s_barrier
    s_barrier
    buffer_load_dword v5, v4, s[24:27], 0 offen sc1
    s_barrier
    s_barrier
    s_waitcnt vmcnt(0)
    v_readfirstlane_b32 s96, v5
    s_mov_b32 s32, s10
    s_and_b32 s33, s11, 0xffff
    s_mov_b32 s34, 16777216
    s_mov_b32 s35, 0x20000
    s_mov_b32 s36, s12
    s_and_b32 s37, s13, 0xffff
    s_mov_b32 s38, 921600
    s_mov_b32 s39, 0x20000
    s_mov_b32 s40, s14
    s_and_b32 s41, s15, 0xffff
    s_mov_b32 s42, 921600
    s_mov_b32 s43, 0x20000
    s_lshr_b32 s50, s2, 6
    s_bfe_u32 s51, s2, 0x20002
    s_bfe_u32 s52, s2, 0x10004
    s_bfe_u32 s53, s2, 0x10005
    s_lshl_b32 s98, s50, 4
    s_add_u32 s98, s98, s52
    s_lshl_b32 s59, s51, 9
    s_add_u32 s98, s98, s59
    s_lshl_b32 s59, s53, 8
    s_add_u32 s98, s98, s59
    s_mul_i32 s98, s98, 450
    s_and_b32 s59, s2, 3
    s_mul_i32 s59, s59, 57
    s_lshl_b32 s60, s23, 4
    s_add_u32 s63, s59, s60
    v_add_u32 v102, s63, v2
    v_min_u32 v102, 224, v102
    v_mul_u32_u24 v9, 900, v3
    v_add_lshl_u32 v102, v102, v9, 1
    s_add_u32 s59, s98, 0
    buffer_load_ushort v64, v102, s[36:39], s59 offen
    buffer_load_ushort v72, v102, s[40:43], s59 offen
    s_add_u32 s59, s98, 28800
    buffer_load_ushort v65, v102, s[36:39], s59 offen
    buffer_load_ushort v73, v102, s[40:43], s59 offen
    s_add_u32 s59, s98, 57600
    buffer_load_ushort v66, v102, s[36:39], s59 offen
    buffer_load_ushort v74, v102, s[40:43], s59 offen
    s_add_u32 s59, s98, 86400
    buffer_load_ushort v67, v102, s[36:39], s59 offen
    buffer_load_ushort v75, v102, s[40:43], s59 offen
    s_add_u32 s59, s98, 900
    buffer_load_ushort v68, v102, s[36:39], s59 offen
    buffer_load_ushort v76, v102, s[40:43], s59 offen
    s_add_u32 s59, s98, 29700
    buffer_load_ushort v69, v102, s[36:39], s59 offen
    buffer_load_ushort v77, v102, s[40:43], s59 offen
    s_add_u32 s59, s98, 58500
    buffer_load_ushort v70, v102, s[36:39], s59 offen
    buffer_load_ushort v78, v102, s[40:43], s59 offen
    s_add_u32 s59, s98, 87300
    buffer_load_ushort v71, v102, s[36:39], s59 offen
    buffer_load_ushort v79, v102, s[40:43], s59 offen
    v_lshrrev_b32 v7, 3, v1
    v_and_b32 v8, 7, v1
    v_lshrrev_b32 v9, 1, v8
    v_lshl_add_u32 v9, v9, 4, v7
    v_lshlrev_b32 v100, 2, v9
    v_add_u32 v10, s63, v7
    v_lshlrev_b32 v101, 13, v10
    v_lshl_add_u32 v101, v8, 4, v101
    s_lshl_b32 s60, s23, 4
    v_add_u32 v7, s60, v7
    s_lshl_b32 s59, s53, 9
    s_lshl_b32 s60, s50, 7
    s_add_u32 s59, s59, s60
    s_lshl_b32 s60, s52, 12
    s_add_u32 s59, s59, s60
    s_lshl_b32 s60, s51, 10
    s_add_u32 s59, s59, s60
    s_add_u32 s92, s59, 8388608
    s_add_u32 s93, s92, 65536
    v_and_b32 v8, 1, v8
    v_cmp_eq_u32 s[86:87], 1, v8
    v_cmp_gt_u32 vcc, 57, v7
    v_mov_b32 v6, 225
    v_cmp_gt_u32 s[64:65], v6, v10
    s_and_b64 s[88:89], vcc, s[64:65]
    v_cmp_gt_u32 vcc, 49, v7
    v_mov_b32 v6, 217
    v_cmp_gt_u32 s[64:65], v6, v10
    s_and_b64 s[90:91], vcc, s[64:65]
    s_barrier
    s_cmp_lg_u32 s20, 3
    s_cbranch_scc1 L1_nba
    s_barrier
L1_nba:
    s_cmp_lg_u32 s58, 8
    s_cbranch_scc1 L1_nq
    s_mov_b32 s59, 0
L1_nl:
    s_cmp_lg_u32 s96, 0
    s_cbranch_scc1 L1_nq
    s_cmp_gt_u32 s59, 0x100000
    s_cbranch_scc1 L1_nq
    buffer_load_dword v5, v4, s[24:27], 0 offen sc1
    s_add_u32 s59, s59, 1
    s_waitcnt vmcnt(0)
    v_readfirstlane_b32 s96, v5
    s_branch L1_nl
L1_nq:
    s_branch L2_entry
L1_comp:
    v_lshrrev_b32 v4, 1, v3
    v_and_b32 v5, 1, v3
    v_lshrrev_b32 v6, 2, v2
    v_lshl_add_u32 v5, v5, 2, v6
    v_lshl_add_u32 v4, v4, 4, v5
    v_lshlrev_b32 v4, 8, v4
    v_and_b32 v6, 3, v2
    v_lshl_add_u32 v4, v6, 3, v4
    v_add_u32 v4, 16384, v4
    s_and_b32 s48, s22, 1
    s_add_u32 s49, s48, 0
    v_xor_b32 v6, s49, v5
    v_lshl_add_u32 v160, v6, 5, v4
    s_add_u32 s49, s48, 1
    v_xor_b32 v6, s49, v5
    v_lshl_add_u32 v161, v6, 5, v4
    s_add_u32 s49, s48, 2
    v_xor_b32 v6, s49, v5
    v_lshl_add_u32 v162, v6, 5, v4
    s_add_u32 s49, s48, 3
    v_xor_b32 v6, s49, v5
    v_lshl_add_u32 v163, v6, 5, v4
    s_add_u32 s49, s48, 4
    v_xor_b32 v6, s49, v5
    v_lshl_add_u32 v164, v6, 5, v4
    s_add_u32 s49, s48, 5
    v_xor_b32 v6, s49, v5
    v_lshl_add_u32 v165, v6, 5, v4
    s_add_u32 s49, s48, 6
    v_xor_b32 v6, s49, v5
    v_lshl_add_u32 v166, v6, 5, v4
    v_lshrrev_b32 v4, 1, v2
    v_xor_b32 v4, v4, v3
    v_xor_b32 v5, 4, v4
    v_lshlrev_b32 v6, 7, v2
    v_add_u32 v6, s61, v6
    v_lshl_add_u32 v26, v4, 4, v6
    v_lshl_add_u32 v27, v5, 4, v6
    v_mov_b32 v32, 0
    v_mov_b32 v33, 0
    v_mov_b32 v34, 0
    v_mov_b32 v35, 0
    v_mov_b32 v36, 0
    v_mov_b32 v37, 0
    v_mov_b32 v38, 0
    v_mov_b32 v39, 0
    v_mov_b32 v40, 0
    v_mov_b32 v41, 0
    v_mov_b32 v42, 0
    v_mov_b32 v43, 0
    v_mov_b32 v44, 0
    v_mov_b32 v45, 0
    v_mov_b32 v46, 0
    v_mov_b32 v47, 0
    v_mov_b32 v48, 0
    v_mov_b32 v49, 0
    v_mov_b32 v50, 0
    v_mov_b32 v51, 0
    v_mov_b32 v52, 0
    v_mov_b32 v53, 0
    v_mov_b32 v54, 0
    v_mov_b32 v55, 0
    v_mov_b32 v56, 0
    v_mov_b32 v57, 0
    v_mov_b32 v58, 0
    v_mov_b32 v59, 0
    v_mov_b32 v60, 0
    v_mov_b32 v61, 0
    v_mov_b32 v62, 0
    v_mov_b32 v63, 0
    v_mov_b32 v64, 0
    v_mov_b32 v65, 0
    v_mov_b32 v66, 0
    v_mov_b32 v67, 0
    v_mov_b32 v68, 0
    v_mov_b32 v69, 0
    v_mov_b32 v70, 0
    v_mov_b32 v71, 0
    v_mov_b32 v72, 0
    v_mov_b32 v73, 0
    v_mov_b32 v74, 0
    v_mov_b32 v75, 0
    v_mov_b32 v76, 0
    v_mov_b32 v77, 0
    v_mov_b32 v78, 0
    v_mov_b32 v79, 0
    v_mov_b32 v80, 0
    v_mov_b32 v81, 0
    v_mov_b32 v82, 0
    v_mov_b32 v83, 0
    v_mov_b32 v84, 0
    v_mov_b32 v85, 0
    v_mov_b32 v86, 0
    v_mov_b32 v87, 0
    s_waitcnt lgkmcnt(0)
    s_mov_b32 s32, s10
    s_and_b32 s33, s11, 0xffff
    s_mov_b32 s34, 16777216
    s_mov_b32 s35, 0x20000
    s_cmp_ge_u32 s20, 2
    s_cbranch_scc1 L1_vf
    s_cmp_eq_u32 s20, 0
    s_cselect_b32 s64, 0x3e8b97f6, 1.0
    s_mov_b32 s65, s64
    s_lshl_b32 s48, s21, 2
    s_add_u32 s48, s48, s23
    s_lshl_b32 s48, s48, 11
    s_lshl_b32 s49, s22, 19
    s_add_u32 s48, s48, s49
    s_lshl_b32 s48, s48, s20
    s_cmp_eq_u32 s20, 0
    s_cselect_b32 s49, 0, 2097152
    s_add_u32 s48, s48, s49
    s_cmp_eq_u32 s20, 0
    s_mov_b32 s49, 262144
    s_cselect_b32 s49, 131072, s49
    s_lshl_b32 s50, s23, 13
    s_add_u32 s50, s50, 65536
    v_and_b32 v4, 7, v2
    v_and_b32 v5, 8, v2
    v_lshl_add_u32 v4, v5, 1, v4
    v_lshlrev_b32 v4, 4, v4
    v_add_u32 v4, s50, v4
    v_and_b32 v5, 31, v1
    v_lshrrev_b32 v6, 5, v1
    v_lshlrev_b32 v6, 11, v6
    v_lshl_add_u32 v5, v5, 4, v6
    v_add_u32 v19, s50, v5
    s_mul_i32 s51, s20, 0x3f803f80
    s_mul_i32 s52, s20, 0x3f80
    v_mov_b32 v28, s51
    v_mov_b32 v29, s52
    v_add_u32 v6, 0, v3
    v_mul_u32_u24 v7, 37, v6
    v_lshrrev_b32 v7, 8, v7
    v_add_u32 v6, v6, v7
    v_lshrrev_b32 v7, 1, v6
    v_and_b32 v6, 1, v6
    v_lshl_add_u32 v7, v7, 9, v4
    v_lshl_add_u32 v12, v6, 3, v7
    v_add_u32 v6, 4, v3
    v_mul_u32_u24 v7, 37, v6
    v_lshrrev_b32 v7, 8, v7
    v_add_u32 v6, v6, v7
    v_lshrrev_b32 v7, 1, v6
    v_and_b32 v6, 1, v6
    v_lshl_add_u32 v7, v7, 9, v4
    v_lshl_add_u32 v13, v6, 3, v7
    v_add_u32 v6, 8, v3
    v_mul_u32_u24 v7, 37, v6
    v_lshrrev_b32 v7, 8, v7
    v_add_u32 v6, v6, v7
    v_lshrrev_b32 v7, 1, v6
    v_and_b32 v6, 1, v6
    v_lshl_add_u32 v7, v7, 9, v4
    v_lshl_add_u32 v14, v6, 3, v7
    v_add_u32 v6, 12, v3
    v_mul_u32_u24 v7, 37, v6
    v_lshrrev_b32 v7, 8, v7
    v_add_u32 v6, v6, v7
    v_lshrrev_b32 v7, 1, v6
    v_and_b32 v6, 1, v6
    v_lshl_add_u32 v7, v7, 9, v4
    v_lshl_add_u32 v15, v6, 3, v7
    v_add_u32 v6, 16, v3
    v_mul_u32_u24 v7, 37, v6
    v_lshrrev_b32 v7, 8, v7
    v_add_u32 v6, v6, v7
    v_lshrrev_b32 v7, 1, v6
    v_and_b32 v6, 1, v6
    v_lshl_add_u32 v7, v7, 9, v4
    v_lshl_add_u32 v16, v6, 3, v7
    v_add_u32 v6, 20, v3
    v_mul_u32_u24 v7, 37, v6
    v_lshrrev_b32 v7, 8, v7
    v_add_u32 v6, v6, v7
    v_lshrrev_b32 v7, 1, v6
    v_and_b32 v6, 1, v6
    v_lshl_add_u32 v7, v7, 9, v4
    v_lshl_add_u32 v17, v6, 3, v7
    v_add_u32 v6, 24, v3
    v_mul_u32_u24 v7, 37, v6
    v_lshrrev_b32 v7, 8, v7
    v_add_u32 v6, v6, v7
    v_lshrrev_b32 v7, 1, v6
    v_and_b32 v6, 1, v6
    v_lshl_add_u32 v7, v7, 9, v4
    v_lshl_add_u32 v18, v6, 3, v7
    v_lshlrev_b32 v20, 4, v1
    v_add_u32 v21, s50, v20
    s_barrier
    ds_read_b128 v[144:147], v26 offset:0
    ds_read_b128 v[148:151], v26 offset:2048
    ds_read_b64_tr_b16 v[88:89], v160 offset:0
    ds_read_b64_tr_b16 v[90:91], v160 offset:2048
    ds_read_b64_tr_b16 v[92:93], v161 offset:0
    ds_read_b64_tr_b16 v[94:95], v161 offset:2048
    ds_read_b64_tr_b16 v[96:97], v162 offset:0
    ds_read_b64_tr_b16 v[98:99], v162 offset:2048
    ds_read_b64_tr_b16 v[100:101], v163 offset:0
    ds_read_b64_tr_b16 v[102:103], v163 offset:2048
    ds_read_b64_tr_b16 v[104:105], v164 offset:0
    ds_read_b64_tr_b16 v[106:107], v164 offset:2048
    ds_read_b64_tr_b16 v[108:109], v165 offset:0
    ds_read_b64_tr_b16 v[110:111], v165 offset:2048
    ds_read_b64_tr_b16 v[112:113], v166 offset:0
    ds_read_b64_tr_b16 v[114:115], v166 offset:2048
    s_waitcnt lgkmcnt(0)
    v_mfma_f32_16x16x32_bf16 v[32:35], v[88:91], v[144:147], v[32:35]
    ds_read_b128 v[152:155], v27 offset:0
    ds_read_b128 v[156:159], v27 offset:2048
    v_mfma_f32_16x16x32_bf16 v[60:63], v[88:91], v[148:151], v[60:63]
    ds_read_b64_tr_b16 v[116:117], v160 offset:8192
    ds_read_b64_tr_b16 v[118:119], v160 offset:10240
    v_mfma_f32_16x16x32_bf16 v[36:39], v[92:95], v[144:147], v[36:39]
    ds_read_b64_tr_b16 v[120:121], v161 offset:8192
    ds_read_b64_tr_b16 v[122:123], v161 offset:10240
    v_mfma_f32_16x16x32_bf16 v[64:67], v[92:95], v[148:151], v[64:67]
    ds_read_b64_tr_b16 v[124:125], v162 offset:8192
    ds_read_b64_tr_b16 v[126:127], v162 offset:10240
    v_mfma_f32_16x16x32_bf16 v[40:43], v[96:99], v[144:147], v[40:43]
    ds_read_b64_tr_b16 v[128:129], v163 offset:8192
    ds_read_b64_tr_b16 v[130:131], v163 offset:10240
    v_mfma_f32_16x16x32_bf16 v[68:71], v[96:99], v[148:151], v[68:71]
    ds_read_b64_tr_b16 v[132:133], v164 offset:8192
    ds_read_b64_tr_b16 v[134:135], v164 offset:10240
    v_mfma_f32_16x16x32_bf16 v[44:47], v[100:103], v[144:147], v[44:47]
    ds_read_b64_tr_b16 v[136:137], v165 offset:8192
    ds_read_b64_tr_b16 v[138:139], v165 offset:10240
    v_mfma_f32_16x16x32_bf16 v[72:75], v[100:103], v[148:151], v[72:75]
    ds_read_b64_tr_b16 v[140:141], v166 offset:8192
    ds_read_b64_tr_b16 v[142:143], v166 offset:10240
    v_mfma_f32_16x16x32_bf16 v[48:51], v[104:107], v[144:147], v[48:51]
    v_mfma_f32_16x16x32_bf16 v[76:79], v[104:107], v[148:151], v[76:79]
    v_mfma_f32_16x16x32_bf16 v[52:55], v[108:111], v[144:147], v[52:55]
    v_mfma_f32_16x16x32_bf16 v[80:83], v[108:111], v[148:151], v[80:83]
    v_mfma_f32_16x16x32_bf16 v[56:59], v[112:115], v[144:147], v[56:59]
    v_mfma_f32_16x16x32_bf16 v[84:87], v[112:115], v[148:151], v[84:87]
    s_barrier
    s_waitcnt lgkmcnt(0)
    v_mfma_f32_16x16x32_bf16 v[32:35], v[116:119], v[152:155], v[32:35]
    ds_read_b128 v[144:147], v26 offset:32768
    ds_read_b128 v[148:151], v26 offset:34816
    v_mfma_f32_16x16x32_bf16 v[60:63], v[116:119], v[156:159], v[60:63]
    ds_read_b64_tr_b16 v[88:89], v160 offset:32768
    ds_read_b64_tr_b16 v[90:91], v160 offset:34816
    v_mfma_f32_16x16x32_bf16 v[36:39], v[120:123], v[152:155], v[36:39]
    ds_read_b64_tr_b16 v[92:93], v161 offset:32768
    ds_read_b64_tr_b16 v[94:95], v161 offset:34816
    v_mfma_f32_16x16x32_bf16 v[64:67], v[120:123], v[156:159], v[64:67]
    ds_read_b64_tr_b16 v[96:97], v162 offset:32768
    ds_read_b64_tr_b16 v[98:99], v162 offset:34816
    v_mfma_f32_16x16x32_bf16 v[40:43], v[124:127], v[152:155], v[40:43]
    ds_read_b64_tr_b16 v[100:101], v163 offset:32768
    ds_read_b64_tr_b16 v[102:103], v163 offset:34816
    v_mfma_f32_16x16x32_bf16 v[68:71], v[124:127], v[156:159], v[68:71]
    ds_read_b64_tr_b16 v[104:105], v164 offset:32768
    ds_read_b64_tr_b16 v[106:107], v164 offset:34816
    v_mfma_f32_16x16x32_bf16 v[44:47], v[128:131], v[152:155], v[44:47]
    ds_read_b64_tr_b16 v[108:109], v165 offset:32768
    ds_read_b64_tr_b16 v[110:111], v165 offset:34816
    v_mfma_f32_16x16x32_bf16 v[72:75], v[128:131], v[156:159], v[72:75]
    ds_read_b64_tr_b16 v[112:113], v166 offset:32768
    ds_read_b64_tr_b16 v[114:115], v166 offset:34816
    v_mfma_f32_16x16x32_bf16 v[48:51], v[132:135], v[152:155], v[48:51]
    v_mfma_f32_16x16x32_bf16 v[76:79], v[132:135], v[156:159], v[76:79]
    v_mfma_f32_16x16x32_bf16 v[52:55], v[136:139], v[152:155], v[52:55]
    v_mfma_f32_16x16x32_bf16 v[80:83], v[136:139], v[156:159], v[80:83]
    v_mfma_f32_16x16x32_bf16 v[56:59], v[140:143], v[152:155], v[56:59]
    v_mfma_f32_16x16x32_bf16 v[84:87], v[140:143], v[156:159], v[84:87]
    s_waitcnt lgkmcnt(0)
    v_mfma_f32_16x16x32_bf16 v[32:35], v[88:91], v[144:147], v[32:35]
    ds_read_b128 v[152:155], v27 offset:32768
    ds_read_b128 v[156:159], v27 offset:34816
    v_mfma_f32_16x16x32_bf16 v[60:63], v[88:91], v[148:151], v[60:63]
    ds_read_b64_tr_b16 v[116:117], v160 offset:40960
    ds_read_b64_tr_b16 v[118:119], v160 offset:43008
    v_mfma_f32_16x16x32_bf16 v[36:39], v[92:95], v[144:147], v[36:39]
    ds_read_b64_tr_b16 v[120:121], v161 offset:40960
    ds_read_b64_tr_b16 v[122:123], v161 offset:43008
    v_mfma_f32_16x16x32_bf16 v[64:67], v[92:95], v[148:151], v[64:67]
    ds_read_b64_tr_b16 v[124:125], v162 offset:40960
    ds_read_b64_tr_b16 v[126:127], v162 offset:43008
    v_mfma_f32_16x16x32_bf16 v[40:43], v[96:99], v[144:147], v[40:43]
    ds_read_b64_tr_b16 v[128:129], v163 offset:40960
    ds_read_b64_tr_b16 v[130:131], v163 offset:43008
    v_mfma_f32_16x16x32_bf16 v[68:71], v[96:99], v[148:151], v[68:71]
    ds_read_b64_tr_b16 v[132:133], v164 offset:40960
    ds_read_b64_tr_b16 v[134:135], v164 offset:43008
    v_mfma_f32_16x16x32_bf16 v[44:47], v[100:103], v[144:147], v[44:47]
    ds_read_b64_tr_b16 v[136:137], v165 offset:40960
    ds_read_b64_tr_b16 v[138:139], v165 offset:43008
    v_mfma_f32_16x16x32_bf16 v[72:75], v[100:103], v[148:151], v[72:75]
    ds_read_b64_tr_b16 v[140:141], v166 offset:40960
    ds_read_b64_tr_b16 v[142:143], v166 offset:43008
    v_mfma_f32_16x16x32_bf16 v[48:51], v[104:107], v[144:147], v[48:51]
    v_mfma_f32_16x16x32_bf16 v[76:79], v[104:107], v[148:151], v[76:79]
    v_mfma_f32_16x16x32_bf16 v[52:55], v[108:111], v[144:147], v[52:55]
    v_mfma_f32_16x16x32_bf16 v[80:83], v[108:111], v[148:151], v[80:83]
    v_mfma_f32_16x16x32_bf16 v[56:59], v[112:115], v[144:147], v[56:59]
    v_mfma_f32_16x16x32_bf16 v[84:87], v[112:115], v[148:151], v[84:87]
    s_barrier
    v_add_u32 v160, 0x10000, v160
    v_add_u32 v161, 0x10000, v161
    v_add_u32 v162, 0x10000, v162
    v_add_u32 v163, 0x10000, v163
    v_add_u32 v164, 0x10000, v164
    v_add_u32 v165, 0x10000, v165
    v_add_u32 v166, 0x10000, v166
    v_add_u32 v26, 0x10000, v26
    v_add_u32 v27, 0x10000, v27
    s_waitcnt lgkmcnt(0)
    v_mfma_f32_16x16x32_bf16 v[32:35], v[116:119], v[152:155], v[32:35]
    ds_read_b128 v[144:147], v26 offset:0
    ds_read_b128 v[148:151], v26 offset:2048
    v_mfma_f32_16x16x32_bf16 v[60:63], v[116:119], v[156:159], v[60:63]
    ds_read_b64_tr_b16 v[88:89], v160 offset:0
    ds_read_b64_tr_b16 v[90:91], v160 offset:2048
    v_mfma_f32_16x16x32_bf16 v[36:39], v[120:123], v[152:155], v[36:39]
    ds_read_b64_tr_b16 v[92:93], v161 offset:0
    ds_read_b64_tr_b16 v[94:95], v161 offset:2048
    v_mfma_f32_16x16x32_bf16 v[64:67], v[120:123], v[156:159], v[64:67]
    ds_read_b64_tr_b16 v[96:97], v162 offset:0
    ds_read_b64_tr_b16 v[98:99], v162 offset:2048
    v_mfma_f32_16x16x32_bf16 v[40:43], v[124:127], v[152:155], v[40:43]
    ds_read_b64_tr_b16 v[100:101], v163 offset:0
    ds_read_b64_tr_b16 v[102:103], v163 offset:2048
    v_mfma_f32_16x16x32_bf16 v[68:71], v[124:127], v[156:159], v[68:71]
    ds_read_b64_tr_b16 v[104:105], v164 offset:0
    ds_read_b64_tr_b16 v[106:107], v164 offset:2048
    v_mfma_f32_16x16x32_bf16 v[44:47], v[128:131], v[152:155], v[44:47]
    ds_read_b64_tr_b16 v[108:109], v165 offset:0
    ds_read_b64_tr_b16 v[110:111], v165 offset:2048
    v_mfma_f32_16x16x32_bf16 v[72:75], v[128:131], v[156:159], v[72:75]
    ds_read_b64_tr_b16 v[112:113], v166 offset:0
    ds_read_b64_tr_b16 v[114:115], v166 offset:2048
    v_mfma_f32_16x16x32_bf16 v[48:51], v[132:135], v[152:155], v[48:51]
    v_mfma_f32_16x16x32_bf16 v[76:79], v[132:135], v[156:159], v[76:79]
    v_mfma_f32_16x16x32_bf16 v[52:55], v[136:139], v[152:155], v[52:55]
    v_mfma_f32_16x16x32_bf16 v[80:83], v[136:139], v[156:159], v[80:83]
    v_mfma_f32_16x16x32_bf16 v[56:59], v[140:143], v[152:155], v[56:59]
    v_mfma_f32_16x16x32_bf16 v[84:87], v[140:143], v[156:159], v[84:87]
    s_waitcnt lgkmcnt(0)
    v_mfma_f32_16x16x32_bf16 v[32:35], v[88:91], v[144:147], v[32:35]
    ds_read_b128 v[152:155], v27 offset:0
    ds_read_b128 v[156:159], v27 offset:2048
    v_mfma_f32_16x16x32_bf16 v[60:63], v[88:91], v[148:151], v[60:63]
    ds_read_b64_tr_b16 v[116:117], v160 offset:8192
    ds_read_b64_tr_b16 v[118:119], v160 offset:10240
    v_mfma_f32_16x16x32_bf16 v[36:39], v[92:95], v[144:147], v[36:39]
    ds_read_b64_tr_b16 v[120:121], v161 offset:8192
    ds_read_b64_tr_b16 v[122:123], v161 offset:10240
    v_mfma_f32_16x16x32_bf16 v[64:67], v[92:95], v[148:151], v[64:67]
    ds_read_b64_tr_b16 v[124:125], v162 offset:8192
    ds_read_b64_tr_b16 v[126:127], v162 offset:10240
    v_mfma_f32_16x16x32_bf16 v[40:43], v[96:99], v[144:147], v[40:43]
    ds_read_b64_tr_b16 v[128:129], v163 offset:8192
    ds_read_b64_tr_b16 v[130:131], v163 offset:10240
    v_mfma_f32_16x16x32_bf16 v[68:71], v[96:99], v[148:151], v[68:71]
    ds_read_b64_tr_b16 v[132:133], v164 offset:8192
    ds_read_b64_tr_b16 v[134:135], v164 offset:10240
    v_mfma_f32_16x16x32_bf16 v[44:47], v[100:103], v[144:147], v[44:47]
    ds_read_b64_tr_b16 v[136:137], v165 offset:8192
    ds_read_b64_tr_b16 v[138:139], v165 offset:10240
    v_mfma_f32_16x16x32_bf16 v[72:75], v[100:103], v[148:151], v[72:75]
    ds_read_b64_tr_b16 v[140:141], v166 offset:8192
    ds_read_b64_tr_b16 v[142:143], v166 offset:10240
    v_mfma_f32_16x16x32_bf16 v[48:51], v[104:107], v[144:147], v[48:51]
    v_mfma_f32_16x16x32_bf16 v[76:79], v[104:107], v[148:151], v[76:79]
    v_mfma_f32_16x16x32_bf16 v[52:55], v[108:111], v[144:147], v[52:55]
    v_mfma_f32_16x16x32_bf16 v[80:83], v[108:111], v[148:151], v[80:83]
    v_mfma_f32_16x16x32_bf16 v[56:59], v[112:115], v[144:147], v[56:59]
    v_mfma_f32_16x16x32_bf16 v[84:87], v[112:115], v[148:151], v[84:87]
    s_barrier
    s_waitcnt lgkmcnt(0)
    v_mfma_f32_16x16x32_bf16 v[32:35], v[116:119], v[152:155], v[32:35]
    ds_read_b128 v[144:147], v26 offset:32768
    ds_read_b128 v[148:151], v26 offset:34816
    v_mfma_f32_16x16x32_bf16 v[60:63], v[116:119], v[156:159], v[60:63]
    ds_read_b64_tr_b16 v[88:89], v160 offset:32768
    ds_read_b64_tr_b16 v[90:91], v160 offset:34816
    v_mfma_f32_16x16x32_bf16 v[36:39], v[120:123], v[152:155], v[36:39]
    ds_read_b64_tr_b16 v[92:93], v161 offset:32768
    ds_read_b64_tr_b16 v[94:95], v161 offset:34816
    v_mfma_f32_16x16x32_bf16 v[64:67], v[120:123], v[156:159], v[64:67]
    ds_read_b64_tr_b16 v[96:97], v162 offset:32768
    ds_read_b64_tr_b16 v[98:99], v162 offset:34816
    v_mfma_f32_16x16x32_bf16 v[40:43], v[124:127], v[152:155], v[40:43]
    ds_read_b64_tr_b16 v[100:101], v163 offset:32768
    ds_read_b64_tr_b16 v[102:103], v163 offset:34816
    v_mfma_f32_16x16x32_bf16 v[68:71], v[124:127], v[156:159], v[68:71]
    ds_read_b64_tr_b16 v[104:105], v164 offset:32768
    ds_read_b64_tr_b16 v[106:107], v164 offset:34816
    v_mfma_f32_16x16x32_bf16 v[44:47], v[128:131], v[152:155], v[44:47]
    ds_read_b64_tr_b16 v[108:109], v165 offset:32768
    ds_read_b64_tr_b16 v[110:111], v165 offset:34816
    v_mfma_f32_16x16x32_bf16 v[72:75], v[128:131], v[156:159], v[72:75]
    ds_read_b64_tr_b16 v[112:113], v166 offset:32768
    ds_read_b64_tr_b16 v[114:115], v166 offset:34816
    v_mfma_f32_16x16x32_bf16 v[48:51], v[132:135], v[152:155], v[48:51]
    v_mfma_f32_16x16x32_bf16 v[76:79], v[132:135], v[156:159], v[76:79]
    v_mfma_f32_16x16x32_bf16 v[52:55], v[136:139], v[152:155], v[52:55]
    v_mfma_f32_16x16x32_bf16 v[80:83], v[136:139], v[156:159], v[80:83]
    v_mfma_f32_16x16x32_bf16 v[56:59], v[140:143], v[152:155], v[56:59]
    v_mfma_f32_16x16x32_bf16 v[84:87], v[140:143], v[156:159], v[84:87]
    s_waitcnt lgkmcnt(0)
    v_mfma_f32_16x16x32_bf16 v[32:35], v[88:91], v[144:147], v[32:35]
    ds_read_b128 v[152:155], v27 offset:32768
    ds_read_b128 v[156:159], v27 offset:34816
    v_mfma_f32_16x16x32_bf16 v[60:63], v[88:91], v[148:151], v[60:63]
    ds_read_b64_tr_b16 v[116:117], v160 offset:40960
    ds_read_b64_tr_b16 v[118:119], v160 offset:43008
    v_mfma_f32_16x16x32_bf16 v[36:39], v[92:95], v[144:147], v[36:39]
    ds_read_b64_tr_b16 v[120:121], v161 offset:40960
    ds_read_b64_tr_b16 v[122:123], v161 offset:43008
    v_mfma_f32_16x16x32_bf16 v[64:67], v[92:95], v[148:151], v[64:67]
    ds_read_b64_tr_b16 v[124:125], v162 offset:40960
    ds_read_b64_tr_b16 v[126:127], v162 offset:43008
    v_mfma_f32_16x16x32_bf16 v[40:43], v[96:99], v[144:147], v[40:43]
    ds_read_b64_tr_b16 v[128:129], v163 offset:40960
    ds_read_b64_tr_b16 v[130:131], v163 offset:43008
    v_mfma_f32_16x16x32_bf16 v[68:71], v[96:99], v[148:151], v[68:71]
    ds_read_b64_tr_b16 v[132:133], v164 offset:40960
    ds_read_b64_tr_b16 v[134:135], v164 offset:43008
    v_mfma_f32_16x16x32_bf16 v[44:47], v[100:103], v[144:147], v[44:47]
    ds_read_b64_tr_b16 v[136:137], v165 offset:40960
    ds_read_b64_tr_b16 v[138:139], v165 offset:43008
    v_mfma_f32_16x16x32_bf16 v[72:75], v[100:103], v[148:151], v[72:75]
    ds_read_b64_tr_b16 v[140:141], v166 offset:40960
    ds_read_b64_tr_b16 v[142:143], v166 offset:43008
    v_mfma_f32_16x16x32_bf16 v[48:51], v[104:107], v[144:147], v[48:51]
    v_mfma_f32_16x16x32_bf16 v[76:79], v[104:107], v[148:151], v[76:79]
    v_mfma_f32_16x16x32_bf16 v[52:55], v[108:111], v[144:147], v[52:55]
    v_mfma_f32_16x16x32_bf16 v[80:83], v[108:111], v[148:151], v[80:83]
    v_mfma_f32_16x16x32_bf16 v[56:59], v[112:115], v[144:147], v[56:59]
    v_mfma_f32_16x16x32_bf16 v[84:87], v[112:115], v[148:151], v[84:87]
    s_barrier
    v_add_u32 v160, 0x10000, v160
    v_add_u32 v161, 0x10000, v161
    v_add_u32 v162, 0x10000, v162
    v_add_u32 v163, 0x10000, v163
    v_add_u32 v164, 0x10000, v164
    v_add_u32 v165, 0x10000, v165
    v_add_u32 v166, 0x10000, v166
    v_add_u32 v26, 0x10000, v26
    v_add_u32 v27, 0x10000, v27
    s_waitcnt lgkmcnt(0)
    v_mfma_f32_16x16x32_bf16 v[32:35], v[116:119], v[152:155], v[32:35]
    ds_read_b128 v[144:147], v26 offset:0
    ds_read_b128 v[148:151], v26 offset:2048
    v_mfma_f32_16x16x32_bf16 v[60:63], v[116:119], v[156:159], v[60:63]
    ds_read_b64_tr_b16 v[88:89], v160 offset:0
    ds_read_b64_tr_b16 v[90:91], v160 offset:2048
    v_mfma_f32_16x16x32_bf16 v[36:39], v[120:123], v[152:155], v[36:39]
    ds_read_b64_tr_b16 v[92:93], v161 offset:0
    ds_read_b64_tr_b16 v[94:95], v161 offset:2048
    v_mfma_f32_16x16x32_bf16 v[64:67], v[120:123], v[156:159], v[64:67]
    ds_read_b64_tr_b16 v[96:97], v162 offset:0
    ds_read_b64_tr_b16 v[98:99], v162 offset:2048
    v_mfma_f32_16x16x32_bf16 v[40:43], v[124:127], v[152:155], v[40:43]
    ds_read_b64_tr_b16 v[100:101], v163 offset:0
    ds_read_b64_tr_b16 v[102:103], v163 offset:2048
    v_mfma_f32_16x16x32_bf16 v[68:71], v[124:127], v[156:159], v[68:71]
    ds_read_b64_tr_b16 v[104:105], v164 offset:0
    ds_read_b64_tr_b16 v[106:107], v164 offset:2048
    v_mfma_f32_16x16x32_bf16 v[44:47], v[128:131], v[152:155], v[44:47]
    ds_read_b64_tr_b16 v[108:109], v165 offset:0
    ds_read_b64_tr_b16 v[110:111], v165 offset:2048
    v_mfma_f32_16x16x32_bf16 v[72:75], v[128:131], v[156:159], v[72:75]
    ds_read_b64_tr_b16 v[112:113], v166 offset:0
    ds_read_b64_tr_b16 v[114:115], v166 offset:2048
    v_mfma_f32_16x16x32_bf16 v[48:51], v[132:135], v[152:155], v[48:51]
    v_mfma_f32_16x16x32_bf16 v[76:79], v[132:135], v[156:159], v[76:79]
    v_mfma_f32_16x16x32_bf16 v[52:55], v[136:139], v[152:155], v[52:55]
    v_mfma_f32_16x16x32_bf16 v[80:83], v[136:139], v[156:159], v[80:83]
    v_mfma_f32_16x16x32_bf16 v[56:59], v[140:143], v[152:155], v[56:59]
    v_mfma_f32_16x16x32_bf16 v[84:87], v[140:143], v[156:159], v[84:87]
    s_waitcnt lgkmcnt(0)
    v_mfma_f32_16x16x32_bf16 v[32:35], v[88:91], v[144:147], v[32:35]
    ds_read_b128 v[152:155], v27 offset:0
    ds_read_b128 v[156:159], v27 offset:2048
    v_mfma_f32_16x16x32_bf16 v[60:63], v[88:91], v[148:151], v[60:63]
    ds_read_b64_tr_b16 v[116:117], v160 offset:8192
    ds_read_b64_tr_b16 v[118:119], v160 offset:10240
    v_mfma_f32_16x16x32_bf16 v[36:39], v[92:95], v[144:147], v[36:39]
    ds_read_b64_tr_b16 v[120:121], v161 offset:8192
    ds_read_b64_tr_b16 v[122:123], v161 offset:10240
    v_mfma_f32_16x16x32_bf16 v[64:67], v[92:95], v[148:151], v[64:67]
    ds_read_b64_tr_b16 v[124:125], v162 offset:8192
    ds_read_b64_tr_b16 v[126:127], v162 offset:10240
    v_mfma_f32_16x16x32_bf16 v[40:43], v[96:99], v[144:147], v[40:43]
    ds_read_b64_tr_b16 v[128:129], v163 offset:8192
    ds_read_b64_tr_b16 v[130:131], v163 offset:10240
    v_mfma_f32_16x16x32_bf16 v[68:71], v[96:99], v[148:151], v[68:71]
    ds_read_b64_tr_b16 v[132:133], v164 offset:8192
    ds_read_b64_tr_b16 v[134:135], v164 offset:10240
    v_mfma_f32_16x16x32_bf16 v[44:47], v[100:103], v[144:147], v[44:47]
    ds_read_b64_tr_b16 v[136:137], v165 offset:8192
    ds_read_b64_tr_b16 v[138:139], v165 offset:10240
    v_mfma_f32_16x16x32_bf16 v[72:75], v[100:103], v[148:151], v[72:75]
    ds_read_b64_tr_b16 v[140:141], v166 offset:8192
    ds_read_b64_tr_b16 v[142:143], v166 offset:10240
    v_mfma_f32_16x16x32_bf16 v[48:51], v[104:107], v[144:147], v[48:51]
    v_mfma_f32_16x16x32_bf16 v[76:79], v[104:107], v[148:151], v[76:79]
    v_mfma_f32_16x16x32_bf16 v[52:55], v[108:111], v[144:147], v[52:55]
    v_mfma_f32_16x16x32_bf16 v[80:83], v[108:111], v[148:151], v[80:83]
    v_mfma_f32_16x16x32_bf16 v[56:59], v[112:115], v[144:147], v[56:59]
    v_mfma_f32_16x16x32_bf16 v[84:87], v[112:115], v[148:151], v[84:87]
    s_barrier
    v_add_u32 v160, 0xfffe0000, v160
    v_add_u32 v161, 0xfffe0000, v161
    v_add_u32 v162, 0xfffe0000, v162
    v_add_u32 v163, 0xfffe0000, v163
    v_add_u32 v164, 0xfffe0000, v164
    v_add_u32 v165, 0xfffe0000, v165
    v_add_u32 v166, 0xfffe0000, v166
    v_add_u32 v26, 0xfffe0000, v26
    v_add_u32 v27, 0xfffe0000, v27
    s_waitcnt lgkmcnt(0)
    v_mfma_f32_16x16x32_bf16 v[32:35], v[116:119], v[152:155], v[32:35]
    ds_read_b128 v[144:147], v26 offset:0
    ds_read_b128 v[148:151], v26 offset:2048
    v_mfma_f32_16x16x32_bf16 v[60:63], v[116:119], v[156:159], v[60:63]
    ds_read_b64_tr_b16 v[88:89], v160 offset:0
    ds_read_b64_tr_b16 v[90:91], v160 offset:2048
    v_mfma_f32_16x16x32_bf16 v[36:39], v[120:123], v[152:155], v[36:39]
    ds_read_b64_tr_b16 v[92:93], v161 offset:0
    ds_read_b64_tr_b16 v[94:95], v161 offset:2048
    v_mfma_f32_16x16x32_bf16 v[64:67], v[120:123], v[156:159], v[64:67]
    ds_read_b64_tr_b16 v[96:97], v162 offset:0
    ds_read_b64_tr_b16 v[98:99], v162 offset:2048
    v_mfma_f32_16x16x32_bf16 v[40:43], v[124:127], v[152:155], v[40:43]
    ds_read_b64_tr_b16 v[100:101], v163 offset:0
    ds_read_b64_tr_b16 v[102:103], v163 offset:2048
    v_mfma_f32_16x16x32_bf16 v[68:71], v[124:127], v[156:159], v[68:71]
    ds_read_b64_tr_b16 v[104:105], v164 offset:0
    ds_read_b64_tr_b16 v[106:107], v164 offset:2048
    v_mfma_f32_16x16x32_bf16 v[44:47], v[128:131], v[152:155], v[44:47]
    ds_read_b64_tr_b16 v[108:109], v165 offset:0
    ds_read_b64_tr_b16 v[110:111], v165 offset:2048
    v_mfma_f32_16x16x32_bf16 v[72:75], v[128:131], v[156:159], v[72:75]
    ds_read_b64_tr_b16 v[112:113], v166 offset:0
    ds_read_b64_tr_b16 v[114:115], v166 offset:2048
    v_mfma_f32_16x16x32_bf16 v[48:51], v[132:135], v[152:155], v[48:51]
    v_mfma_f32_16x16x32_bf16 v[76:79], v[132:135], v[156:159], v[76:79]
    v_mfma_f32_16x16x32_bf16 v[52:55], v[136:139], v[152:155], v[52:55]
    v_mfma_f32_16x16x32_bf16 v[80:83], v[136:139], v[156:159], v[80:83]
    v_mfma_f32_16x16x32_bf16 v[56:59], v[140:143], v[152:155], v[56:59]
    v_mfma_f32_16x16x32_bf16 v[84:87], v[140:143], v[156:159], v[84:87]
    s_waitcnt lgkmcnt(0)
    v_mfma_f32_16x16x32_bf16 v[32:35], v[88:91], v[144:147], v[32:35]
    ds_read_b128 v[152:155], v27 offset:0
    ds_read_b128 v[156:159], v27 offset:2048
    v_mfma_f32_16x16x32_bf16 v[60:63], v[88:91], v[148:151], v[60:63]
    ds_read_b64_tr_b16 v[116:117], v160 offset:8192
    ds_read_b64_tr_b16 v[118:119], v160 offset:10240
    v_mfma_f32_16x16x32_bf16 v[36:39], v[92:95], v[144:147], v[36:39]
    ds_read_b64_tr_b16 v[120:121], v161 offset:8192
    ds_read_b64_tr_b16 v[122:123], v161 offset:10240
    v_mfma_f32_16x16x32_bf16 v[64:67], v[92:95], v[148:151], v[64:67]
    ds_read_b64_tr_b16 v[124:125], v162 offset:8192
    ds_read_b64_tr_b16 v[126:127], v162 offset:10240
    v_mfma_f32_16x16x32_bf16 v[40:43], v[96:99], v[144:147], v[40:43]
    ds_read_b64_tr_b16 v[128:129], v163 offset:8192
    ds_read_b64_tr_b16 v[130:131], v163 offset:10240
    v_mfma_f32_16x16x32_bf16 v[68:71], v[96:99], v[148:151], v[68:71]
    ds_read_b64_tr_b16 v[132:133], v164 offset:8192
    ds_read_b64_tr_b16 v[134:135], v164 offset:10240
    v_mfma_f32_16x16x32_bf16 v[44:47], v[100:103], v[144:147], v[44:47]
    ds_read_b64_tr_b16 v[136:137], v165 offset:8192
    ds_read_b64_tr_b16 v[138:139], v165 offset:10240
    v_mfma_f32_16x16x32_bf16 v[72:75], v[100:103], v[148:151], v[72:75]
    ds_read_b64_tr_b16 v[140:141], v166 offset:8192
    ds_read_b64_tr_b16 v[142:143], v166 offset:10240
    v_mfma_f32_16x16x32_bf16 v[48:51], v[104:107], v[144:147], v[48:51]
    v_mfma_f32_16x16x32_bf16 v[76:79], v[104:107], v[148:151], v[76:79]
    v_mfma_f32_16x16x32_bf16 v[52:55], v[108:111], v[144:147], v[52:55]
    v_mfma_f32_16x16x32_bf16 v[80:83], v[108:111], v[148:151], v[80:83]
    v_mfma_f32_16x16x32_bf16 v[56:59], v[112:115], v[144:147], v[56:59]
    v_mfma_f32_16x16x32_bf16 v[84:87], v[112:115], v[148:151], v[84:87]
    s_barrier
    s_waitcnt lgkmcnt(0)
    v_mfma_f32_16x16x32_bf16 v[32:35], v[116:119], v[152:155], v[32:35]
    ds_read_b128 v[144:147], v26 offset:32768
    ds_read_b128 v[148:151], v26 offset:34816
    v_mfma_f32_16x16x32_bf16 v[60:63], v[116:119], v[156:159], v[60:63]
    ds_read_b64_tr_b16 v[88:89], v160 offset:32768
    ds_read_b64_tr_b16 v[90:91], v160 offset:34816
    v_mfma_f32_16x16x32_bf16 v[36:39], v[120:123], v[152:155], v[36:39]
    ds_read_b64_tr_b16 v[92:93], v161 offset:32768
    ds_read_b64_tr_b16 v[94:95], v161 offset:34816
    v_mfma_f32_16x16x32_bf16 v[64:67], v[120:123], v[156:159], v[64:67]
    ds_read_b64_tr_b16 v[96:97], v162 offset:32768
    ds_read_b64_tr_b16 v[98:99], v162 offset:34816
    v_mfma_f32_16x16x32_bf16 v[40:43], v[124:127], v[152:155], v[40:43]
    ds_read_b64_tr_b16 v[100:101], v163 offset:32768
    ds_read_b64_tr_b16 v[102:103], v163 offset:34816
    v_mfma_f32_16x16x32_bf16 v[68:71], v[124:127], v[156:159], v[68:71]
    ds_read_b64_tr_b16 v[104:105], v164 offset:32768
    ds_read_b64_tr_b16 v[106:107], v164 offset:34816
    v_mfma_f32_16x16x32_bf16 v[44:47], v[128:131], v[152:155], v[44:47]
    ds_read_b64_tr_b16 v[108:109], v165 offset:32768
    ds_read_b64_tr_b16 v[110:111], v165 offset:34816
    v_mfma_f32_16x16x32_bf16 v[72:75], v[128:131], v[156:159], v[72:75]
    ds_read_b64_tr_b16 v[112:113], v166 offset:32768
    ds_read_b64_tr_b16 v[114:115], v166 offset:34816
    v_mfma_f32_16x16x32_bf16 v[48:51], v[132:135], v[152:155], v[48:51]
    v_mfma_f32_16x16x32_bf16 v[76:79], v[132:135], v[156:159], v[76:79]
    v_mfma_f32_16x16x32_bf16 v[52:55], v[136:139], v[152:155], v[52:55]
    v_mfma_f32_16x16x32_bf16 v[80:83], v[136:139], v[156:159], v[80:83]
    v_mfma_f32_16x16x32_bf16 v[56:59], v[140:143], v[152:155], v[56:59]
    v_mfma_f32_16x16x32_bf16 v[84:87], v[140:143], v[156:159], v[84:87]
    s_waitcnt lgkmcnt(0)
    ds_write_b64 v19, v[28:29] offset:1544
    ds_write_b64 v19, v[28:29] offset:5640
    v_mfma_f32_16x16x32_bf16 v[32:35], v[88:91], v[144:147], v[32:35]
    ds_read_b128 v[152:155], v27 offset:32768
    ds_read_b128 v[156:159], v27 offset:34816
    v_mfma_f32_16x16x32_bf16 v[60:63], v[88:91], v[148:151], v[60:63]
    ds_read_b64_tr_b16 v[116:117], v160 offset:40960
    ds_read_b64_tr_b16 v[118:119], v160 offset:43008
    v_mfma_f32_16x16x32_bf16 v[36:39], v[92:95], v[144:147], v[36:39]
    ds_read_b64_tr_b16 v[120:121], v161 offset:40960
    ds_read_b64_tr_b16 v[122:123], v161 offset:43008
    v_mfma_f32_16x16x32_bf16 v[64:67], v[92:95], v[148:151], v[64:67]
    ds_read_b64_tr_b16 v[124:125], v162 offset:40960
    ds_read_b64_tr_b16 v[126:127], v162 offset:43008
    v_mfma_f32_16x16x32_bf16 v[40:43], v[96:99], v[144:147], v[40:43]
    ds_read_b64_tr_b16 v[128:129], v163 offset:40960
    ds_read_b64_tr_b16 v[130:131], v163 offset:43008
    v_mfma_f32_16x16x32_bf16 v[68:71], v[96:99], v[148:151], v[68:71]
    ds_read_b64_tr_b16 v[132:133], v164 offset:40960
    ds_read_b64_tr_b16 v[134:135], v164 offset:43008
    v_mfma_f32_16x16x32_bf16 v[44:47], v[100:103], v[144:147], v[44:47]
    ds_read_b64_tr_b16 v[136:137], v165 offset:40960
    ds_read_b64_tr_b16 v[138:139], v165 offset:43008
    v_mfma_f32_16x16x32_bf16 v[72:75], v[100:103], v[148:151], v[72:75]
    ds_read_b64_tr_b16 v[140:141], v166 offset:40960
    ds_read_b64_tr_b16 v[142:143], v166 offset:43008
    v_mfma_f32_16x16x32_bf16 v[48:51], v[104:107], v[144:147], v[48:51]
    v_mfma_f32_16x16x32_bf16 v[76:79], v[104:107], v[148:151], v[76:79]
    v_mfma_f32_16x16x32_bf16 v[52:55], v[108:111], v[144:147], v[52:55]
    v_mfma_f32_16x16x32_bf16 v[80:83], v[108:111], v[148:151], v[80:83]
    v_mfma_f32_16x16x32_bf16 v[56:59], v[112:115], v[144:147], v[56:59]
    v_mfma_f32_16x16x32_bf16 v[84:87], v[112:115], v[148:151], v[84:87]
    s_waitcnt lgkmcnt(0)
    v_mfma_f32_16x16x32_bf16 v[32:35], v[116:119], v[152:155], v[32:35]
    v_mfma_f32_16x16x32_bf16 v[60:63], v[116:119], v[156:159], v[60:63]
    v_mfma_f32_16x16x32_bf16 v[36:39], v[120:123], v[152:155], v[36:39]
    v_mfma_f32_16x16x32_bf16 v[64:67], v[120:123], v[156:159], v[64:67]
    v_mfma_f32_16x16x32_bf16 v[40:43], v[124:127], v[152:155], v[40:43]
    v_mfma_f32_16x16x32_bf16 v[68:71], v[124:127], v[156:159], v[68:71]
    s_nop 3
    v_pk_mul_f32 v[32:33], s[64:65], v[32:33]
    v_pk_mul_f32 v[34:35], s[64:65], v[34:35]
    v_cvt_pk_bf16_f32 v32, v32, v33
    v_cvt_pk_bf16_f32 v33, v34, v35
    ds_write_b64 v12, v[32:33] offset:0
    v_pk_mul_f32 v[60:61], s[64:65], v[60:61]
    v_pk_mul_f32 v[62:63], s[64:65], v[62:63]
    v_cvt_pk_bf16_f32 v60, v60, v61
    v_cvt_pk_bf16_f32 v61, v62, v63
    ds_write_b64 v12, v[60:61] offset:128
    v_mfma_f32_16x16x32_bf16 v[44:47], v[128:131], v[152:155], v[44:47]
    v_mfma_f32_16x16x32_bf16 v[72:75], v[128:131], v[156:159], v[72:75]
    v_pk_mul_f32 v[36:37], s[64:65], v[36:37]
    v_pk_mul_f32 v[38:39], s[64:65], v[38:39]
    v_cvt_pk_bf16_f32 v36, v36, v37
    v_cvt_pk_bf16_f32 v37, v38, v39
    ds_write_b64 v13, v[36:37] offset:0
    v_pk_mul_f32 v[64:65], s[64:65], v[64:65]
    v_pk_mul_f32 v[66:67], s[64:65], v[66:67]
    v_cvt_pk_bf16_f32 v64, v64, v65
    v_cvt_pk_bf16_f32 v65, v66, v67
    ds_write_b64 v13, v[64:65] offset:128
    ds_read_b128 v[88:91], v21 offset:0
    ds_read_b128 v[92:95], v21 offset:1024
    v_mfma_f32_16x16x32_bf16 v[48:51], v[132:135], v[152:155], v[48:51]
    v_mfma_f32_16x16x32_bf16 v[76:79], v[132:135], v[156:159], v[76:79]
    v_pk_mul_f32 v[40:41], s[64:65], v[40:41]
    v_pk_mul_f32 v[42:43], s[64:65], v[42:43]
    v_cvt_pk_bf16_f32 v40, v40, v41
    v_cvt_pk_bf16_f32 v41, v42, v43
    ds_write_b64 v14, v[40:41] offset:0
    v_pk_mul_f32 v[68:69], s[64:65], v[68:69]
    v_pk_mul_f32 v[70:71], s[64:65], v[70:71]
    v_cvt_pk_bf16_f32 v68, v68, v69
    v_cvt_pk_bf16_f32 v69, v70, v71
    ds_write_b64 v14, v[68:69] offset:128
    v_mfma_f32_16x16x32_bf16 v[52:55], v[136:139], v[152:155], v[52:55]
    v_mfma_f32_16x16x32_bf16 v[80:83], v[136:139], v[156:159], v[80:83]
    v_pk_mul_f32 v[44:45], s[64:65], v[44:45]
    v_pk_mul_f32 v[46:47], s[64:65], v[46:47]
    v_cvt_pk_bf16_f32 v44, v44, v45
    v_cvt_pk_bf16_f32 v45, v46, v47
    ds_write_b64 v15, v[44:45] offset:0
    v_pk_mul_f32 v[72:73], s[64:65], v[72:73]
    v_pk_mul_f32 v[74:75], s[64:65], v[74:75]
    v_cvt_pk_bf16_f32 v72, v72, v73
    v_cvt_pk_bf16_f32 v73, v74, v75
    ds_write_b64 v15, v[72:73] offset:128
    s_waitcnt lgkmcnt(4)
    buffer_store_dwordx4 v[88:91], v20, s[32:35], s48 offen offset:0 sc1
    buffer_store_dwordx4 v[92:95], v20, s[32:35], s48 offen offset:1024 sc1
    s_add_u32 s48, s48, s49
    ds_read_b128 v[96:99], v21 offset:2048
    ds_read_b128 v[100:103], v21 offset:3072
    v_mfma_f32_16x16x32_bf16 v[56:59], v[140:143], v[152:155], v[56:59]
    v_mfma_f32_16x16x32_bf16 v[84:87], v[140:143], v[156:159], v[84:87]
    v_pk_mul_f32 v[48:49], s[64:65], v[48:49]
    v_pk_mul_f32 v[50:51], s[64:65], v[50:51]
    v_cvt_pk_bf16_f32 v48, v48, v49
    v_cvt_pk_bf16_f32 v49, v50, v51
    ds_write_b64 v16, v[48:49] offset:0
    v_pk_mul_f32 v[76:77], s[64:65], v[76:77]
    v_pk_mul_f32 v[78:79], s[64:65], v[78:79]
    v_cvt_pk_bf16_f32 v76, v76, v77
    v_cvt_pk_bf16_f32 v77, v78, v79
    ds_write_b64 v16, v[76:77] offset:128
    v_pk_mul_f32 v[52:53], s[64:65], v[52:53]
    v_pk_mul_f32 v[54:55], s[64:65], v[54:55]
    v_cvt_pk_bf16_f32 v52, v52, v53
    v_cvt_pk_bf16_f32 v53, v54, v55
    ds_write_b64 v17, v[52:53] offset:0
    v_pk_mul_f32 v[80:81], s[64:65], v[80:81]
    v_pk_mul_f32 v[82:83], s[64:65], v[82:83]
    v_cvt_pk_bf16_f32 v80, v80, v81
    v_cvt_pk_bf16_f32 v81, v82, v83
    ds_write_b64 v17, v[80:81] offset:128
    s_waitcnt lgkmcnt(4)
    buffer_store_dwordx4 v[96:99], v20, s[32:35], s48 offen offset:0 sc1
    buffer_store_dwordx4 v[100:103], v20, s[32:35], s48 offen offset:1024 sc1
    s_add_u32 s48, s48, s49
    ds_read_b128 v[104:107], v21 offset:4096
    ds_read_b128 v[108:111], v21 offset:5120
    v_pk_mul_f32 v[56:57], s[64:65], v[56:57]
    v_pk_mul_f32 v[58:59], s[64:65], v[58:59]
    v_cvt_pk_bf16_f32 v56, v56, v57
    v_cvt_pk_bf16_f32 v57, v58, v59
    ds_write_b64 v18, v[56:57] offset:0
    v_pk_mul_f32 v[84:85], s[64:65], v[84:85]
    v_pk_mul_f32 v[86:87], s[64:65], v[86:87]
    v_cvt_pk_bf16_f32 v84, v84, v85
    v_cvt_pk_bf16_f32 v85, v86, v87
    ds_write_b64 v18, v[84:85] offset:128
    s_waitcnt lgkmcnt(2)
    buffer_store_dwordx4 v[104:107], v20, s[32:35], s48 offen offset:0 sc1
    buffer_store_dwordx4 v[108:111], v20, s[32:35], s48 offen offset:1024 sc1
    s_add_u32 s48, s48, s49
    ds_read_b128 v[88:91], v21 offset:6144
    ds_read_b128 v[92:95], v21 offset:7168
    s_waitcnt lgkmcnt(1)
    buffer_store_dwordx4 v[88:91], v20, s[32:35], s48 offen offset:0 sc1
    s_waitcnt lgkmcnt(0)
    buffer_store_dwordx4 v[92:95], v20, s[32:35], s48 offen offset:1024 sc1
    s_branch L1_side
L1_vf:
    s_cmp_eq_u32 s20, 3
    s_cbranch_scc1 L1_fpre
    s_lshl_b32 s48, s21, 2
    s_add_u32 s48, s48, s23
    s_lshl_b32 s48, s48, 12
    s_lshl_b32 s49, s22, 20
    s_add_u32 s48, s48, s49
    s_add_u32 s48, s48, 2099200
    v_lshlrev_b32 v4, 18, v3
    v_bfe_u32 v5, v1, 2, 2
    v_lshl_add_u32 v4, v5, 9, v4
    v_and_b32 v5, 3, v1
    v_lshl_add_u32 v4, v5, 4, v4
    v_cmp_eq_u32 vcc, 0, v5
    v_mov_b32 v6, 0x3f803f80
    s_nop 0
    v_cndmask_b32 v28, 0, v6, vcc
    v_cndmask_b32 v29, 0, v6, vcc
    v_cndmask_b32 v30, 0, v6, vcc
    v_cndmask_b32 v31, 0, v6, vcc
    buffer_store_dwordx4 v[28:31], v4, s[32:35], s48 offen offset:448 sc1
    v_lshlrev_b32 v9, 9, v3
    v_add_u32 v6, 0, v2
    v_mul_u32_u24 v7, 147, v6
    v_lshrrev_b32 v7, 12, v7
    v_mul_u32_u24 v8, 28, v7
    v_sub_u32 v6, v6, v8
    v_lshl_add_u32 v7, v7, 18, v9
    v_lshl_add_u32 v12, v6, 4, v7
    v_add_u32 v6, 16, v2
    v_mul_u32_u24 v7, 147, v6
    v_lshrrev_b32 v7, 12, v7
    v_mul_u32_u24 v8, 28, v7
    v_sub_u32 v6, v6, v8
    v_lshl_add_u32 v7, v7, 18, v9
    v_lshl_add_u32 v13, v6, 4, v7
    v_add_u32 v6, 32, v2
    v_mul_u32_u24 v7, 147, v6
    v_lshrrev_b32 v7, 12, v7
    v_mul_u32_u24 v8, 28, v7
    v_sub_u32 v6, v6, v8
    v_lshl_add_u32 v7, v7, 18, v9
    v_lshl_add_u32 v14, v6, 4, v7
    v_add_u32 v6, 48, v2
    v_mul_u32_u24 v7, 147, v6
    v_lshrrev_b32 v7, 12, v7
    v_mul_u32_u24 v8, 28, v7
    v_sub_u32 v6, v6, v8
    v_lshl_add_u32 v7, v7, 18, v9
    v_lshl_add_u32 v15, v6, 4, v7
    v_add_u32 v6, 64, v2
    v_mul_u32_u24 v7, 147, v6
    v_lshrrev_b32 v7, 12, v7
    v_mul_u32_u24 v8, 28, v7
    v_sub_u32 v6, v6, v8
    v_lshl_add_u32 v7, v7, 18, v9
    v_lshl_add_u32 v16, v6, 4, v7
    v_add_u32 v6, 80, v2
    v_mul_u32_u24 v7, 147, v6
    v_lshrrev_b32 v7, 12, v7
    v_mul_u32_u24 v8, 28, v7
    v_sub_u32 v6, v6, v8
    v_lshl_add_u32 v7, v7, 18, v9
    v_lshl_add_u32 v17, v6, 4, v7
    v_add_u32 v6, 96, v2
    v_mul_u32_u24 v7, 147, v6
    v_lshrrev_b32 v7, 12, v7
    v_mul_u32_u24 v8, 28, v7
    v_sub_u32 v6, v6, v8
    v_lshl_add_u32 v7, v7, 18, v9
    v_lshl_add_u32 v18, v6, 4, v7
    v_mov_b32 v19, 0
    v_mov_b32 v20, 0
    s_branch L1_vfmain
L1_fpre:
    v_mul_u32_u24 v4, 144, v2
    v_lshl_add_u32 v4, v3, 3, v4
    s_lshl_b32 s48, s23, 5
    s_add_u32 s48, s48, 65536
    v_add_u32 v19, s48, v4
    v_lshrrev_b32 v5, 3, v1
    s_lshl_b32 s48, s23, 3
    v_add_u32 v5, s48, v5
    v_and_b32 v6, 7, v1
    v_mul_u32_u24 v7, 144, v5
    v_lshl_add_u32 v7, v6, 4, v7
    v_add_u32 v20, 65536, v7
    s_mul_i32 s48, s22, 229376
    s_and_b32 s49, s21, 3
    s_lshl_b32 s49, s49, 9
    s_add_u32 s48, s48, s49
    s_lshr_b32 s49, s21, 2
    s_lshl_b32 s49, s49, 7
    s_add_u32 s48, s48, s49
    s_add_u32 s48, s48, 6291456
    v_lshlrev_b32 v6, 4, v6
    v_add_u32 v8, 0, v5
    v_add_u32 v9, 336, v8
    v_cmp_le_u32 vcc, 112, v8
    s_nop 1
    v_cndmask_b32 v8, v8, v9, vcc
    v_lshl_add_u32 v12, v8, 11, v6
    v_add_u32 v8, 32, v5
    v_add_u32 v9, 336, v8
    v_cmp_le_u32 vcc, 112, v8
    s_nop 1
    v_cndmask_b32 v8, v8, v9, vcc
    v_lshl_add_u32 v13, v8, 11, v6
    v_add_u32 v8, 64, v5
    v_add_u32 v9, 336, v8
    v_cmp_le_u32 vcc, 112, v8
    s_nop 1
    v_cndmask_b32 v8, v8, v9, vcc
    v_lshl_add_u32 v14, v8, 11, v6
    v_add_u32 v8, 96, v5
    v_add_u32 v9, 336, v8
    v_cmp_le_u32 vcc, 112, v8
    s_nop 1
    v_cndmask_b32 v8, v8, v9, vcc
    v_lshl_add_u32 v15, v8, 11, v6
    v_add_u32 v8, 128, v5
    v_add_u32 v9, 336, v8
    v_cmp_le_u32 vcc, 112, v8
    s_nop 1
    v_cndmask_b32 v8, v8, v9, vcc
    v_lshl_add_u32 v16, v8, 11, v6
    v_add_u32 v8, 160, v5
    v_add_u32 v9, 336, v8
    v_cmp_le_u32 vcc, 112, v8
    s_nop 1
    v_cndmask_b32 v8, v8, v9, vcc
    v_lshl_add_u32 v17, v8, 11, v6
    v_add_u32 v8, 192, v5
    v_add_u32 v9, 336, v8
    v_cmp_le_u32 vcc, 112, v8
    s_nop 1
    v_cndmask_b32 v8, v8, v9, vcc
    v_lshl_add_u32 v18, v8, 11, v6
L1_vfmain:
    s_barrier
    ds_read_b128 v[144:147], v26 offset:0
    ds_read_b128 v[148:151], v26 offset:2048
    ds_read_b64_tr_b16 v[88:89], v160 offset:0
    ds_read_b64_tr_b16 v[90:91], v160 offset:2048
    ds_read_b64_tr_b16 v[92:93], v161 offset:0
    ds_read_b64_tr_b16 v[94:95], v161 offset:2048
    ds_read_b64_tr_b16 v[96:97], v162 offset:0
    ds_read_b64_tr_b16 v[98:99], v162 offset:2048
    ds_read_b64_tr_b16 v[100:101], v163 offset:0
    ds_read_b64_tr_b16 v[102:103], v163 offset:2048
    ds_read_b64_tr_b16 v[104:105], v164 offset:0
    ds_read_b64_tr_b16 v[106:107], v164 offset:2048
    ds_read_b64_tr_b16 v[108:109], v165 offset:0
    ds_read_b64_tr_b16 v[110:111], v165 offset:2048
    ds_read_b64_tr_b16 v[112:113], v166 offset:0
    ds_read_b64_tr_b16 v[114:115], v166 offset:2048
    s_waitcnt lgkmcnt(0)
    v_mfma_f32_16x16x32_bf16 v[32:35], v[144:147], v[88:91], v[32:35]
    ds_read_b128 v[152:155], v27 offset:0
    ds_read_b128 v[156:159], v27 offset:2048
    v_mfma_f32_16x16x32_bf16 v[60:63], v[148:151], v[88:91], v[60:63]
    ds_read_b64_tr_b16 v[116:117], v160 offset:8192
    ds_read_b64_tr_b16 v[118:119], v160 offset:10240
    v_mfma_f32_16x16x32_bf16 v[36:39], v[144:147], v[92:95], v[36:39]
    ds_read_b64_tr_b16 v[120:121], v161 offset:8192
    ds_read_b64_tr_b16 v[122:123], v161 offset:10240
    v_mfma_f32_16x16x32_bf16 v[64:67], v[148:151], v[92:95], v[64:67]
    ds_read_b64_tr_b16 v[124:125], v162 offset:8192
    ds_read_b64_tr_b16 v[126:127], v162 offset:10240
    v_mfma_f32_16x16x32_bf16 v[40:43], v[144:147], v[96:99], v[40:43]
    ds_read_b64_tr_b16 v[128:129], v163 offset:8192
    ds_read_b64_tr_b16 v[130:131], v163 offset:10240
    v_mfma_f32_16x16x32_bf16 v[68:71], v[148:151], v[96:99], v[68:71]
    ds_read_b64_tr_b16 v[132:133], v164 offset:8192
    ds_read_b64_tr_b16 v[134:135], v164 offset:10240
    v_mfma_f32_16x16x32_bf16 v[44:47], v[144:147], v[100:103], v[44:47]
    ds_read_b64_tr_b16 v[136:137], v165 offset:8192
    ds_read_b64_tr_b16 v[138:139], v165 offset:10240
    v_mfma_f32_16x16x32_bf16 v[72:75], v[148:151], v[100:103], v[72:75]
    ds_read_b64_tr_b16 v[140:141], v166 offset:8192
    ds_read_b64_tr_b16 v[142:143], v166 offset:10240
    v_mfma_f32_16x16x32_bf16 v[48:51], v[144:147], v[104:107], v[48:51]
    v_mfma_f32_16x16x32_bf16 v[76:79], v[148:151], v[104:107], v[76:79]
    v_mfma_f32_16x16x32_bf16 v[52:55], v[144:147], v[108:111], v[52:55]
    v_mfma_f32_16x16x32_bf16 v[80:83], v[148:151], v[108:111], v[80:83]
    v_mfma_f32_16x16x32_bf16 v[56:59], v[144:147], v[112:115], v[56:59]
    v_mfma_f32_16x16x32_bf16 v[84:87], v[148:151], v[112:115], v[84:87]
    s_barrier
    s_waitcnt lgkmcnt(0)
    v_mfma_f32_16x16x32_bf16 v[32:35], v[152:155], v[116:119], v[32:35]
    ds_read_b128 v[144:147], v26 offset:32768
    ds_read_b128 v[148:151], v26 offset:34816
    v_mfma_f32_16x16x32_bf16 v[60:63], v[156:159], v[116:119], v[60:63]
    ds_read_b64_tr_b16 v[88:89], v160 offset:32768
    ds_read_b64_tr_b16 v[90:91], v160 offset:34816
    v_mfma_f32_16x16x32_bf16 v[36:39], v[152:155], v[120:123], v[36:39]
    ds_read_b64_tr_b16 v[92:93], v161 offset:32768
    ds_read_b64_tr_b16 v[94:95], v161 offset:34816
    v_mfma_f32_16x16x32_bf16 v[64:67], v[156:159], v[120:123], v[64:67]
    ds_read_b64_tr_b16 v[96:97], v162 offset:32768
    ds_read_b64_tr_b16 v[98:99], v162 offset:34816
    v_mfma_f32_16x16x32_bf16 v[40:43], v[152:155], v[124:127], v[40:43]
    ds_read_b64_tr_b16 v[100:101], v163 offset:32768
    ds_read_b64_tr_b16 v[102:103], v163 offset:34816
    v_mfma_f32_16x16x32_bf16 v[68:71], v[156:159], v[124:127], v[68:71]
    ds_read_b64_tr_b16 v[104:105], v164 offset:32768
    ds_read_b64_tr_b16 v[106:107], v164 offset:34816
    v_mfma_f32_16x16x32_bf16 v[44:47], v[152:155], v[128:131], v[44:47]
    ds_read_b64_tr_b16 v[108:109], v165 offset:32768
    ds_read_b64_tr_b16 v[110:111], v165 offset:34816
    v_mfma_f32_16x16x32_bf16 v[72:75], v[156:159], v[128:131], v[72:75]
    ds_read_b64_tr_b16 v[112:113], v166 offset:32768
    ds_read_b64_tr_b16 v[114:115], v166 offset:34816
    v_mfma_f32_16x16x32_bf16 v[48:51], v[152:155], v[132:135], v[48:51]
    v_mfma_f32_16x16x32_bf16 v[76:79], v[156:159], v[132:135], v[76:79]
    v_mfma_f32_16x16x32_bf16 v[52:55], v[152:155], v[136:139], v[52:55]
    v_mfma_f32_16x16x32_bf16 v[80:83], v[156:159], v[136:139], v[80:83]
    v_mfma_f32_16x16x32_bf16 v[56:59], v[152:155], v[140:143], v[56:59]
    v_mfma_f32_16x16x32_bf16 v[84:87], v[156:159], v[140:143], v[84:87]
    s_waitcnt lgkmcnt(0)
    v_mfma_f32_16x16x32_bf16 v[32:35], v[144:147], v[88:91], v[32:35]
    ds_read_b128 v[152:155], v27 offset:32768
    ds_read_b128 v[156:159], v27 offset:34816
    v_mfma_f32_16x16x32_bf16 v[60:63], v[148:151], v[88:91], v[60:63]
    ds_read_b64_tr_b16 v[116:117], v160 offset:40960
    ds_read_b64_tr_b16 v[118:119], v160 offset:43008
    v_mfma_f32_16x16x32_bf16 v[36:39], v[144:147], v[92:95], v[36:39]
    ds_read_b64_tr_b16 v[120:121], v161 offset:40960
    ds_read_b64_tr_b16 v[122:123], v161 offset:43008
    v_mfma_f32_16x16x32_bf16 v[64:67], v[148:151], v[92:95], v[64:67]
    ds_read_b64_tr_b16 v[124:125], v162 offset:40960
    ds_read_b64_tr_b16 v[126:127], v162 offset:43008
    v_mfma_f32_16x16x32_bf16 v[40:43], v[144:147], v[96:99], v[40:43]
    ds_read_b64_tr_b16 v[128:129], v163 offset:40960
    ds_read_b64_tr_b16 v[130:131], v163 offset:43008
    v_mfma_f32_16x16x32_bf16 v[68:71], v[148:151], v[96:99], v[68:71]
    ds_read_b64_tr_b16 v[132:133], v164 offset:40960
    ds_read_b64_tr_b16 v[134:135], v164 offset:43008
    v_mfma_f32_16x16x32_bf16 v[44:47], v[144:147], v[100:103], v[44:47]
    ds_read_b64_tr_b16 v[136:137], v165 offset:40960
    ds_read_b64_tr_b16 v[138:139], v165 offset:43008
    v_mfma_f32_16x16x32_bf16 v[72:75], v[148:151], v[100:103], v[72:75]
    ds_read_b64_tr_b16 v[140:141], v166 offset:40960
    ds_read_b64_tr_b16 v[142:143], v166 offset:43008
    v_mfma_f32_16x16x32_bf16 v[48:51], v[144:147], v[104:107], v[48:51]
    v_mfma_f32_16x16x32_bf16 v[76:79], v[148:151], v[104:107], v[76:79]
    v_mfma_f32_16x16x32_bf16 v[52:55], v[144:147], v[108:111], v[52:55]
    v_mfma_f32_16x16x32_bf16 v[80:83], v[148:151], v[108:111], v[80:83]
    v_mfma_f32_16x16x32_bf16 v[56:59], v[144:147], v[112:115], v[56:59]
    v_mfma_f32_16x16x32_bf16 v[84:87], v[148:151], v[112:115], v[84:87]
    s_barrier
    v_add_u32 v160, 0x10000, v160
    v_add_u32 v161, 0x10000, v161
    v_add_u32 v162, 0x10000, v162
    v_add_u32 v163, 0x10000, v163
    v_add_u32 v164, 0x10000, v164
    v_add_u32 v165, 0x10000, v165
    v_add_u32 v166, 0x10000, v166
    v_add_u32 v26, 0x10000, v26
    v_add_u32 v27, 0x10000, v27
    s_waitcnt lgkmcnt(0)
    v_mfma_f32_16x16x32_bf16 v[32:35], v[152:155], v[116:119], v[32:35]
    ds_read_b128 v[144:147], v26 offset:0
    ds_read_b128 v[148:151], v26 offset:2048
    v_mfma_f32_16x16x32_bf16 v[60:63], v[156:159], v[116:119], v[60:63]
    ds_read_b64_tr_b16 v[88:89], v160 offset:0
    ds_read_b64_tr_b16 v[90:91], v160 offset:2048
    v_mfma_f32_16x16x32_bf16 v[36:39], v[152:155], v[120:123], v[36:39]
    ds_read_b64_tr_b16 v[92:93], v161 offset:0
    ds_read_b64_tr_b16 v[94:95], v161 offset:2048
    v_mfma_f32_16x16x32_bf16 v[64:67], v[156:159], v[120:123], v[64:67]
    ds_read_b64_tr_b16 v[96:97], v162 offset:0
    ds_read_b64_tr_b16 v[98:99], v162 offset:2048
    v_mfma_f32_16x16x32_bf16 v[40:43], v[152:155], v[124:127], v[40:43]
    ds_read_b64_tr_b16 v[100:101], v163 offset:0
    ds_read_b64_tr_b16 v[102:103], v163 offset:2048
    v_mfma_f32_16x16x32_bf16 v[68:71], v[156:159], v[124:127], v[68:71]
    ds_read_b64_tr_b16 v[104:105], v164 offset:0
    ds_read_b64_tr_b16 v[106:107], v164 offset:2048
    v_mfma_f32_16x16x32_bf16 v[44:47], v[152:155], v[128:131], v[44:47]
    ds_read_b64_tr_b16 v[108:109], v165 offset:0
    ds_read_b64_tr_b16 v[110:111], v165 offset:2048
    v_mfma_f32_16x16x32_bf16 v[72:75], v[156:159], v[128:131], v[72:75]
    ds_read_b64_tr_b16 v[112:113], v166 offset:0
    ds_read_b64_tr_b16 v[114:115], v166 offset:2048
    v_mfma_f32_16x16x32_bf16 v[48:51], v[152:155], v[132:135], v[48:51]
    v_mfma_f32_16x16x32_bf16 v[76:79], v[156:159], v[132:135], v[76:79]
    v_mfma_f32_16x16x32_bf16 v[52:55], v[152:155], v[136:139], v[52:55]
    v_mfma_f32_16x16x32_bf16 v[80:83], v[156:159], v[136:139], v[80:83]
    v_mfma_f32_16x16x32_bf16 v[56:59], v[152:155], v[140:143], v[56:59]
    v_mfma_f32_16x16x32_bf16 v[84:87], v[156:159], v[140:143], v[84:87]
    s_waitcnt lgkmcnt(0)
    v_mfma_f32_16x16x32_bf16 v[32:35], v[144:147], v[88:91], v[32:35]
    ds_read_b128 v[152:155], v27 offset:0
    ds_read_b128 v[156:159], v27 offset:2048
    v_mfma_f32_16x16x32_bf16 v[60:63], v[148:151], v[88:91], v[60:63]
    ds_read_b64_tr_b16 v[116:117], v160 offset:8192
    ds_read_b64_tr_b16 v[118:119], v160 offset:10240
    v_mfma_f32_16x16x32_bf16 v[36:39], v[144:147], v[92:95], v[36:39]
    ds_read_b64_tr_b16 v[120:121], v161 offset:8192
    ds_read_b64_tr_b16 v[122:123], v161 offset:10240
    v_mfma_f32_16x16x32_bf16 v[64:67], v[148:151], v[92:95], v[64:67]
    ds_read_b64_tr_b16 v[124:125], v162 offset:8192
    ds_read_b64_tr_b16 v[126:127], v162 offset:10240
    v_mfma_f32_16x16x32_bf16 v[40:43], v[144:147], v[96:99], v[40:43]
    ds_read_b64_tr_b16 v[128:129], v163 offset:8192
    ds_read_b64_tr_b16 v[130:131], v163 offset:10240
    v_mfma_f32_16x16x32_bf16 v[68:71], v[148:151], v[96:99], v[68:71]
    ds_read_b64_tr_b16 v[132:133], v164 offset:8192
    ds_read_b64_tr_b16 v[134:135], v164 offset:10240
    v_mfma_f32_16x16x32_bf16 v[44:47], v[144:147], v[100:103], v[44:47]
    ds_read_b64_tr_b16 v[136:137], v165 offset:8192
    ds_read_b64_tr_b16 v[138:139], v165 offset:10240
    v_mfma_f32_16x16x32_bf16 v[72:75], v[148:151], v[100:103], v[72:75]
    ds_read_b64_tr_b16 v[140:141], v166 offset:8192
    ds_read_b64_tr_b16 v[142:143], v166 offset:10240
    v_mfma_f32_16x16x32_bf16 v[48:51], v[144:147], v[104:107], v[48:51]
    v_mfma_f32_16x16x32_bf16 v[76:79], v[148:151], v[104:107], v[76:79]
    v_mfma_f32_16x16x32_bf16 v[52:55], v[144:147], v[108:111], v[52:55]
    v_mfma_f32_16x16x32_bf16 v[80:83], v[148:151], v[108:111], v[80:83]
    v_mfma_f32_16x16x32_bf16 v[56:59], v[144:147], v[112:115], v[56:59]
    v_mfma_f32_16x16x32_bf16 v[84:87], v[148:151], v[112:115], v[84:87]
    s_barrier
    s_waitcnt lgkmcnt(0)
    v_mfma_f32_16x16x32_bf16 v[32:35], v[152:155], v[116:119], v[32:35]
    ds_read_b128 v[144:147], v26 offset:32768
    ds_read_b128 v[148:151], v26 offset:34816
    v_mfma_f32_16x16x32_bf16 v[60:63], v[156:159], v[116:119], v[60:63]
    ds_read_b64_tr_b16 v[88:89], v160 offset:32768
    ds_read_b64_tr_b16 v[90:91], v160 offset:34816
    v_mfma_f32_16x16x32_bf16 v[36:39], v[152:155], v[120:123], v[36:39]
    ds_read_b64_tr_b16 v[92:93], v161 offset:32768
    ds_read_b64_tr_b16 v[94:95], v161 offset:34816
    v_mfma_f32_16x16x32_bf16 v[64:67], v[156:159], v[120:123], v[64:67]
    ds_read_b64_tr_b16 v[96:97], v162 offset:32768
    ds_read_b64_tr_b16 v[98:99], v162 offset:34816
    v_mfma_f32_16x16x32_bf16 v[40:43], v[152:155], v[124:127], v[40:43]
    ds_read_b64_tr_b16 v[100:101], v163 offset:32768
    ds_read_b64_tr_b16 v[102:103], v163 offset:34816
    v_mfma_f32_16x16x32_bf16 v[68:71], v[156:159], v[124:127], v[68:71]
    ds_read_b64_tr_b16 v[104:105], v164 offset:32768
    ds_read_b64_tr_b16 v[106:107], v164 offset:34816
    v_mfma_f32_16x16x32_bf16 v[44:47], v[152:155], v[128:131], v[44:47]
    ds_read_b64_tr_b16 v[108:109], v165 offset:32768
    ds_read_b64_tr_b16 v[110:111], v165 offset:34816
    v_mfma_f32_16x16x32_bf16 v[72:75], v[156:159], v[128:131], v[72:75]
    ds_read_b64_tr_b16 v[112:113], v166 offset:32768
    ds_read_b64_tr_b16 v[114:115], v166 offset:34816
    v_mfma_f32_16x16x32_bf16 v[48:51], v[152:155], v[132:135], v[48:51]
    v_mfma_f32_16x16x32_bf16 v[76:79], v[156:159], v[132:135], v[76:79]
    v_mfma_f32_16x16x32_bf16 v[52:55], v[152:155], v[136:139], v[52:55]
    v_mfma_f32_16x16x32_bf16 v[80:83], v[156:159], v[136:139], v[80:83]
    v_mfma_f32_16x16x32_bf16 v[56:59], v[152:155], v[140:143], v[56:59]
    v_mfma_f32_16x16x32_bf16 v[84:87], v[156:159], v[140:143], v[84:87]
    s_waitcnt lgkmcnt(0)
    v_mfma_f32_16x16x32_bf16 v[32:35], v[144:147], v[88:91], v[32:35]
    ds_read_b128 v[152:155], v27 offset:32768
    ds_read_b128 v[156:159], v27 offset:34816
    v_mfma_f32_16x16x32_bf16 v[60:63], v[148:151], v[88:91], v[60:63]
    ds_read_b64_tr_b16 v[116:117], v160 offset:40960
    ds_read_b64_tr_b16 v[118:119], v160 offset:43008
    v_mfma_f32_16x16x32_bf16 v[36:39], v[144:147], v[92:95], v[36:39]
    ds_read_b64_tr_b16 v[120:121], v161 offset:40960
    ds_read_b64_tr_b16 v[122:123], v161 offset:43008
    v_mfma_f32_16x16x32_bf16 v[64:67], v[148:151], v[92:95], v[64:67]
    ds_read_b64_tr_b16 v[124:125], v162 offset:40960
    ds_read_b64_tr_b16 v[126:127], v162 offset:43008
    v_mfma_f32_16x16x32_bf16 v[40:43], v[144:147], v[96:99], v[40:43]
    ds_read_b64_tr_b16 v[128:129], v163 offset:40960
    ds_read_b64_tr_b16 v[130:131], v163 offset:43008
    v_mfma_f32_16x16x32_bf16 v[68:71], v[148:151], v[96:99], v[68:71]
    ds_read_b64_tr_b16 v[132:133], v164 offset:40960
    ds_read_b64_tr_b16 v[134:135], v164 offset:43008
    v_mfma_f32_16x16x32_bf16 v[44:47], v[144:147], v[100:103], v[44:47]
    ds_read_b64_tr_b16 v[136:137], v165 offset:40960
    ds_read_b64_tr_b16 v[138:139], v165 offset:43008
    v_mfma_f32_16x16x32_bf16 v[72:75], v[148:151], v[100:103], v[72:75]
    ds_read_b64_tr_b16 v[140:141], v166 offset:40960
    ds_read_b64_tr_b16 v[142:143], v166 offset:43008
    v_mfma_f32_16x16x32_bf16 v[48:51], v[144:147], v[104:107], v[48:51]
    v_mfma_f32_16x16x32_bf16 v[76:79], v[148:151], v[104:107], v[76:79]
    v_mfma_f32_16x16x32_bf16 v[52:55], v[144:147], v[108:111], v[52:55]
    v_mfma_f32_16x16x32_bf16 v[80:83], v[148:151], v[108:111], v[80:83]
    v_mfma_f32_16x16x32_bf16 v[56:59], v[144:147], v[112:115], v[56:59]
    v_mfma_f32_16x16x32_bf16 v[84:87], v[148:151], v[112:115], v[84:87]
    s_barrier
    v_add_u32 v160, 0x10000, v160
    v_add_u32 v161, 0x10000, v161
    v_add_u32 v162, 0x10000, v162
    v_add_u32 v163, 0x10000, v163
    v_add_u32 v164, 0x10000, v164
    v_add_u32 v165, 0x10000, v165
    v_add_u32 v166, 0x10000, v166
    v_add_u32 v26, 0x10000, v26
    v_add_u32 v27, 0x10000, v27
    s_waitcnt lgkmcnt(0)
    v_mfma_f32_16x16x32_bf16 v[32:35], v[152:155], v[116:119], v[32:35]
    ds_read_b128 v[144:147], v26 offset:0
    ds_read_b128 v[148:151], v26 offset:2048
    v_mfma_f32_16x16x32_bf16 v[60:63], v[156:159], v[116:119], v[60:63]
    ds_read_b64_tr_b16 v[88:89], v160 offset:0
    ds_read_b64_tr_b16 v[90:91], v160 offset:2048
    v_mfma_f32_16x16x32_bf16 v[36:39], v[152:155], v[120:123], v[36:39]
    ds_read_b64_tr_b16 v[92:93], v161 offset:0
    ds_read_b64_tr_b16 v[94:95], v161 offset:2048
    v_mfma_f32_16x16x32_bf16 v[64:67], v[156:159], v[120:123], v[64:67]
    ds_read_b64_tr_b16 v[96:97], v162 offset:0
    ds_read_b64_tr_b16 v[98:99], v162 offset:2048
    v_mfma_f32_16x16x32_bf16 v[40:43], v[152:155], v[124:127], v[40:43]
    ds_read_b64_tr_b16 v[100:101], v163 offset:0
    ds_read_b64_tr_b16 v[102:103], v163 offset:2048
    v_mfma_f32_16x16x32_bf16 v[68:71], v[156:159], v[124:127], v[68:71]
    ds_read_b64_tr_b16 v[104:105], v164 offset:0
    ds_read_b64_tr_b16 v[106:107], v164 offset:2048
    v_mfma_f32_16x16x32_bf16 v[44:47], v[152:155], v[128:131], v[44:47]
    ds_read_b64_tr_b16 v[108:109], v165 offset:0
    ds_read_b64_tr_b16 v[110:111], v165 offset:2048
    v_mfma_f32_16x16x32_bf16 v[72:75], v[156:159], v[128:131], v[72:75]
    ds_read_b64_tr_b16 v[112:113], v166 offset:0
    ds_read_b64_tr_b16 v[114:115], v166 offset:2048
    v_mfma_f32_16x16x32_bf16 v[48:51], v[152:155], v[132:135], v[48:51]
    v_mfma_f32_16x16x32_bf16 v[76:79], v[156:159], v[132:135], v[76:79]
    v_mfma_f32_16x16x32_bf16 v[52:55], v[152:155], v[136:139], v[52:55]
    v_mfma_f32_16x16x32_bf16 v[80:83], v[156:159], v[136:139], v[80:83]
    v_mfma_f32_16x16x32_bf16 v[56:59], v[152:155], v[140:143], v[56:59]
    v_mfma_f32_16x16x32_bf16 v[84:87], v[156:159], v[140:143], v[84:87]
    s_waitcnt lgkmcnt(0)
    v_mfma_f32_16x16x32_bf16 v[32:35], v[144:147], v[88:91], v[32:35]
    ds_read_b128 v[152:155], v27 offset:0
    ds_read_b128 v[156:159], v27 offset:2048
    v_mfma_f32_16x16x32_bf16 v[60:63], v[148:151], v[88:91], v[60:63]
    ds_read_b64_tr_b16 v[116:117], v160 offset:8192
    ds_read_b64_tr_b16 v[118:119], v160 offset:10240
    v_mfma_f32_16x16x32_bf16 v[36:39], v[144:147], v[92:95], v[36:39]
    ds_read_b64_tr_b16 v[120:121], v161 offset:8192
    ds_read_b64_tr_b16 v[122:123], v161 offset:10240
    v_mfma_f32_16x16x32_bf16 v[64:67], v[148:151], v[92:95], v[64:67]
    ds_read_b64_tr_b16 v[124:125], v162 offset:8192
    ds_read_b64_tr_b16 v[126:127], v162 offset:10240
    v_mfma_f32_16x16x32_bf16 v[40:43], v[144:147], v[96:99], v[40:43]
    ds_read_b64_tr_b16 v[128:129], v163 offset:8192
    ds_read_b64_tr_b16 v[130:131], v163 offset:10240
    v_mfma_f32_16x16x32_bf16 v[68:71], v[148:151], v[96:99], v[68:71]
    ds_read_b64_tr_b16 v[132:133], v164 offset:8192
    ds_read_b64_tr_b16 v[134:135], v164 offset:10240
    v_mfma_f32_16x16x32_bf16 v[44:47], v[144:147], v[100:103], v[44:47]
    ds_read_b64_tr_b16 v[136:137], v165 offset:8192
    ds_read_b64_tr_b16 v[138:139], v165 offset:10240
    v_mfma_f32_16x16x32_bf16 v[72:75], v[148:151], v[100:103], v[72:75]
    ds_read_b64_tr_b16 v[140:141], v166 offset:8192
    ds_read_b64_tr_b16 v[142:143], v166 offset:10240
    v_mfma_f32_16x16x32_bf16 v[48:51], v[144:147], v[104:107], v[48:51]
    v_mfma_f32_16x16x32_bf16 v[76:79], v[148:151], v[104:107], v[76:79]
    v_mfma_f32_16x16x32_bf16 v[52:55], v[144:147], v[108:111], v[52:55]
    v_mfma_f32_16x16x32_bf16 v[80:83], v[148:151], v[108:111], v[80:83]
    v_mfma_f32_16x16x32_bf16 v[56:59], v[144:147], v[112:115], v[56:59]
    v_mfma_f32_16x16x32_bf16 v[84:87], v[148:151], v[112:115], v[84:87]
    s_barrier
    v_add_u32 v160, 0xfffe0000, v160
    v_add_u32 v161, 0xfffe0000, v161
    v_add_u32 v162, 0xfffe0000, v162
    v_add_u32 v163, 0xfffe0000, v163
    v_add_u32 v164, 0xfffe0000, v164
    v_add_u32 v165, 0xfffe0000, v165
    v_add_u32 v166, 0xfffe0000, v166
    v_add_u32 v26, 0xfffe0000, v26
    v_add_u32 v27, 0xfffe0000, v27
    s_waitcnt lgkmcnt(0)
    v_mfma_f32_16x16x32_bf16 v[32:35], v[152:155], v[116:119], v[32:35]
    ds_read_b128 v[144:147], v26 offset:0
    ds_read_b128 v[148:151], v26 offset:2048
    v_mfma_f32_16x16x32_bf16 v[60:63], v[156:159], v[116:119], v[60:63]
    ds_read_b64_tr_b16 v[88:89], v160 offset:0
    ds_read_b64_tr_b16 v[90:91], v160 offset:2048
    v_mfma_f32_16x16x32_bf16 v[36:39], v[152:155], v[120:123], v[36:39]
    ds_read_b64_tr_b16 v[92:93], v161 offset:0
    ds_read_b64_tr_b16 v[94:95], v161 offset:2048
    v_mfma_f32_16x16x32_bf16 v[64:67], v[156:159], v[120:123], v[64:67]
    ds_read_b64_tr_b16 v[96:97], v162 offset:0
    ds_read_b64_tr_b16 v[98:99], v162 offset:2048
    v_mfma_f32_16x16x32_bf16 v[40:43], v[152:155], v[124:127], v[40:43]
    ds_read_b64_tr_b16 v[100:101], v163 offset:0
    ds_read_b64_tr_b16 v[102:103], v163 offset:2048
    v_mfma_f32_16x16x32_bf16 v[68:71], v[156:159], v[124:127], v[68:71]
    ds_read_b64_tr_b16 v[104:105], v164 offset:0
    ds_read_b64_tr_b16 v[106:107], v164 offset:2048
    v_mfma_f32_16x16x32_bf16 v[44:47], v[152:155], v[128:131], v[44:47]
    ds_read_b64_tr_b16 v[108:109], v165 offset:0
    ds_read_b64_tr_b16 v[110:111], v165 offset:2048
    v_mfma_f32_16x16x32_bf16 v[72:75], v[156:159], v[128:131], v[72:75]
    ds_read_b64_tr_b16 v[112:113], v166 offset:0
    ds_read_b64_tr_b16 v[114:115], v166 offset:2048
    v_mfma_f32_16x16x32_bf16 v[48:51], v[152:155], v[132:135], v[48:51]
    v_mfma_f32_16x16x32_bf16 v[76:79], v[156:159], v[132:135], v[76:79]
    v_mfma_f32_16x16x32_bf16 v[52:55], v[152:155], v[136:139], v[52:55]
    v_mfma_f32_16x16x32_bf16 v[80:83], v[156:159], v[136:139], v[80:83]
    v_mfma_f32_16x16x32_bf16 v[56:59], v[152:155], v[140:143], v[56:59]
    v_mfma_f32_16x16x32_bf16 v[84:87], v[156:159], v[140:143], v[84:87]
    s_waitcnt lgkmcnt(0)
    v_mfma_f32_16x16x32_bf16 v[32:35], v[144:147], v[88:91], v[32:35]
    ds_read_b128 v[152:155], v27 offset:0
    ds_read_b128 v[156:159], v27 offset:2048
    v_mfma_f32_16x16x32_bf16 v[60:63], v[148:151], v[88:91], v[60:63]
    ds_read_b64_tr_b16 v[116:117], v160 offset:8192
    ds_read_b64_tr_b16 v[118:119], v160 offset:10240
    v_mfma_f32_16x16x32_bf16 v[36:39], v[144:147], v[92:95], v[36:39]
    ds_read_b64_tr_b16 v[120:121], v161 offset:8192
    ds_read_b64_tr_b16 v[122:123], v161 offset:10240
    v_mfma_f32_16x16x32_bf16 v[64:67], v[148:151], v[92:95], v[64:67]
    ds_read_b64_tr_b16 v[124:125], v162 offset:8192
    ds_read_b64_tr_b16 v[126:127], v162 offset:10240
    v_mfma_f32_16x16x32_bf16 v[40:43], v[144:147], v[96:99], v[40:43]
    ds_read_b64_tr_b16 v[128:129], v163 offset:8192
    ds_read_b64_tr_b16 v[130:131], v163 offset:10240
    v_mfma_f32_16x16x32_bf16 v[68:71], v[148:151], v[96:99], v[68:71]
    ds_read_b64_tr_b16 v[132:133], v164 offset:8192
    ds_read_b64_tr_b16 v[134:135], v164 offset:10240
    v_mfma_f32_16x16x32_bf16 v[44:47], v[144:147], v[100:103], v[44:47]
    ds_read_b64_tr_b16 v[136:137], v165 offset:8192
    ds_read_b64_tr_b16 v[138:139], v165 offset:10240
    v_mfma_f32_16x16x32_bf16 v[72:75], v[148:151], v[100:103], v[72:75]
    ds_read_b64_tr_b16 v[140:141], v166 offset:8192
    ds_read_b64_tr_b16 v[142:143], v166 offset:10240
    v_mfma_f32_16x16x32_bf16 v[48:51], v[144:147], v[104:107], v[48:51]
    v_mfma_f32_16x16x32_bf16 v[76:79], v[148:151], v[104:107], v[76:79]
    v_mfma_f32_16x16x32_bf16 v[52:55], v[144:147], v[108:111], v[52:55]
    v_mfma_f32_16x16x32_bf16 v[80:83], v[148:151], v[108:111], v[80:83]
    v_mfma_f32_16x16x32_bf16 v[56:59], v[144:147], v[112:115], v[56:59]
    v_mfma_f32_16x16x32_bf16 v[84:87], v[148:151], v[112:115], v[84:87]
    s_barrier
    s_waitcnt lgkmcnt(0)
    v_mfma_f32_16x16x32_bf16 v[32:35], v[152:155], v[116:119], v[32:35]
    ds_read_b128 v[144:147], v26 offset:32768
    ds_read_b128 v[148:151], v26 offset:34816
    v_mfma_f32_16x16x32_bf16 v[60:63], v[156:159], v[116:119], v[60:63]
    ds_read_b64_tr_b16 v[88:89], v160 offset:32768
    ds_read_b64_tr_b16 v[90:91], v160 offset:34816
    v_mfma_f32_16x16x32_bf16 v[36:39], v[152:155], v[120:123], v[36:39]
    ds_read_b64_tr_b16 v[92:93], v161 offset:32768
    ds_read_b64_tr_b16 v[94:95], v161 offset:34816
    v_mfma_f32_16x16x32_bf16 v[64:67], v[156:159], v[120:123], v[64:67]
    ds_read_b64_tr_b16 v[96:97], v162 offset:32768
    ds_read_b64_tr_b16 v[98:99], v162 offset:34816
    v_mfma_f32_16x16x32_bf16 v[40:43], v[152:155], v[124:127], v[40:43]
    ds_read_b64_tr_b16 v[100:101], v163 offset:32768
    ds_read_b64_tr_b16 v[102:103], v163 offset:34816
    v_mfma_f32_16x16x32_bf16 v[68:71], v[156:159], v[124:127], v[68:71]
    ds_read_b64_tr_b16 v[104:105], v164 offset:32768
    ds_read_b64_tr_b16 v[106:107], v164 offset:34816
    v_mfma_f32_16x16x32_bf16 v[44:47], v[152:155], v[128:131], v[44:47]
    ds_read_b64_tr_b16 v[108:109], v165 offset:32768
    ds_read_b64_tr_b16 v[110:111], v165 offset:34816
    v_mfma_f32_16x16x32_bf16 v[72:75], v[156:159], v[128:131], v[72:75]
    ds_read_b64_tr_b16 v[112:113], v166 offset:32768
    ds_read_b64_tr_b16 v[114:115], v166 offset:34816
    v_mfma_f32_16x16x32_bf16 v[48:51], v[152:155], v[132:135], v[48:51]
    v_mfma_f32_16x16x32_bf16 v[76:79], v[156:159], v[132:135], v[76:79]
    v_mfma_f32_16x16x32_bf16 v[52:55], v[152:155], v[136:139], v[52:55]
    v_mfma_f32_16x16x32_bf16 v[80:83], v[156:159], v[136:139], v[80:83]
    v_mfma_f32_16x16x32_bf16 v[56:59], v[152:155], v[140:143], v[56:59]
    v_mfma_f32_16x16x32_bf16 v[84:87], v[156:159], v[140:143], v[84:87]
    s_waitcnt lgkmcnt(0)
    v_mfma_f32_16x16x32_bf16 v[32:35], v[144:147], v[88:91], v[32:35]
    ds_read_b128 v[152:155], v27 offset:32768
    ds_read_b128 v[156:159], v27 offset:34816
    v_mfma_f32_16x16x32_bf16 v[60:63], v[148:151], v[88:91], v[60:63]
    ds_read_b64_tr_b16 v[116:117], v160 offset:40960
    ds_read_b64_tr_b16 v[118:119], v160 offset:43008
    v_mfma_f32_16x16x32_bf16 v[36:39], v[144:147], v[92:95], v[36:39]
    ds_read_b64_tr_b16 v[120:121], v161 offset:40960
    ds_read_b64_tr_b16 v[122:123], v161 offset:43008
    v_mfma_f32_16x16x32_bf16 v[64:67], v[148:151], v[92:95], v[64:67]
    ds_read_b64_tr_b16 v[124:125], v162 offset:40960
    ds_read_b64_tr_b16 v[126:127], v162 offset:43008
    v_mfma_f32_16x16x32_bf16 v[40:43], v[144:147], v[96:99], v[40:43]
    ds_read_b64_tr_b16 v[128:129], v163 offset:40960
    ds_read_b64_tr_b16 v[130:131], v163 offset:43008
    v_mfma_f32_16x16x32_bf16 v[68:71], v[148:151], v[96:99], v[68:71]
    ds_read_b64_tr_b16 v[132:133], v164 offset:40960
    ds_read_b64_tr_b16 v[134:135], v164 offset:43008
    v_mfma_f32_16x16x32_bf16 v[44:47], v[144:147], v[100:103], v[44:47]
    ds_read_b64_tr_b16 v[136:137], v165 offset:40960
    ds_read_b64_tr_b16 v[138:139], v165 offset:43008
    v_mfma_f32_16x16x32_bf16 v[72:75], v[148:151], v[100:103], v[72:75]
    ds_read_b64_tr_b16 v[140:141], v166 offset:40960
    ds_read_b64_tr_b16 v[142:143], v166 offset:43008
    v_mfma_f32_16x16x32_bf16 v[48:51], v[144:147], v[104:107], v[48:51]
    v_mfma_f32_16x16x32_bf16 v[76:79], v[148:151], v[104:107], v[76:79]
    v_mfma_f32_16x16x32_bf16 v[52:55], v[144:147], v[108:111], v[52:55]
    v_mfma_f32_16x16x32_bf16 v[80:83], v[148:151], v[108:111], v[80:83]
    v_mfma_f32_16x16x32_bf16 v[56:59], v[144:147], v[112:115], v[56:59]
    v_mfma_f32_16x16x32_bf16 v[84:87], v[148:151], v[112:115], v[84:87]
    s_waitcnt lgkmcnt(0)
    s_cmp_eq_u32 s20, 3
    s_cbranch_scc1 L1_fepi
    v_mfma_f32_16x16x32_bf16 v[32:35], v[152:155], v[116:119], v[32:35]
    v_mfma_f32_16x16x32_bf16 v[60:63], v[156:159], v[116:119], v[60:63]
    v_mfma_f32_16x16x32_bf16 v[36:39], v[152:155], v[120:123], v[36:39]
    v_mfma_f32_16x16x32_bf16 v[64:67], v[156:159], v[120:123], v[64:67]
    v_mfma_f32_16x16x32_bf16 v[40:43], v[152:155], v[124:127], v[40:43]
    v_mfma_f32_16x16x32_bf16 v[68:71], v[156:159], v[124:127], v[68:71]
    s_nop 3
    v_cvt_pk_bf16_f32 v32, v32, v33
    v_cvt_pk_bf16_f32 v33, v34, v35
    v_cvt_pk_bf16_f32 v34, v60, v61
    v_cvt_pk_bf16_f32 v35, v62, v63
    buffer_store_dwordx4 v[32:35], v12, s[32:35], s48 offen sc1
    v_mfma_f32_16x16x32_bf16 v[44:47], v[152:155], v[128:131], v[44:47]
    v_mfma_f32_16x16x32_bf16 v[72:75], v[156:159], v[128:131], v[72:75]
    v_cvt_pk_bf16_f32 v36, v36, v37
    v_cvt_pk_bf16_f32 v37, v38, v39
    v_cvt_pk_bf16_f32 v38, v64, v65
    v_cvt_pk_bf16_f32 v39, v66, v67
    buffer_store_dwordx4 v[36:39], v13, s[32:35], s48 offen sc1
    v_mfma_f32_16x16x32_bf16 v[48:51], v[152:155], v[132:135], v[48:51]
    v_mfma_f32_16x16x32_bf16 v[76:79], v[156:159], v[132:135], v[76:79]
    v_cvt_pk_bf16_f32 v40, v40, v41
    v_cvt_pk_bf16_f32 v41, v42, v43
    v_cvt_pk_bf16_f32 v42, v68, v69
    v_cvt_pk_bf16_f32 v43, v70, v71
    buffer_store_dwordx4 v[40:43], v14, s[32:35], s48 offen sc1
    v_mfma_f32_16x16x32_bf16 v[52:55], v[152:155], v[136:139], v[52:55]
    v_mfma_f32_16x16x32_bf16 v[80:83], v[156:159], v[136:139], v[80:83]
    v_cvt_pk_bf16_f32 v44, v44, v45
    v_cvt_pk_bf16_f32 v45, v46, v47
    v_cvt_pk_bf16_f32 v46, v72, v73
    v_cvt_pk_bf16_f32 v47, v74, v75
    buffer_store_dwordx4 v[44:47], v15, s[32:35], s48 offen sc1
    v_mfma_f32_16x16x32_bf16 v[56:59], v[152:155], v[140:143], v[56:59]
    v_mfma_f32_16x16x32_bf16 v[84:87], v[156:159], v[140:143], v[84:87]
    v_cvt_pk_bf16_f32 v48, v48, v49
    v_cvt_pk_bf16_f32 v49, v50, v51
    v_cvt_pk_bf16_f32 v50, v76, v77
    v_cvt_pk_bf16_f32 v51, v78, v79
    buffer_store_dwordx4 v[48:51], v16, s[32:35], s48 offen sc1
    s_nop 3
    v_cvt_pk_bf16_f32 v52, v52, v53
    v_cvt_pk_bf16_f32 v53, v54, v55
    v_cvt_pk_bf16_f32 v54, v80, v81
    v_cvt_pk_bf16_f32 v55, v82, v83
    buffer_store_dwordx4 v[52:55], v17, s[32:35], s48 offen sc1
    s_nop 3
    v_cvt_pk_bf16_f32 v56, v56, v57
    v_cvt_pk_bf16_f32 v57, v58, v59
    v_cvt_pk_bf16_f32 v58, v84, v85
    v_cvt_pk_bf16_f32 v59, v86, v87
    buffer_store_dwordx4 v[56:59], v18, s[32:35], s48 offen sc1
    s_nop 3
    s_branch L1_side
L1_fepi:
    v_mfma_f32_16x16x32_bf16 v[32:35], v[152:155], v[116:119], v[32:35]
    v_mfma_f32_16x16x32_bf16 v[60:63], v[156:159], v[116:119], v[60:63]
    v_mfma_f32_16x16x32_bf16 v[36:39], v[152:155], v[120:123], v[36:39]
    v_mfma_f32_16x16x32_bf16 v[64:67], v[156:159], v[120:123], v[64:67]
    v_mfma_f32_16x16x32_bf16 v[40:43], v[152:155], v[124:127], v[40:43]
    v_mfma_f32_16x16x32_bf16 v[68:71], v[156:159], v[124:127], v[68:71]
    s_nop 3
    v_add_f32 v88, v32, v60
    v_sub_f32 v60, v32, v60
    v_add_f32 v89, v33, v61
    v_sub_f32 v61, v33, v61
    v_add_f32 v90, v34, v62
    v_sub_f32 v62, v34, v62
    v_add_f32 v91, v35, v63
    v_sub_f32 v63, v35, v63
    v_cvt_pk_bf16_f32 v32, v88, v89
    v_cvt_pk_bf16_f32 v33, v90, v91
    v_cvt_pk_bf16_f32 v34, v60, v61
    v_cvt_pk_bf16_f32 v35, v62, v63
    ds_write_b64 v19, v[32:33] offset:0
    ds_write_b64 v19, v[34:35] offset:16128
    v_mfma_f32_16x16x32_bf16 v[44:47], v[152:155], v[128:131], v[44:47]
    v_mfma_f32_16x16x32_bf16 v[72:75], v[156:159], v[128:131], v[72:75]
    v_add_f32 v92, v36, v64
    v_sub_f32 v64, v36, v64
    v_add_f32 v93, v37, v65
    v_sub_f32 v65, v37, v65
    v_add_f32 v94, v38, v66
    v_sub_f32 v66, v38, v66
    v_add_f32 v95, v39, v67
    v_sub_f32 v67, v39, v67
    v_cvt_pk_bf16_f32 v36, v92, v93
    v_cvt_pk_bf16_f32 v37, v94, v95
    v_cvt_pk_bf16_f32 v38, v64, v65
    v_cvt_pk_bf16_f32 v39, v66, v67
    ds_write_b64 v19, v[36:37] offset:2304
    ds_write_b64 v19, v[38:39] offset:18432
    v_mfma_f32_16x16x32_bf16 v[48:51], v[152:155], v[132:135], v[48:51]
    v_mfma_f32_16x16x32_bf16 v[76:79], v[156:159], v[132:135], v[76:79]
    v_add_f32 v96, v40, v68
    v_sub_f32 v68, v40, v68
    v_add_f32 v97, v41, v69
    v_sub_f32 v69, v41, v69
    v_add_f32 v98, v42, v70
    v_sub_f32 v70, v42, v70
    v_add_f32 v99, v43, v71
    v_sub_f32 v71, v43, v71
    v_cvt_pk_bf16_f32 v40, v96, v97
    v_cvt_pk_bf16_f32 v41, v98, v99
    v_cvt_pk_bf16_f32 v42, v68, v69
    v_cvt_pk_bf16_f32 v43, v70, v71
    ds_write_b64 v19, v[40:41] offset:4608
    ds_write_b64 v19, v[42:43] offset:20736
    v_mfma_f32_16x16x32_bf16 v[52:55], v[152:155], v[136:139], v[52:55]
    v_mfma_f32_16x16x32_bf16 v[80:83], v[156:159], v[136:139], v[80:83]
    v_add_f32 v100, v44, v72
    v_sub_f32 v72, v44, v72
    v_add_f32 v101, v45, v73
    v_sub_f32 v73, v45, v73
    v_add_f32 v102, v46, v74
    v_sub_f32 v74, v46, v74
    v_add_f32 v103, v47, v75
    v_sub_f32 v75, v47, v75
    v_cvt_pk_bf16_f32 v44, v100, v101
    v_cvt_pk_bf16_f32 v45, v102, v103
    v_cvt_pk_bf16_f32 v46, v72, v73
    v_cvt_pk_bf16_f32 v47, v74, v75
    ds_write_b64 v19, v[44:45] offset:6912
    ds_write_b64 v19, v[46:47] offset:23040
    v_mfma_f32_16x16x32_bf16 v[56:59], v[152:155], v[140:143], v[56:59]
    v_mfma_f32_16x16x32_bf16 v[84:87], v[156:159], v[140:143], v[84:87]
    v_add_f32 v104, v48, v76
    v_sub_f32 v76, v48, v76
    v_add_f32 v105, v49, v77
    v_sub_f32 v77, v49, v77
    v_add_f32 v106, v50, v78
    v_sub_f32 v78, v50, v78
    v_add_f32 v107, v51, v79
    v_sub_f32 v79, v51, v79
    v_cvt_pk_bf16_f32 v48, v104, v105
    v_cvt_pk_bf16_f32 v49, v106, v107
    v_cvt_pk_bf16_f32 v50, v76, v77
    v_cvt_pk_bf16_f32 v51, v78, v79
    ds_write_b64 v19, v[48:49] offset:9216
    ds_write_b64 v19, v[50:51] offset:25344
    v_add_f32 v108, v52, v80
    v_sub_f32 v80, v52, v80
    v_add_f32 v109, v53, v81
    v_sub_f32 v81, v53, v81
    v_add_f32 v110, v54, v82
    v_sub_f32 v82, v54, v82
    v_add_f32 v111, v55, v83
    v_sub_f32 v83, v55, v83
    v_cvt_pk_bf16_f32 v52, v108, v109
    v_cvt_pk_bf16_f32 v53, v110, v111
    v_cvt_pk_bf16_f32 v54, v80, v81
    v_cvt_pk_bf16_f32 v55, v82, v83
    ds_write_b64 v19, v[52:53] offset:11520
    ds_write_b64 v19, v[54:55] offset:27648
    v_add_f32 v112, v56, v84
    v_sub_f32 v84, v56, v84
    v_add_f32 v113, v57, v85
    v_sub_f32 v85, v57, v85
    v_add_f32 v114, v58, v86
    v_sub_f32 v86, v58, v86
    v_add_f32 v115, v59, v87
    v_sub_f32 v87, v59, v87
    v_cvt_pk_bf16_f32 v56, v112, v113
    v_cvt_pk_bf16_f32 v57, v114, v115
    v_cvt_pk_bf16_f32 v58, v84, v85
    v_cvt_pk_bf16_f32 v59, v86, v87
    ds_write_b64 v19, v[56:57] offset:13824
    ds_write_b64 v19, v[58:59] offset:29952
    s_waitcnt lgkmcnt(0)
    s_barrier
    ds_read_b128 v[88:91], v20 offset:0
    ds_read_b128 v[92:95], v20 offset:4608
    ds_read_b128 v[96:99], v20 offset:9216
    ds_read_b128 v[100:103], v20 offset:13824
    ds_read_b128 v[104:107], v20 offset:18432
    ds_read_b128 v[108:111], v20 offset:23040
    ds_read_b128 v[112:115], v20 offset:27648
    s_waitcnt lgkmcnt(6)
    buffer_store_dwordx4 v[88:91], v12, s[32:35], s48 offen sc1
    s_waitcnt lgkmcnt(5)
    buffer_store_dwordx4 v[92:95], v13, s[32:35], s48 offen sc1
    s_waitcnt lgkmcnt(4)
    buffer_store_dwordx4 v[96:99], v14, s[32:35], s48 offen sc1
    s_waitcnt lgkmcnt(3)
    buffer_store_dwordx4 v[100:103], v15, s[32:35], s48 offen sc1
    s_waitcnt lgkmcnt(2)
    buffer_store_dwordx4 v[104:107], v16, s[32:35], s48 offen sc1
    s_waitcnt lgkmcnt(1)
    buffer_store_dwordx4 v[108:111], v17, s[32:35], s48 offen sc1
    s_waitcnt lgkmcnt(0)
    buffer_store_dwordx4 v[112:115], v18, s[32:35], s48 offen sc1
L1_side:
    s_branch L2_entry
L1_end:
    s_endpgm
L2_entry:
    s_cmp_ge_u32 s2, 256
    s_cbranch_scc1 L2_end
    s_load_dwordx2 s[4:5], s[0:1], 64
    v_lshrrev_b32 v8, 6, v0
    v_and_b32 v1, 63, v0
    v_readfirstlane_b32 s22, v8
    s_and_b32 s20, s2, 7
    s_lshl_b32 s20, s20, 1
    s_bfe_u32 s25, s2, 0x10003
    s_add_u32 s20, s20, s25
    s_lshr_b32 s21, s2, 4
    v_lshlrev_b32 v2, 4, v1
    s_cmp_ge_u32 s22, 10
    s_cbranch_scc1 L2_fft
    s_cmp_ge_u32 s22, 8
    s_cbranch_scc1 L2_loader
    s_and_b32 s23, s22, 1
    s_lshr_b32 s24, s22, 1
    s_lshl_b32 s25, s24, 12
    v_add_u32 v3, s25, v2
    v_add_u32 v4, 0x10000, v3
    s_lshl_b32 s35, s21, 1
    s_add_u32 s35, s35, s23
    s_lshl_b32 s35, s35, 12
    s_lshl_b32 s25, s20, 17
    s_add_u32 s35, s35, s25
    s_lshl_b32 s25, s20, 18
    s_lshr_b32 s26, s24, 1
    s_lshl_b32 s27, s26, 17
    s_add_u32 s25, s25, s27
    s_and_b32 s27, s24, 1
    s_mul_i32 s28, s27, 65536
    s_add_u32 s25, s25, s28
    s_add_u32 s25, s25, 2097152
    s_cmp_eq_u32 s27, 0
    s_cselect_b32 s31, 16, 16
    s_mov_b32 s34, 0x07060302
    v_mov_b32 v5, 0xff800000
    v_mov_b32 v6, 0xff800000
    s_mov_b32 s30, 0
    s_waitcnt lgkmcnt(0)
    s_mov_b32 s8, s4
    s_and_b32 s9, s5, 0xffff
    s_mov_b32 s10, 16777216
    s_mov_b32 s11, 0x20000
    s_add_u32 s12, s4, s25
    s_addc_u32 s13, s5, 0
    s_and_b32 s13, s13, 0xffff
    s_lshl_b32 s14, s31, 12
    s_mov_b32 s15, 0x20000
    s_lshl_b32 s25, s22, 13
    s_add_u32 s25, s25, 16384
    v_add_u32 v148, s25, v2
    v_lshlrev_b32 v9, 2, v1
    s_lshl_b32 s25, s22, 10
    s_add_u32 s25, s25, 131072
    v_add_u32 v149, s25, v9
    s_and_b32 s25, s24, 1
    s_lshr_b32 s26, s24, 1
    s_and_b32 s51, s20, 1
    s_lshl_b32 s27, s23, 13
    s_lshl_b32 s28, s25, 12
    s_add_u32 s27, s27, s28
    s_add_u32 s27, s27, 16384
    v_lshrrev_b32 v10, 5, v1
    s_lshl_b32 s28, s26, 1
    v_add_u32 v10, s28, v10
    v_lshlrev_b32 v11, 1, v10
    v_subrev_u32 v11, s51, v11
    v_add_u32 v12, 1, v11
    v_max_i32 v11, 0, v11
    v_and_b32 v14, 31, v1
    v_lshlrev_b32 v14, 4, v14
    v_add_u32 v14, s27, v14
    v_lshl_add_u32 v150, v11, 9, v14
    v_lshl_add_u32 v151, v12, 9, v14
    s_lshl_b32 s27, s23, 10
    s_lshl_b32 s28, s25, 9
    s_add_u32 s27, s27, s28
    s_add_u32 s27, s27, 131072
    v_or_b32 v9, 128, v9
    v_add_u32 v152, s27, v9
    s_lshl_b32 s27, s21, 3
    s_lshl_b32 s28, s23, 2
    s_add_u32 s27, s27, s28
    s_lshl_b32 s28, s25, 1
    s_add_u32 s27, s27, s28
    s_mul_i32 s27, s27, 14336
    s_mul_i32 s28, s20, 7
    s_lshr_b32 s28, s28, 1
    s_lshl_b32 s28, s28, 8
    s_add_u32 s27, s27, s28
    s_add_u32 s50, s27, 10485760
    v_lshlrev_b32 v11, 8, v10
    v_and_b32 v12, 15, v1
    v_lshl_add_u32 v11, v12, 4, v11
    v_bfe_u32 v12, v1, 4, 1
    v_mul_u32_u24 v12, 14336, v12
    v_add_u32 v153, v12, v11
    s_xor_b32 s28, s51, 1
    s_mul_i32 s28, s28, 3
    v_cmp_ne_u32 s[38:39], s28, v10
    v_mov_b32 v154, 0x53800000
    v_mov_b32 v155, 0x207
    v_mov_b32 v112, 0
    v_mov_b32 v113, 0
    v_mov_b32 v114, 0
    v_mov_b32 v115, 0
    v_mov_b32 v116, 0
    v_mov_b32 v117, 0
    v_mov_b32 v118, 0
    v_mov_b32 v119, 0
    v_mov_b32 v120, 0
    v_mov_b32 v121, 0
    v_mov_b32 v122, 0
    v_mov_b32 v123, 0
    v_mov_b32 v124, 0
    v_mov_b32 v125, 0
    v_mov_b32 v126, 0
    v_mov_b32 v127, 0
    v_mov_b32 v128, 0
    v_mov_b32 v129, 0
    v_mov_b32 v130, 0
    v_mov_b32 v131, 0
    v_mov_b32 v132, 0
    v_mov_b32 v133, 0
    v_mov_b32 v134, 0
    v_mov_b32 v135, 0
    v_mov_b32 v136, 0
    v_mov_b32 v137, 0
    v_mov_b32 v138, 0
    v_mov_b32 v139, 0
    v_mov_b32 v140, 0
    v_mov_b32 v141, 0
    v_mov_b32 v142, 0
    v_mov_b32 v143, 0
    s_waitcnt vmcnt(0)
    s_barrier
    s_barrier
    v_mov_b32 v8, 139456
    ds_read_b64 v[10:11], v8
    buffer_load_dwordx4 v[16:19], v2, s[8:11], s35 offen offset:0 sc1
    buffer_load_dwordx4 v[20:23], v2, s[8:11], s35 offen offset:1024 sc1
    buffer_load_dwordx4 v[24:27], v2, s[8:11], s35 offen offset:2048 sc1
    buffer_load_dwordx4 v[28:31], v2, s[8:11], s35 offen offset:3072 sc1
    buffer_load_dwordx4 v[32:35], v2, s[12:15], 0 offen sc1
    buffer_load_dwordx4 v[36:39], v2, s[12:15], 0 offen offset:1024 sc1
    v_mov_b32 v72, 0
    v_mov_b32 v56, 0
    v_mov_b32 v73, 0
    v_mov_b32 v57, 0
    v_mov_b32 v74, 0
    v_mov_b32 v58, 0
    v_mov_b32 v75, 0
    v_mov_b32 v59, 0
    v_mov_b32 v76, 0
    v_mov_b32 v60, 0
    v_mov_b32 v77, 0
    v_mov_b32 v61, 0
    v_mov_b32 v78, 0
    v_mov_b32 v62, 0
    v_mov_b32 v79, 0
    v_mov_b32 v63, 0
    s_waitcnt lgkmcnt(0)
    v_readfirstlane_b32 s96, v10
    v_readfirstlane_b32 s97, v11
    s_waitcnt vmcnt(0)
    v_mfma_f32_32x32x16_bf16 v[80:95], v[32:35], v[16:19], 0
    v_mfma_f32_32x32x16_bf16 v[80:95], v[36:39], v[20:23], v[80:95]
    v_mfma_f32_32x32x16_bf16 v[96:111], v[32:35], v[24:27], 0
    v_mfma_f32_32x32x16_bf16 v[96:111], v[36:39], v[28:31], v[96:111]
    s_nop 9
    v_max3_f32 v5, v80, v81, v5
    v_max3_f32 v5, v82, v83, v5
    v_max3_f32 v5, v84, v85, v5
    v_max3_f32 v5, v86, v87, v5
    v_max3_f32 v5, v88, v89, v5
    v_max3_f32 v5, v90, v91, v5
    v_max3_f32 v5, v92, v93, v5
    v_max3_f32 v5, v94, v95, v5
    v_max3_f32 v6, v96, v97, v6
    v_max3_f32 v6, v98, v99, v6
    v_max3_f32 v6, v100, v101, v6
    v_max3_f32 v6, v102, v103, v6
    v_max3_f32 v6, v104, v105, v6
    v_max3_f32 v6, v106, v107, v6
    v_max3_f32 v6, v108, v109, v6
    v_max3_f32 v6, v110, v111, v6
    v_mov_b32 v8, v5
    v_mov_b32 v9, v5
    v_mov_b32 v10, v6
    v_mov_b32 v11, v6
    s_nop 1
    v_permlane32_swap_b32 v8, v9
    v_permlane32_swap_b32 v10, v11
    v_max_f32 v5, v8, v9
    v_max_f32 v6, v10, v11
    s_mov_b32 exec_lo, 0
    v_sub_f32 v8, 0, v5
    v_and_b32 v9, 0xffff0000, v8
    v_sub_f32 v8, v8, v9
    v_and_b32 v10, 0xffff0000, v8
    v_sub_f32 v8, v8, v10
    v_perm_b32 v22, v10, v9, s34
    v_lshrrev_b32 v23, 16, v8
    v_sub_f32 v8, 0, v6
    v_and_b32 v9, 0xffff0000, v8
    v_sub_f32 v8, v8, v9
    v_and_b32 v10, 0xffff0000, v8
    v_sub_f32 v8, v8, v10
    v_perm_b32 v30, v10, v9, s34
    v_lshrrev_b32 v31, 16, v8
    s_mov_b32 exec_lo, -1
    s_nop 3
    v_mfma_f32_32x32x16_bf16 v[80:95], v[32:35], v[16:19], 0
    v_mfma_f32_32x32x16_bf16 v[80:95], v[36:39], v[20:23], v[80:95]
    s_nop 7
L2_loop:
    s_barrier
    ds_read_b128 v[40:43], v3 offset:16384
    ds_read_b128 v[44:47], v3 offset:17408
    ds_read_b128 v[48:51], v3 offset:2048
    ds_read_b128 v[52:55], v3 offset:3072
    v_mfma_f32_32x32x16_bf16 v[96:111], v[32:35], v[24:27], 0
    v_exp_f32 v80, v80
    v_exp_f32 v81, v81
    v_exp_f32 v82, v82
    v_exp_f32 v83, v83
    v_mfma_f32_32x32x16_bf16 v[96:111], v[36:39], v[28:31], v[96:111]
    v_exp_f32 v84, v84
    v_exp_f32 v85, v85
    v_exp_f32 v86, v86
    v_exp_f32 v87, v87
    v_cvt_pk_bf16_f32 v64, v80, v81
    v_cvt_pk_bf16_f32 v65, v82, v83
    v_mfma_f32_32x32x16_bf16 v[128:143], v[56:59], v[72:75], v[128:143]
    v_exp_f32 v88, v88
    v_exp_f32 v89, v89
    v_exp_f32 v90, v90
    v_exp_f32 v91, v91
    v_cvt_pk_bf16_f32 v66, v84, v85
    v_cvt_pk_bf16_f32 v67, v86, v87
    v_mfma_f32_32x32x16_bf16 v[128:143], v[60:63], v[76:79], v[128:143]
    v_exp_f32 v92, v92
    v_exp_f32 v93, v93
    v_exp_f32 v94, v94
    v_exp_f32 v95, v95
    v_cvt_pk_bf16_f32 v68, v88, v89
    v_cvt_pk_bf16_f32 v69, v90, v91
    v_cvt_pk_bf16_f32 v70, v92, v93
    v_cvt_pk_bf16_f32 v71, v94, v95
    s_waitcnt lgkmcnt(0)
    v_mfma_f32_32x32x16_bf16 v[80:95], v[40:43], v[16:19], 0
    v_exp_f32 v96, v96
    v_exp_f32 v97, v97
    v_exp_f32 v98, v98
    v_exp_f32 v99, v99
    v_mfma_f32_32x32x16_bf16 v[80:95], v[44:47], v[20:23], v[80:95]
    v_exp_f32 v100, v100
    v_exp_f32 v101, v101
    v_exp_f32 v102, v102
    v_exp_f32 v103, v103
    v_cvt_pk_bf16_f32 v72, v96, v97
    v_cvt_pk_bf16_f32 v73, v98, v99
    v_mfma_f32_32x32x16_bf16 v[112:127], v[48:51], v[64:67], v[112:127]
    v_exp_f32 v104, v104
    v_exp_f32 v105, v105
    v_exp_f32 v106, v106
    v_exp_f32 v107, v107
    v_cvt_pk_bf16_f32 v74, v100, v101
    v_cvt_pk_bf16_f32 v75, v102, v103
    v_mfma_f32_32x32x16_bf16 v[112:127], v[52:55], v[68:71], v[112:127]
    v_exp_f32 v108, v108
    v_exp_f32 v109, v109
    v_exp_f32 v110, v110
    v_exp_f32 v111, v111
    v_cvt_pk_bf16_f32 v76, v104, v105
    v_cvt_pk_bf16_f32 v77, v106, v107
    v_cvt_pk_bf16_f32 v78, v108, v109
    v_cvt_pk_bf16_f32 v79, v110, v111
    s_barrier
    ds_read_b128 v[32:35], v3 offset:32768
    ds_read_b128 v[36:39], v3 offset:33792
    ds_read_b128 v[56:59], v3 offset:18432
    ds_read_b128 v[60:63], v3 offset:19456
    v_mfma_f32_32x32x16_bf16 v[96:111], v[40:43], v[24:27], 0
    v_exp_f32 v80, v80
    v_exp_f32 v81, v81
    v_exp_f32 v82, v82
    v_exp_f32 v83, v83
    v_mfma_f32_32x32x16_bf16 v[96:111], v[44:47], v[28:31], v[96:111]
    v_exp_f32 v84, v84
    v_exp_f32 v85, v85
    v_exp_f32 v86, v86
    v_exp_f32 v87, v87
    v_cvt_pk_bf16_f32 v64, v80, v81
    v_cvt_pk_bf16_f32 v65, v82, v83
    v_mfma_f32_32x32x16_bf16 v[128:143], v[48:51], v[72:75], v[128:143]
    v_exp_f32 v88, v88
    v_exp_f32 v89, v89
    v_exp_f32 v90, v90
    v_exp_f32 v91, v91
    v_cvt_pk_bf16_f32 v66, v84, v85
    v_cvt_pk_bf16_f32 v67, v86, v87
    v_mfma_f32_32x32x16_bf16 v[128:143], v[52:55], v[76:79], v[128:143]
    v_exp_f32 v92, v92
    v_exp_f32 v93, v93
    v_exp_f32 v94, v94
    v_exp_f32 v95, v95
    v_cvt_pk_bf16_f32 v68, v88, v89
    v_cvt_pk_bf16_f32 v69, v90, v91
    v_cvt_pk_bf16_f32 v70, v92, v93
    v_cvt_pk_bf16_f32 v71, v94, v95
    s_waitcnt lgkmcnt(0)
    v_mfma_f32_32x32x16_bf16 v[80:95], v[32:35], v[16:19], 0
    v_exp_f32 v96, v96
    v_exp_f32 v97, v97
    v_exp_f32 v98, v98
    v_exp_f32 v99, v99
    v_mfma_f32_32x32x16_bf16 v[80:95], v[36:39], v[20:23], v[80:95]
    v_exp_f32 v100, v100
    v_exp_f32 v101, v101
    v_exp_f32 v102, v102
    v_exp_f32 v103, v103
    v_cvt_pk_bf16_f32 v72, v96, v97
    v_cvt_pk_bf16_f32 v73, v98, v99
    v_mfma_f32_32x32x16_bf16 v[112:127], v[56:59], v[64:67], v[112:127]
    v_exp_f32 v104, v104
    v_exp_f32 v105, v105
    v_exp_f32 v106, v106
    v_exp_f32 v107, v107
    v_cvt_pk_bf16_f32 v74, v100, v101
    v_cvt_pk_bf16_f32 v75, v102, v103
    v_mfma_f32_32x32x16_bf16 v[112:127], v[60:63], v[68:71], v[112:127]
    v_exp_f32 v108, v108
    v_exp_f32 v109, v109
    v_exp_f32 v110, v110
    v_exp_f32 v111, v111
    v_cvt_pk_bf16_f32 v76, v104, v105
    v_cvt_pk_bf16_f32 v77, v106, v107
    v_cvt_pk_bf16_f32 v78, v108, v109
    v_cvt_pk_bf16_f32 v79, v110, v111
    s_barrier
    ds_read_b128 v[40:43], v3 offset:49152
    ds_read_b128 v[44:47], v3 offset:50176
    ds_read_b128 v[48:51], v3 offset:34816
    ds_read_b128 v[52:55], v3 offset:35840
    v_mfma_f32_32x32x16_bf16 v[96:111], v[32:35], v[24:27], 0
    v_exp_f32 v80, v80
    v_exp_f32 v81, v81
    v_exp_f32 v82, v82
    v_exp_f32 v83, v83
    v_mfma_f32_32x32x16_bf16 v[96:111], v[36:39], v[28:31], v[96:111]
    v_exp_f32 v84, v84
    v_exp_f32 v85, v85
    v_exp_f32 v86, v86
    v_exp_f32 v87, v87
    v_cvt_pk_bf16_f32 v64, v80, v81
    v_cvt_pk_bf16_f32 v65, v82, v83
    v_mfma_f32_32x32x16_bf16 v[128:143], v[56:59], v[72:75], v[128:143]
    v_exp_f32 v88, v88
    v_exp_f32 v89, v89
    v_exp_f32 v90, v90
    v_exp_f32 v91, v91
    v_cvt_pk_bf16_f32 v66, v84, v85
    v_cvt_pk_bf16_f32 v67, v86, v87
    v_mfma_f32_32x32x16_bf16 v[128:143], v[60:63], v[76:79], v[128:143]
    v_exp_f32 v92, v92
    v_exp_f32 v93, v93
    v_exp_f32 v94, v94
    v_exp_f32 v95, v95
    v_cvt_pk_bf16_f32 v68, v88, v89
    v_cvt_pk_bf16_f32 v69, v90, v91
    v_cvt_pk_bf16_f32 v70, v92, v93
    v_cvt_pk_bf16_f32 v71, v94, v95
    s_waitcnt lgkmcnt(0)
    v_mfma_f32_32x32x16_bf16 v[80:95], v[40:43], v[16:19], 0
    v_exp_f32 v96, v96
    v_exp_f32 v97, v97
    v_exp_f32 v98, v98
    v_exp_f32 v99, v99
    v_mfma_f32_32x32x16_bf16 v[80:95], v[44:47], v[20:23], v[80:95]
    v_exp_f32 v100, v100
    v_exp_f32 v101, v101
    v_exp_f32 v102, v102
    v_exp_f32 v103, v103
    v_cvt_pk_bf16_f32 v72, v96, v97
    v_cvt_pk_bf16_f32 v73, v98, v99
    v_mfma_f32_32x32x16_bf16 v[112:127], v[48:51], v[64:67], v[112:127]
    v_exp_f32 v104, v104
    v_exp_f32 v105, v105
    v_exp_f32 v106, v106
    v_exp_f32 v107, v107
    v_cvt_pk_bf16_f32 v74, v100, v101
    v_cvt_pk_bf16_f32 v75, v102, v103
    v_mfma_f32_32x32x16_bf16 v[112:127], v[52:55], v[68:71], v[112:127]
    v_exp_f32 v108, v108
    v_exp_f32 v109, v109
    v_exp_f32 v110, v110
    v_exp_f32 v111, v111
    v_cvt_pk_bf16_f32 v76, v104, v105
    v_cvt_pk_bf16_f32 v77, v106, v107
    v_cvt_pk_bf16_f32 v78, v108, v109
    v_cvt_pk_bf16_f32 v79, v110, v111
    s_barrier
    ds_read_b128 v[32:35], v4 offset:0
    ds_read_b128 v[36:39], v4 offset:1024
    ds_read_b128 v[56:59], v3 offset:51200
    ds_read_b128 v[60:63], v3 offset:52224
    v_mfma_f32_32x32x16_bf16 v[96:111], v[40:43], v[24:27], 0
    v_exp_f32 v80, v80
    v_exp_f32 v81, v81
    v_exp_f32 v82, v82
    v_exp_f32 v83, v83
    v_mfma_f32_32x32x16_bf16 v[96:111], v[44:47], v[28:31], v[96:111]
    v_exp_f32 v84, v84
    v_exp_f32 v85, v85
    v_exp_f32 v86, v86
    v_exp_f32 v87, v87
    v_cvt_pk_bf16_f32 v64, v80, v81
    v_cvt_pk_bf16_f32 v65, v82, v83
    v_mfma_f32_32x32x16_bf16 v[128:143], v[48:51], v[72:75], v[128:143]
    v_exp_f32 v88, v88
    v_exp_f32 v89, v89
    v_exp_f32 v90, v90
    v_exp_f32 v91, v91
    v_cvt_pk_bf16_f32 v66, v84, v85
    v_cvt_pk_bf16_f32 v67, v86, v87
    v_mfma_f32_32x32x16_bf16 v[128:143], v[52:55], v[76:79], v[128:143]
    v_exp_f32 v92, v92
    v_exp_f32 v93, v93
    v_exp_f32 v94, v94
    v_exp_f32 v95, v95
    v_cvt_pk_bf16_f32 v68, v88, v89
    v_cvt_pk_bf16_f32 v69, v90, v91
    v_cvt_pk_bf16_f32 v70, v92, v93
    v_cvt_pk_bf16_f32 v71, v94, v95
    s_waitcnt lgkmcnt(0)
    v_mfma_f32_32x32x16_bf16 v[80:95], v[32:35], v[16:19], 0
    v_exp_f32 v96, v96
    v_exp_f32 v97, v97
    v_exp_f32 v98, v98
    v_exp_f32 v99, v99
    v_mfma_f32_32x32x16_bf16 v[80:95], v[36:39], v[20:23], v[80:95]
    v_exp_f32 v100, v100
    v_exp_f32 v101, v101
    v_exp_f32 v102, v102
    v_exp_f32 v103, v103
    v_cvt_pk_bf16_f32 v72, v96, v97
    v_cvt_pk_bf16_f32 v73, v98, v99
    v_mfma_f32_32x32x16_bf16 v[112:127], v[56:59], v[64:67], v[112:127]
    v_exp_f32 v104, v104
    v_exp_f32 v105, v105
    v_exp_f32 v106, v106
    v_exp_f32 v107, v107
    v_cvt_pk_bf16_f32 v74, v100, v101
    v_cvt_pk_bf16_f32 v75, v102, v103
    v_mfma_f32_32x32x16_bf16 v[112:127], v[60:63], v[68:71], v[112:127]
    v_exp_f32 v108, v108
    v_exp_f32 v109, v109
    v_exp_f32 v110, v110
    v_exp_f32 v111, v111
    v_cvt_pk_bf16_f32 v76, v104, v105
    v_cvt_pk_bf16_f32 v77, v106, v107
    v_cvt_pk_bf16_f32 v78, v108, v109
    v_cvt_pk_bf16_f32 v79, v110, v111
    s_barrier
    ds_read_b128 v[40:43], v4 offset:16384
    ds_read_b128 v[44:47], v4 offset:17408
    ds_read_b128 v[48:51], v4 offset:2048
    ds_read_b128 v[52:55], v4 offset:3072
    v_mfma_f32_32x32x16_bf16 v[96:111], v[32:35], v[24:27], 0
    v_exp_f32 v80, v80
    v_exp_f32 v81, v81
    v_exp_f32 v82, v82
    v_exp_f32 v83, v83
    v_mfma_f32_32x32x16_bf16 v[96:111], v[36:39], v[28:31], v[96:111]
    v_exp_f32 v84, v84
    v_exp_f32 v85, v85
    v_exp_f32 v86, v86
    v_exp_f32 v87, v87
    v_cvt_pk_bf16_f32 v64, v80, v81
    v_cvt_pk_bf16_f32 v65, v82, v83
    v_mfma_f32_32x32x16_bf16 v[128:143], v[56:59], v[72:75], v[128:143]
    v_exp_f32 v88, v88
    v_exp_f32 v89, v89
    v_exp_f32 v90, v90
    v_exp_f32 v91, v91
    v_cvt_pk_bf16_f32 v66, v84, v85
    v_cvt_pk_bf16_f32 v67, v86, v87
    v_mfma_f32_32x32x16_bf16 v[128:143], v[60:63], v[76:79], v[128:143]
    v_exp_f32 v92, v92
    v_exp_f32 v93, v93
    v_exp_f32 v94, v94
    v_exp_f32 v95, v95
    v_cvt_pk_bf16_f32 v68, v88, v89
    v_cvt_pk_bf16_f32 v69, v90, v91
    v_cvt_pk_bf16_f32 v70, v92, v93
    v_cvt_pk_bf16_f32 v71, v94, v95
    s_waitcnt lgkmcnt(0)
    v_mfma_f32_32x32x16_bf16 v[80:95], v[40:43], v[16:19], 0
    v_exp_f32 v96, v96
    v_exp_f32 v97, v97
    v_exp_f32 v98, v98
    v_exp_f32 v99, v99
    v_mfma_f32_32x32x16_bf16 v[80:95], v[44:47], v[20:23], v[80:95]
    v_exp_f32 v100, v100
    v_exp_f32 v101, v101
    v_exp_f32 v102, v102
    v_exp_f32 v103, v103
    v_cvt_pk_bf16_f32 v72, v96, v97
    v_cvt_pk_bf16_f32 v73, v98, v99
    v_mfma_f32_32x32x16_bf16 v[112:127], v[48:51], v[64:67], v[112:127]
    v_exp_f32 v104, v104
    v_exp_f32 v105, v105
    v_exp_f32 v106, v106
    v_exp_f32 v107, v107
    v_cvt_pk_bf16_f32 v74, v100, v101
    v_cvt_pk_bf16_f32 v75, v102, v103
    v_mfma_f32_32x32x16_bf16 v[112:127], v[52:55], v[68:71], v[112:127]
    v_exp_f32 v108, v108
    v_exp_f32 v109, v109
    v_exp_f32 v110, v110
    v_exp_f32 v111, v111
    v_cvt_pk_bf16_f32 v76, v104, v105
    v_cvt_pk_bf16_f32 v77, v106, v107
    v_cvt_pk_bf16_f32 v78, v108, v109
    v_cvt_pk_bf16_f32 v79, v110, v111
    s_barrier
    ds_read_b128 v[32:35], v4 offset:32768
    ds_read_b128 v[36:39], v4 offset:33792
    ds_read_b128 v[56:59], v4 offset:18432
    ds_read_b128 v[60:63], v4 offset:19456
    v_mfma_f32_32x32x16_bf16 v[96:111], v[40:43], v[24:27], 0
    v_exp_f32 v80, v80
    v_exp_f32 v81, v81
    v_exp_f32 v82, v82
    v_exp_f32 v83, v83
    v_mfma_f32_32x32x16_bf16 v[96:111], v[44:47], v[28:31], v[96:111]
    v_exp_f32 v84, v84
    v_exp_f32 v85, v85
    v_exp_f32 v86, v86
    v_exp_f32 v87, v87
    v_cvt_pk_bf16_f32 v64, v80, v81
    v_cvt_pk_bf16_f32 v65, v82, v83
    v_mfma_f32_32x32x16_bf16 v[128:143], v[48:51], v[72:75], v[128:143]
    v_exp_f32 v88, v88
    v_exp_f32 v89, v89
    v_exp_f32 v90, v90
    v_exp_f32 v91, v91
    v_cvt_pk_bf16_f32 v66, v84, v85
    v_cvt_pk_bf16_f32 v67, v86, v87
    v_mfma_f32_32x32x16_bf16 v[128:143], v[52:55], v[76:79], v[128:143]
    v_exp_f32 v92, v92
    v_exp_f32 v93, v93
    v_exp_f32 v94, v94
    v_exp_f32 v95, v95
    v_cvt_pk_bf16_f32 v68, v88, v89
    v_cvt_pk_bf16_f32 v69, v90, v91
    v_cvt_pk_bf16_f32 v70, v92, v93
    v_cvt_pk_bf16_f32 v71, v94, v95
    s_waitcnt lgkmcnt(0)
    v_mfma_f32_32x32x16_bf16 v[80:95], v[32:35], v[16:19], 0
    v_exp_f32 v96, v96
    v_exp_f32 v97, v97
    v_exp_f32 v98, v98
    v_exp_f32 v99, v99
    v_mfma_f32_32x32x16_bf16 v[80:95], v[36:39], v[20:23], v[80:95]
    v_exp_f32 v100, v100
    v_exp_f32 v101, v101
    v_exp_f32 v102, v102
    v_exp_f32 v103, v103
    v_cvt_pk_bf16_f32 v72, v96, v97
    v_cvt_pk_bf16_f32 v73, v98, v99
    v_mfma_f32_32x32x16_bf16 v[112:127], v[56:59], v[64:67], v[112:127]
    v_exp_f32 v104, v104
    v_exp_f32 v105, v105
    v_exp_f32 v106, v106
    v_exp_f32 v107, v107
    v_cvt_pk_bf16_f32 v74, v100, v101
    v_cvt_pk_bf16_f32 v75, v102, v103
    v_mfma_f32_32x32x16_bf16 v[112:127], v[60:63], v[68:71], v[112:127]
    v_exp_f32 v108, v108
    v_exp_f32 v109, v109
    v_exp_f32 v110, v110
    v_exp_f32 v111, v111
    v_cvt_pk_bf16_f32 v76, v104, v105
    v_cvt_pk_bf16_f32 v77, v106, v107
    v_cvt_pk_bf16_f32 v78, v108, v109
    v_cvt_pk_bf16_f32 v79, v110, v111
    s_barrier
    ds_read_b128 v[40:43], v4 offset:49152
    ds_read_b128 v[44:47], v4 offset:50176
    ds_read_b128 v[48:51], v4 offset:34816
    ds_read_b128 v[52:55], v4 offset:35840
    v_mfma_f32_32x32x16_bf16 v[96:111], v[32:35], v[24:27], 0
    v_exp_f32 v80, v80
    v_exp_f32 v81, v81
    v_exp_f32 v82, v82
    v_exp_f32 v83, v83
    v_mfma_f32_32x32x16_bf16 v[96:111], v[36:39], v[28:31], v[96:111]
    v_exp_f32 v84, v84
    v_exp_f32 v85, v85
    v_exp_f32 v86, v86
    v_exp_f32 v87, v87
    v_cvt_pk_bf16_f32 v64, v80, v81
    v_cvt_pk_bf16_f32 v65, v82, v83
    v_mfma_f32_32x32x16_bf16 v[128:143], v[56:59], v[72:75], v[128:143]
    v_exp_f32 v88, v88
    v_exp_f32 v89, v89
    v_exp_f32 v90, v90
    v_exp_f32 v91, v91
    v_cvt_pk_bf16_f32 v66, v84, v85
    v_cvt_pk_bf16_f32 v67, v86, v87
    v_mfma_f32_32x32x16_bf16 v[128:143], v[60:63], v[76:79], v[128:143]
    v_exp_f32 v92, v92
    v_exp_f32 v93, v93
    v_exp_f32 v94, v94
    v_exp_f32 v95, v95
    v_cvt_pk_bf16_f32 v68, v88, v89
    v_cvt_pk_bf16_f32 v69, v90, v91
    v_cvt_pk_bf16_f32 v70, v92, v93
    v_cvt_pk_bf16_f32 v71, v94, v95
    s_waitcnt lgkmcnt(0)
    v_mfma_f32_32x32x16_bf16 v[80:95], v[40:43], v[16:19], 0
    v_exp_f32 v96, v96
    v_exp_f32 v97, v97
    v_exp_f32 v98, v98
    v_exp_f32 v99, v99
    v_mfma_f32_32x32x16_bf16 v[80:95], v[44:47], v[20:23], v[80:95]
    v_exp_f32 v100, v100
    v_exp_f32 v101, v101
    v_exp_f32 v102, v102
    v_exp_f32 v103, v103
    v_cvt_pk_bf16_f32 v72, v96, v97
    v_cvt_pk_bf16_f32 v73, v98, v99
    v_mfma_f32_32x32x16_bf16 v[112:127], v[48:51], v[64:67], v[112:127]
    v_exp_f32 v104, v104
    v_exp_f32 v105, v105
    v_exp_f32 v106, v106
    v_exp_f32 v107, v107
    v_cvt_pk_bf16_f32 v74, v100, v101
    v_cvt_pk_bf16_f32 v75, v102, v103
    v_mfma_f32_32x32x16_bf16 v[112:127], v[52:55], v[68:71], v[112:127]
    v_exp_f32 v108, v108
    v_exp_f32 v109, v109
    v_exp_f32 v110, v110
    v_exp_f32 v111, v111
    v_cvt_pk_bf16_f32 v76, v104, v105
    v_cvt_pk_bf16_f32 v77, v106, v107
    v_cvt_pk_bf16_f32 v78, v108, v109
    v_cvt_pk_bf16_f32 v79, v110, v111
    s_barrier
    ds_read_b128 v[32:35], v3 offset:0
    ds_read_b128 v[36:39], v3 offset:1024
    ds_read_b128 v[56:59], v4 offset:51200
    ds_read_b128 v[60:63], v4 offset:52224
    v_mfma_f32_32x32x16_bf16 v[96:111], v[40:43], v[24:27], 0
    v_exp_f32 v80, v80
    v_exp_f32 v81, v81
    v_exp_f32 v82, v82
    v_exp_f32 v83, v83
    v_mfma_f32_32x32x16_bf16 v[96:111], v[44:47], v[28:31], v[96:111]
    v_exp_f32 v84, v84
    v_exp_f32 v85, v85
    v_exp_f32 v86, v86
    v_exp_f32 v87, v87
    v_cvt_pk_bf16_f32 v64, v80, v81
    v_cvt_pk_bf16_f32 v65, v82, v83
    v_mfma_f32_32x32x16_bf16 v[128:143], v[48:51], v[72:75], v[128:143]
    v_exp_f32 v88, v88
    v_exp_f32 v89, v89
    v_exp_f32 v90, v90
    v_exp_f32 v91, v91
    v_cvt_pk_bf16_f32 v66, v84, v85
    v_cvt_pk_bf16_f32 v67, v86, v87
    v_mfma_f32_32x32x16_bf16 v[128:143], v[52:55], v[76:79], v[128:143]
    v_exp_f32 v92, v92
    v_exp_f32 v93, v93
    v_exp_f32 v94, v94
    v_exp_f32 v95, v95
    v_cvt_pk_bf16_f32 v68, v88, v89
    v_cvt_pk_bf16_f32 v69, v90, v91
    v_cvt_pk_bf16_f32 v70, v92, v93
    v_cvt_pk_bf16_f32 v71, v94, v95
    s_waitcnt lgkmcnt(0)
    v_mfma_f32_32x32x16_bf16 v[80:95], v[32:35], v[16:19], 0
    v_exp_f32 v96, v96
    v_exp_f32 v97, v97
    v_exp_f32 v98, v98
    v_exp_f32 v99, v99
    v_mfma_f32_32x32x16_bf16 v[80:95], v[36:39], v[20:23], v[80:95]
    v_exp_f32 v100, v100
    v_exp_f32 v101, v101
    v_exp_f32 v102, v102
    v_exp_f32 v103, v103
    v_cvt_pk_bf16_f32 v72, v96, v97
    v_cvt_pk_bf16_f32 v73, v98, v99
    v_mfma_f32_32x32x16_bf16 v[112:127], v[56:59], v[64:67], v[112:127]
    v_exp_f32 v104, v104
    v_exp_f32 v105, v105
    v_exp_f32 v106, v106
    v_exp_f32 v107, v107
    v_cvt_pk_bf16_f32 v74, v100, v101
    v_cvt_pk_bf16_f32 v75, v102, v103
    v_mfma_f32_32x32x16_bf16 v[112:127], v[60:63], v[68:71], v[112:127]
    v_exp_f32 v108, v108
    v_exp_f32 v109, v109
    v_exp_f32 v110, v110
    v_exp_f32 v111, v111
    v_cvt_pk_bf16_f32 v76, v104, v105
    v_cvt_pk_bf16_f32 v77, v106, v107
    v_cvt_pk_bf16_f32 v78, v108, v109
    v_cvt_pk_bf16_f32 v79, v110, v111
    s_add_u32 s25, s30, 8
    s_cmp_eq_u32 s25, s31
    s_cbranch_scc1 L2_done
    s_add_u32 s30, s30, 8
    s_branch L2_loop
L2_done:
    v_mfma_f32_32x32x16_bf16 v[128:143], v[56:59], v[72:75], v[128:143]
    v_mfma_f32_32x32x16_bf16 v[128:143], v[60:63], v[76:79], v[128:143]
    s_nop 1
    v_pk_add_f32 v[80:81], v[112:113], v[114:115]
    v_pk_add_f32 v[80:81], v[80:81], v[116:117]
    v_pk_add_f32 v[80:81], v[80:81], v[118:119]
    v_pk_add_f32 v[80:81], v[80:81], v[120:121]
    v_pk_add_f32 v[80:81], v[80:81], v[122:123]
    v_pk_add_f32 v[80:81], v[80:81], v[124:125]
    v_pk_add_f32 v[80:81], v[80:81], v[126:127]
    v_cmp_nlt_f32 s[36:37], v124, v154
    s_nop 3
    v_pk_add_f32 v[80:81], v[80:81], v[128:129]
    v_pk_add_f32 v[80:81], v[80:81], v[130:131]
    v_pk_add_f32 v[80:81], v[80:81], v[132:133]
    v_pk_add_f32 v[80:81], v[80:81], v[134:135]
    v_pk_add_f32 v[80:81], v[80:81], v[136:137]
    v_pk_add_f32 v[80:81], v[80:81], v[138:139]
    v_pk_add_f32 v[80:81], v[80:81], v[140:141]
    v_pk_add_f32 v[80:81], v[80:81], v[142:143]
    v_cmp_nlt_f32 vcc, v140, v154
    s_or_b64 s[36:37], s[36:37], vcc
    v_add_f32 v80, v80, v81
    v_cmp_class_f32 vcc, v80, v155
    s_or_b64 s[36:37], s[36:37], vcc
    s_cmp_lg_u64 s[36:37], 0
    s_cbranch_scc1 L2_fallback
L2_pub:
    ds_write_b128 v148, v[112:115] offset:0
    ds_write_b128 v148, v[116:119] offset:1024
    ds_write_b128 v148, v[120:123] offset:2048
    ds_write_b128 v148, v[124:127] offset:3072
    ds_write_b128 v148, v[128:131] offset:4096
    ds_write_b128 v148, v[132:135] offset:5120
    ds_write_b128 v148, v[136:139] offset:6144
    ds_write_b128 v148, v[140:143] offset:7168
    ds_write_b32 v149, v124
    ds_write_b32 v149, v5 offset:256
    ds_write_b32 v149, v140 offset:512
    ds_write_b32 v149, v6 offset:768
    s_waitcnt lgkmcnt(0)
    s_barrier
    ds_read_b32 v32, v152 offset:0
    ds_read_b32 v36, v152 offset:256
    ds_read_b32 v33, v152 offset:2048
    ds_read_b32 v37, v152 offset:2304
    ds_read_b32 v34, v152 offset:4096
    ds_read_b32 v38, v152 offset:4352
    ds_read_b32 v35, v152 offset:6144
    ds_read_b32 v39, v152 offset:6400
    ds_read_b128 v[80:83], v150 offset:0
    ds_read_b128 v[84:87], v151 offset:0
    ds_read_b128 v[88:91], v150 offset:16384
    ds_read_b128 v[92:95], v151 offset:16384
    ds_read_b128 v[96:99], v150 offset:32768
    ds_read_b128 v[100:103], v151 offset:32768
    ds_read_b128 v[104:107], v150 offset:49152
    ds_read_b128 v[108:111], v151 offset:49152
    s_waitcnt lgkmcnt(8)
    v_max3_f32 v14, v36, v37, v38
    v_max_f32 v14, v14, v39
    v_sub_f32 v36, v36, v14
    v_sub_f32 v37, v37, v14
    v_sub_f32 v38, v38, v14
    v_sub_f32 v39, v39, v14
    v_exp_f32 v36, v36
    v_exp_f32 v37, v37
    v_exp_f32 v38, v38
    v_exp_f32 v39, v39
    s_nop 0
    v_mul_f32 v15, v36, v32
    v_fmac_f32 v15, v37, v33
    v_fmac_f32 v15, v38, v34
    v_fmac_f32 v15, v39, v35
    v_rcp_f32 v15, v15
    s_nop 0
    v_mul_f32 v36, v36, v15
    v_mul_f32 v37, v37, v15
    v_mul_f32 v38, v38, v15
    v_mul_f32 v39, v39, v15
    s_waitcnt lgkmcnt(0)
    v_mul_f32 v112, v36, v80
    v_fmac_f32 v112, v37, v88
    v_fmac_f32 v112, v38, v96
    v_fmac_f32 v112, v39, v104
    v_mul_f32 v113, v36, v81
    v_fmac_f32 v113, v37, v89
    v_fmac_f32 v113, v38, v97
    v_fmac_f32 v113, v39, v105
    v_mul_f32 v114, v36, v82
    v_fmac_f32 v114, v37, v90
    v_fmac_f32 v114, v38, v98
    v_fmac_f32 v114, v39, v106
    v_mul_f32 v115, v36, v83
    v_fmac_f32 v115, v37, v91
    v_fmac_f32 v115, v38, v99
    v_fmac_f32 v115, v39, v107
    v_mul_f32 v116, v36, v84
    v_fmac_f32 v116, v37, v92
    v_fmac_f32 v116, v38, v100
    v_fmac_f32 v116, v39, v108
    v_mul_f32 v117, v36, v85
    v_fmac_f32 v117, v37, v93
    v_fmac_f32 v117, v38, v101
    v_fmac_f32 v117, v39, v109
    v_mul_f32 v118, v36, v86
    v_fmac_f32 v118, v37, v94
    v_fmac_f32 v118, v38, v102
    v_fmac_f32 v118, v39, v110
    v_mul_f32 v119, v36, v87
    v_fmac_f32 v119, v37, v95
    v_fmac_f32 v119, v38, v103
    v_fmac_f32 v119, v39, v111
    v_cvt_pk_bf16_f32 v64, v112, v113
    v_cvt_pk_bf16_f32 v65, v114, v115
    v_cvt_pk_bf16_f32 v66, v116, v117
    v_cvt_pk_bf16_f32 v67, v118, v119
    s_mov_b64 exec, s[38:39]
    buffer_store_dwordx4 v[64:67], v153, s[8:11], s50 offen sc1
    s_not_b64 exec, exec
    s_cbranch_execz L2_nh
    s_cmp_eq_u32 s51, 0
    s_cbranch_scc1 L2_he
    buffer_store_dwordx2 v[66:67], v153, s[8:11], s50 offen offset:8 sc1
    s_branch L2_nh
L2_he:
    buffer_store_dwordx2 v[64:65], v153, s[8:11], s50 offen sc1
L2_nh:
    s_mov_b64 exec, -1
    s_waitcnt vmcnt(0)
    s_barrier
    s_cmp_lg_u32 s22, 0
    s_cbranch_scc1 L2_nf
    s_lshl_b32 s25, s2, 7
    s_add_u32 s25, s25, 14548992
    v_mov_b32 v8, s25
    s_mov_b64 exec, 1
    v_mov_b32 v10, s96
    v_mov_b32 v11, s97
    buffer_store_dwordx2 v[10:11], v8, s[8:11], 0 offen sc1
    s_mov_b64 exec, -1
L2_nf:
    s_branch L3_entry
L2_fallback:
    s_mov_b32 exec_lo, 0
    v_mov_b32 v22, 0
    v_mov_b32 v23, 0
    v_mov_b32 v30, 0
    v_mov_b32 v31, 0
    s_mov_b32 exec_lo, -1
    s_mov_b32 s25, 0
    s_lshl_b32 s26, s31, 12
L2_maxloop:
    buffer_load_dwordx4 v[32:35], v2, s[12:15], s25 offen sc1
    buffer_load_dwordx4 v[36:39], v2, s[12:15], s25 offen offset:1024 sc1
    s_waitcnt vmcnt(0)
    v_mfma_f32_32x32x16_bf16 v[80:95], v[32:35], v[16:19], 0
    v_mfma_f32_32x32x16_bf16 v[80:95], v[36:39], v[20:23], v[80:95]
    v_mfma_f32_32x32x16_bf16 v[96:111], v[32:35], v[24:27], 0
    v_mfma_f32_32x32x16_bf16 v[96:111], v[36:39], v[28:31], v[96:111]
    s_nop 9
    v_max3_f32 v5, v80, v81, v5
    v_max3_f32 v5, v82, v83, v5
    v_max3_f32 v5, v84, v85, v5
    v_max3_f32 v5, v86, v87, v5
    v_max3_f32 v5, v88, v89, v5
    v_max3_f32 v5, v90, v91, v5
    v_max3_f32 v5, v92, v93, v5
    v_max3_f32 v5, v94, v95, v5
    v_max3_f32 v6, v96, v97, v6
    v_max3_f32 v6, v98, v99, v6
    v_max3_f32 v6, v100, v101, v6
    v_max3_f32 v6, v102, v103, v6
    v_max3_f32 v6, v104, v105, v6
    v_max3_f32 v6, v106, v107, v6
    v_max3_f32 v6, v108, v109, v6
    v_max3_f32 v6, v110, v111, v6
    s_add_u32 s25, s25, 4096
    s_cmp_lt_u32 s25, s26
    s_cbranch_scc1 L2_maxloop
    v_mov_b32 v8, v5
    v_mov_b32 v9, v5
    v_mov_b32 v10, v6
    v_mov_b32 v11, v6
    s_nop 1
    v_permlane32_swap_b32 v8, v9
    v_permlane32_swap_b32 v10, v11
    v_max_f32 v5, v8, v9
    v_max_f32 v6, v10, v11
    s_mov_b32 exec_lo, 0
    v_sub_f32 v8, 0, v5
    v_and_b32 v9, 0xffff0000, v8
    v_sub_f32 v8, v8, v9
    v_and_b32 v10, 0xffff0000, v8
    v_sub_f32 v8, v8, v10
    v_perm_b32 v22, v10, v9, s34
    v_lshrrev_b32 v23, 16, v8
    v_sub_f32 v8, 0, v6
    v_and_b32 v9, 0xffff0000, v8
    v_sub_f32 v8, v8, v9
    v_and_b32 v10, 0xffff0000, v8
    v_sub_f32 v8, v8, v10
    v_perm_b32 v30, v10, v9, s34
    v_lshrrev_b32 v31, 16, v8
    s_mov_b32 exec_lo, -1
    s_nop 3
    v_mov_b32 v112, 0
    v_mov_b32 v113, 0
    v_mov_b32 v114, 0
    v_mov_b32 v115, 0
    v_mov_b32 v116, 0
    v_mov_b32 v117, 0
    v_mov_b32 v118, 0
    v_mov_b32 v119, 0
    v_mov_b32 v120, 0
    v_mov_b32 v121, 0
    v_mov_b32 v122, 0
    v_mov_b32 v123, 0
    v_mov_b32 v124, 0
    v_mov_b32 v125, 0
    v_mov_b32 v126, 0
    v_mov_b32 v127, 0
    v_mov_b32 v128, 0
    v_mov_b32 v129, 0
    v_mov_b32 v130, 0
    v_mov_b32 v131, 0
    v_mov_b32 v132, 0
    v_mov_b32 v133, 0
    v_mov_b32 v134, 0
    v_mov_b32 v135, 0
    v_mov_b32 v136, 0
    v_mov_b32 v137, 0
    v_mov_b32 v138, 0
    v_mov_b32 v139, 0
    v_mov_b32 v140, 0
    v_mov_b32 v141, 0
    v_mov_b32 v142, 0
    v_mov_b32 v143, 0
    s_mov_b32 s25, 0
L2_slow:
    buffer_load_dwordx4 v[32:35], v2, s[12:15], s25 offen offset:0 sc1
    buffer_load_dwordx4 v[48:51], v2, s[12:15], s25 offen offset:2048 sc1
    buffer_load_dwordx4 v[36:39], v2, s[12:15], s25 offen offset:1024 sc1
    buffer_load_dwordx4 v[52:55], v2, s[12:15], s25 offen offset:3072 sc1
    s_waitcnt vmcnt(0)
    v_mfma_f32_32x32x16_bf16 v[80:95], v[32:35], v[16:19], 0
    v_mfma_f32_32x32x16_bf16 v[80:95], v[36:39], v[20:23], v[80:95]
    v_mfma_f32_32x32x16_bf16 v[96:111], v[32:35], v[24:27], 0
    v_mfma_f32_32x32x16_bf16 v[96:111], v[36:39], v[28:31], v[96:111]
    s_nop 15
    v_exp_f32 v80, v80
    v_exp_f32 v81, v81
    v_exp_f32 v82, v82
    v_exp_f32 v83, v83
    v_exp_f32 v84, v84
    v_exp_f32 v85, v85
    v_exp_f32 v86, v86
    v_exp_f32 v87, v87
    v_exp_f32 v88, v88
    v_exp_f32 v89, v89
    v_exp_f32 v90, v90
    v_exp_f32 v91, v91
    v_exp_f32 v92, v92
    v_exp_f32 v93, v93
    v_exp_f32 v94, v94
    v_exp_f32 v95, v95
    v_exp_f32 v96, v96
    v_exp_f32 v97, v97
    v_exp_f32 v98, v98
    v_exp_f32 v99, v99
    v_exp_f32 v100, v100
    v_exp_f32 v101, v101
    v_exp_f32 v102, v102
    v_exp_f32 v103, v103
    v_exp_f32 v104, v104
    v_exp_f32 v105, v105
    v_exp_f32 v106, v106
    v_exp_f32 v107, v107
    v_exp_f32 v108, v108
    v_exp_f32 v109, v109
    v_exp_f32 v110, v110
    v_exp_f32 v111, v111
    s_nop 0
    v_cvt_pk_bf16_f32 v64, v80, v81
    v_cvt_pk_bf16_f32 v65, v82, v83
    v_cvt_pk_bf16_f32 v66, v84, v85
    v_cvt_pk_bf16_f32 v67, v86, v87
    v_cvt_pk_bf16_f32 v68, v88, v89
    v_cvt_pk_bf16_f32 v69, v90, v91
    v_cvt_pk_bf16_f32 v70, v92, v93
    v_cvt_pk_bf16_f32 v71, v94, v95
    v_cvt_pk_bf16_f32 v72, v96, v97
    v_cvt_pk_bf16_f32 v73, v98, v99
    v_cvt_pk_bf16_f32 v74, v100, v101
    v_cvt_pk_bf16_f32 v75, v102, v103
    v_cvt_pk_bf16_f32 v76, v104, v105
    v_cvt_pk_bf16_f32 v77, v106, v107
    v_cvt_pk_bf16_f32 v78, v108, v109
    v_cvt_pk_bf16_f32 v79, v110, v111
    s_nop 1
    v_mfma_f32_32x32x16_bf16 v[112:127], v[48:51], v[64:67], v[112:127]
    v_mfma_f32_32x32x16_bf16 v[112:127], v[52:55], v[68:71], v[112:127]
    v_mfma_f32_32x32x16_bf16 v[128:143], v[48:51], v[72:75], v[128:143]
    v_mfma_f32_32x32x16_bf16 v[128:143], v[52:55], v[76:79], v[128:143]
    s_add_u32 s25, s25, 4096
    s_cmp_lt_u32 s25, s26
    s_nop 15
    s_cbranch_scc1 L2_slow
    s_branch L2_pub
L2_loader:
    s_sub_u32 s25, s22, 8
    s_lshl_b32 s33, s25, 13
    s_lshl_b32 s26, s20, 18
    s_lshl_b32 s25, s25, 17
    s_add_u32 s25, s25, s26
    s_add_u32 s25, s25, 2097152
    s_load_dwordx2 s[44:45], s[0:1], 16
    s_getpc_b64 s[46:47]
    s_add_u32 s46, s46, ftab2@rel32@lo+4
    s_addc_u32 s47, s47, ftab2@rel32@hi+12
    s_lshr_b32 s27, s2, 3
    s_lshl_b32 s27, s27, 1
    s_add_u32 s27, s27, s22
    s_sub_u32 s27, s27, 8
    s_mul_i32 s27, s27, 6272
    v_add_u32 v14, s27, v2
    v_add_u32 v15, 4096, v14
    s_waitcnt lgkmcnt(0)
    s_add_u32 s12, s4, s25
    s_addc_u32 s13, s5, 0
    s_and_b32 s13, s13, 0xffff
    s_mov_b32 s14, 131072
    s_mov_b32 s15, 0x20000
    s_mov_b32 s8, s4
    s_and_b32 s9, s5, 0xffff
    s_mov_b32 s10, 16777216
    s_mov_b32 s11, 0x20000
    s_lshr_b32 s28, s20, 2
    s_lshl_b32 s28, s28, 4
    v_bfe_u32 v51, v1, 4, 1
    v_lshlrev_b32 v51, 6, v51
    v_and_b32 v52, 15, v1
    v_add3_u32 v56, v51, v52, 64
    v_and_b32 v52, 12, v1
    v_add3_u32 v51, v51, v52, 64
    v_mov_b32 v52, s21
    v_cmp_gt_u32 vcc, 32, v1
    s_nop 1
    v_cndmask_b32 v51, v52, v51, vcc
    v_add_u32 v51, s28, v51
    v_lshlrev_b32 v51, 7, v51
    v_add_u32 v51, 14585856, v51
    v_cndmask_b32 v56, v52, v56, vcc
    v_add_u32 v56, s28, v56
    v_lshlrev_b32 v56, 7, v56
    v_add_u32 v56, 14585856, v56
    s_cmp_lg_u32 s22, 8
    s_cbranch_scc1 L2_l9
    s_mul_i32 s97, s96, 0x9e3779b1
    s_xor_b32 s97, s97, 0x5bd1e995
    v_mov_b32 v48, s96
    v_mov_b32 v49, s97
    s_bfe_u32 s26, s2, 0x20001
    s_lshl_b32 s26, s26, 6
    s_lshr_b32 s28, s2, 6
    s_lshl_b32 s28, s28, 4
    s_add_u32 s26, s26, s28
    s_and_b32 s28, s2, 1
    s_lshl_b32 s28, s28, 3
    s_add_u32 s26, s26, s28
    s_bfe_u32 s28, s2, 0x30003
    s_add_u32 s26, s26, s28
    s_lshl_b32 s26, s26, 7
    s_add_u32 s26, s26, 14585856
    v_mov_b32 v50, s26
    v_mov_b32 v53, 139456
    s_barrier
    s_mov_b64 exec, 1
    buffer_store_dwordx2 v[48:49], v50, s[8:11], 0 offen sc1
    ds_write_b64 v53, v[48:49]
    s_mov_b64 exec, -1
    s_mov_b32 s29, 0
Lpp1:
    buffer_load_dwordx2 v[16:17], v51, s[8:11], 0 offen sc1
    s_waitcnt vmcnt(0)
    v_cmp_ne_u64 vcc, v[16:17], v[48:49]
    s_cbranch_vccz Lpd1
    s_add_u32 s29, s29, 1
    s_cmp_lt_u32 s29, 0x80000
    s_cbranch_scc1 Lpp1
Lpd1:
L2_pd1:
    s_waitcnt lgkmcnt(0)
    s_barrier
    s_branch L2_l8
L2_l9:
    s_barrier
    s_waitcnt vmcnt(0)
    v_mov_b32 v53, 139456
    s_lshl_b32 s26, s2, 5
    s_add_u32 s26, s26, 14651392
    v_mov_b32 v50, s26
    s_barrier
    ds_read_b64 v[48:49], v53
L2_l8:
    s_add_u32 m0, s33, 0
    s_mov_b32 s32, 0
    buffer_load_dwordx4 v2, s[12:15], s32 offen offset:0 sc1 lds
    buffer_load_dwordx4 v2, s[12:15], s32 offen offset:1024 sc1 lds
    buffer_load_dwordx4 v2, s[12:15], s32 offen offset:2048 sc1 lds
    buffer_load_dwordx4 v2, s[12:15], s32 offen offset:3072 sc1 lds
    s_add_u32 m0, s33, 4096
    s_mov_b32 s32, 65536
    buffer_load_dwordx4 v2, s[12:15], s32 offen offset:0 sc1 lds
    buffer_load_dwordx4 v2, s[12:15], s32 offen offset:1024 sc1 lds
    buffer_load_dwordx4 v2, s[12:15], s32 offen offset:2048 sc1 lds
    buffer_load_dwordx4 v2, s[12:15], s32 offen offset:3072 sc1 lds
    s_add_u32 m0, s33, 16384
    s_mov_b32 s32, 4096
    buffer_load_dwordx4 v2, s[12:15], s32 offen offset:0 sc1 lds
    buffer_load_dwordx4 v2, s[12:15], s32 offen offset:1024 sc1 lds
    buffer_load_dwordx4 v2, s[12:15], s32 offen offset:2048 sc1 lds
    buffer_load_dwordx4 v2, s[12:15], s32 offen offset:3072 sc1 lds
    s_add_u32 m0, s33, 20480
    s_mov_b32 s32, 69632
    buffer_load_dwordx4 v2, s[12:15], s32 offen offset:0 sc1 lds
    buffer_load_dwordx4 v2, s[12:15], s32 offen offset:1024 sc1 lds
    buffer_load_dwordx4 v2, s[12:15], s32 offen offset:2048 sc1 lds
    buffer_load_dwordx4 v2, s[12:15], s32 offen offset:3072 sc1 lds
    s_bitcmp1_b32 s2, 2
    s_cselect_b32 s40, s46, s44
    s_cselect_b32 s41, s47, s45
    s_and_b32 s41, s41, 0xffff
    s_mov_b32 s42, 401408
    s_mov_b32 s43, 0x20000
    s_add_u32 m0, s33, 32768
    s_mov_b32 s32, 8192
    buffer_load_dwordx4 v2, s[12:15], s32 offen offset:0 sc1 lds
    buffer_load_dwordx4 v2, s[12:15], s32 offen offset:1024 sc1 lds
    buffer_load_dwordx4 v2, s[12:15], s32 offen offset:2048 sc1 lds
    buffer_load_dwordx4 v2, s[12:15], s32 offen offset:3072 sc1 lds
    s_add_u32 m0, s33, 36864
    s_mov_b32 s32, 73728
    buffer_load_dwordx4 v2, s[12:15], s32 offen offset:0 sc1 lds
    buffer_load_dwordx4 v2, s[12:15], s32 offen offset:1024 sc1 lds
    buffer_load_dwordx4 v2, s[12:15], s32 offen offset:2048 sc1 lds
    buffer_load_dwordx4 v2, s[12:15], s32 offen offset:3072 sc1 lds
    s_add_u32 m0, s33, 49152
    s_mov_b32 s32, 12288
    buffer_load_dwordx4 v2, s[12:15], s32 offen offset:0 sc1 lds
    buffer_load_dwordx4 v2, s[12:15], s32 offen offset:1024 sc1 lds
    buffer_load_dwordx4 v2, s[12:15], s32 offen offset:2048 sc1 lds
    buffer_load_dwordx4 v2, s[12:15], s32 offen offset:3072 sc1 lds
    s_add_u32 m0, s33, 53248
    s_mov_b32 s32, 77824
    buffer_load_dwordx4 v2, s[12:15], s32 offen offset:0 sc1 lds
    buffer_load_dwordx4 v2, s[12:15], s32 offen offset:1024 sc1 lds
    buffer_load_dwordx4 v2, s[12:15], s32 offen offset:2048 sc1 lds
    buffer_load_dwordx4 v2, s[12:15], s32 offen offset:3072 sc1 lds
    s_waitcnt vmcnt(16)
    s_barrier
    buffer_load_dwordx2 v[54:55], v56, s[8:11], 0 offen sc1
    v_lshl_or_b32 v64, v72, 16, v64
    v_lshl_or_b32 v65, v73, 16, v65
    v_lshl_or_b32 v66, v74, 16, v66
    v_lshl_or_b32 v67, v75, 16, v67
    v_lshl_or_b32 v68, v76, 16, v68
    v_lshl_or_b32 v69, v77, 16, v69
    v_lshl_or_b32 v70, v78, 16, v70
    v_lshl_or_b32 v71, v79, 16, v71
    ds_bpermute_b32 v80, v100, v64 offset:0
    ds_bpermute_b32 v81, v100, v65 offset:0
    ds_bpermute_b32 v82, v100, v66 offset:0
    ds_bpermute_b32 v83, v100, v67 offset:0
    ds_bpermute_b32 v84, v100, v68 offset:0
    ds_bpermute_b32 v85, v100, v69 offset:0
    ds_bpermute_b32 v86, v100, v70 offset:0
    ds_bpermute_b32 v87, v100, v71 offset:0
    ds_bpermute_b32 v88, v100, v64 offset:32
    ds_bpermute_b32 v89, v100, v65 offset:32
    ds_bpermute_b32 v90, v100, v66 offset:32
    ds_bpermute_b32 v91, v100, v67 offset:32
    ds_bpermute_b32 v92, v100, v68 offset:32
    ds_bpermute_b32 v93, v100, v69 offset:32
    ds_bpermute_b32 v94, v100, v70 offset:32
    ds_bpermute_b32 v95, v100, v71 offset:32
    s_waitcnt lgkmcnt(0)
    v_cndmask_b32 v80, v80, v84, s[86:87]
    v_cndmask_b32 v81, v81, v85, s[86:87]
    v_cndmask_b32 v82, v82, v86, s[86:87]
    v_cndmask_b32 v83, v83, v87, s[86:87]
    v_cndmask_b32 v88, v88, v92, s[86:87]
    v_cndmask_b32 v89, v89, v93, s[86:87]
    v_cndmask_b32 v90, v90, v94, s[86:87]
    v_cndmask_b32 v91, v91, v95, s[86:87]
    s_waitcnt vmcnt(9)
    s_barrier
    s_waitcnt vmcnt(0) lgkmcnt(0)
    s_mov_b32 s29, 0
L2_pl2:
    v_cmp_ne_u64 vcc, v[54:55], v[48:49]
    s_cmp_gt_u32 s29, 0x100000
    s_cbranch_scc1 L2_pd2
    s_cbranch_vccz L2_pd2
    buffer_load_dwordx2 v[54:55], v56, s[8:11], 0 offen sc1
    s_add_u32 s29, s29, 1
    s_waitcnt vmcnt(0)
    s_branch L2_pl2
L2_pd2:
    s_add_u32 m0, s33, 65536
    s_mov_b32 s32, 16384
    buffer_load_dwordx4 v2, s[12:15], s32 offen offset:0 sc1 lds
    buffer_load_dwordx4 v2, s[12:15], s32 offen offset:1024 sc1 lds
    buffer_load_dwordx4 v2, s[12:15], s32 offen offset:2048 sc1 lds
    buffer_load_dwordx4 v2, s[12:15], s32 offen offset:3072 sc1 lds
    s_add_u32 m0, s33, 69632
    s_mov_b32 s32, 81920
    buffer_load_dwordx4 v2, s[12:15], s32 offen offset:0 sc1 lds
    buffer_load_dwordx4 v2, s[12:15], s32 offen offset:1024 sc1 lds
    buffer_load_dwordx4 v2, s[12:15], s32 offen offset:2048 sc1 lds
    buffer_load_dwordx4 v2, s[12:15], s32 offen offset:3072 sc1 lds
    s_add_u32 m0, s33, 81920
    s_mov_b32 s32, 20480
    buffer_load_dwordx4 v2, s[12:15], s32 offen offset:0 sc1 lds
    buffer_load_dwordx4 v2, s[12:15], s32 offen offset:1024 sc1 lds
    buffer_load_dwordx4 v2, s[12:15], s32 offen offset:2048 sc1 lds
    buffer_load_dwordx4 v2, s[12:15], s32 offen offset:3072 sc1 lds
    s_add_u32 m0, s33, 86016
    s_mov_b32 s32, 86016
    buffer_load_dwordx4 v2, s[12:15], s32 offen offset:0 sc1 lds
    buffer_load_dwordx4 v2, s[12:15], s32 offen offset:1024 sc1 lds
    buffer_load_dwordx4 v2, s[12:15], s32 offen offset:2048 sc1 lds
    buffer_load_dwordx4 v2, s[12:15], s32 offen offset:3072 sc1 lds
    s_waitcnt vmcnt(17)
    s_barrier
    s_add_u32 m0, s33, 98304
    s_mov_b32 s32, 24576
    buffer_load_dwordx4 v2, s[12:15], s32 offen offset:0 sc1 lds
    buffer_load_dwordx4 v2, s[12:15], s32 offen offset:1024 sc1 lds
    buffer_load_dwordx4 v2, s[12:15], s32 offen offset:2048 sc1 lds
    buffer_load_dwordx4 v2, s[12:15], s32 offen offset:3072 sc1 lds
    s_add_u32 m0, s33, 102400
    s_mov_b32 s32, 90112
    buffer_load_dwordx4 v2, s[12:15], s32 offen offset:0 sc1 lds
    buffer_load_dwordx4 v2, s[12:15], s32 offen offset:1024 sc1 lds
    buffer_load_dwordx4 v2, s[12:15], s32 offen offset:2048 sc1 lds
    buffer_load_dwordx4 v2, s[12:15], s32 offen offset:3072 sc1 lds
    s_add_u32 m0, s33, 114688
    s_mov_b32 s32, 28672
    buffer_load_dwordx4 v2, s[12:15], s32 offen offset:0 sc1 lds
    buffer_load_dwordx4 v2, s[12:15], s32 offen offset:1024 sc1 lds
    buffer_load_dwordx4 v2, s[12:15], s32 offen offset:2048 sc1 lds
    buffer_load_dwordx4 v2, s[12:15], s32 offen offset:3072 sc1 lds
    s_add_u32 m0, s33, 118784
    s_mov_b32 s32, 94208
    buffer_load_dwordx4 v2, s[12:15], s32 offen offset:0 sc1 lds
    buffer_load_dwordx4 v2, s[12:15], s32 offen offset:1024 sc1 lds
    buffer_load_dwordx4 v2, s[12:15], s32 offen offset:2048 sc1 lds
    buffer_load_dwordx4 v2, s[12:15], s32 offen offset:3072 sc1 lds
    s_mov_b64 exec, s[88:89]
    s_cbranch_execz L2_wsl0
    buffer_store_dwordx4 v[80:83], v101, s[8:11], s92 offen sc1
L2_wsl0:
    s_mov_b64 exec, -1
    s_mov_b64 exec, s[90:91]
    s_cbranch_execz L2_wsl1
    buffer_store_dwordx4 v[88:91], v101, s[8:11], s93 offen sc1
L2_wsl1:
    s_mov_b64 exec, -1
    s_waitcnt vmcnt(24)
    s_barrier
    s_add_u32 m0, s33, 0
    s_mov_b32 s32, 32768
    buffer_load_dwordx4 v2, s[12:15], s32 offen offset:0 sc1 lds
    buffer_load_dwordx4 v2, s[12:15], s32 offen offset:1024 sc1 lds
    buffer_load_dwordx4 v2, s[12:15], s32 offen offset:2048 sc1 lds
    buffer_load_dwordx4 v2, s[12:15], s32 offen offset:3072 sc1 lds
    s_add_u32 m0, s33, 4096
    s_mov_b32 s32, 98304
    buffer_load_dwordx4 v2, s[12:15], s32 offen offset:0 sc1 lds
    buffer_load_dwordx4 v2, s[12:15], s32 offen offset:1024 sc1 lds
    buffer_load_dwordx4 v2, s[12:15], s32 offen offset:2048 sc1 lds
    buffer_load_dwordx4 v2, s[12:15], s32 offen offset:3072 sc1 lds
    s_add_u32 m0, s33, 16384
    s_mov_b32 s32, 36864
    buffer_load_dwordx4 v2, s[12:15], s32 offen offset:0 sc1 lds
    buffer_load_dwordx4 v2, s[12:15], s32 offen offset:1024 sc1 lds
    buffer_load_dwordx4 v2, s[12:15], s32 offen offset:2048 sc1 lds
    buffer_load_dwordx4 v2, s[12:15], s32 offen offset:3072 sc1 lds
    s_add_u32 m0, s33, 20480
    s_mov_b32 s32, 102400
    buffer_load_dwordx4 v2, s[12:15], s32 offen offset:0 sc1 lds
    buffer_load_dwordx4 v2, s[12:15], s32 offen offset:1024 sc1 lds
    buffer_load_dwordx4 v2, s[12:15], s32 offen offset:2048 sc1 lds
    buffer_load_dwordx4 v2, s[12:15], s32 offen offset:3072 sc1 lds
    s_waitcnt vmcnt(32)
    s_barrier
    s_add_u32 m0, s33, 32768
    s_mov_b32 s32, 40960
    buffer_load_dwordx4 v2, s[12:15], s32 offen offset:0 sc1 lds
    buffer_load_dwordx4 v2, s[12:15], s32 offen offset:1024 sc1 lds
    buffer_load_dwordx4 v2, s[12:15], s32 offen offset:2048 sc1 lds
    buffer_load_dwordx4 v2, s[12:15], s32 offen offset:3072 sc1 lds
    s_add_u32 m0, s33, 36864
    s_mov_b32 s32, 106496
    buffer_load_dwordx4 v2, s[12:15], s32 offen offset:0 sc1 lds
    buffer_load_dwordx4 v2, s[12:15], s32 offen offset:1024 sc1 lds
    buffer_load_dwordx4 v2, s[12:15], s32 offen offset:2048 sc1 lds
    buffer_load_dwordx4 v2, s[12:15], s32 offen offset:3072 sc1 lds
    s_add_u32 m0, s33, 49152
    s_mov_b32 s32, 45056
    buffer_load_dwordx4 v2, s[12:15], s32 offen offset:0 sc1 lds
    buffer_load_dwordx4 v2, s[12:15], s32 offen offset:1024 sc1 lds
    buffer_load_dwordx4 v2, s[12:15], s32 offen offset:2048 sc1 lds
    buffer_load_dwordx4 v2, s[12:15], s32 offen offset:3072 sc1 lds
    s_add_u32 m0, s33, 53248
    s_mov_b32 s32, 110592
    buffer_load_dwordx4 v2, s[12:15], s32 offen offset:0 sc1 lds
    buffer_load_dwordx4 v2, s[12:15], s32 offen offset:1024 sc1 lds
    buffer_load_dwordx4 v2, s[12:15], s32 offen offset:2048 sc1 lds
    buffer_load_dwordx4 v2, s[12:15], s32 offen offset:3072 sc1 lds
    s_waitcnt vmcnt(32)
    s_barrier
    s_add_u32 m0, s33, 65536
    s_mov_b32 s32, 49152
    buffer_load_dwordx4 v2, s[12:15], s32 offen offset:0 sc1 lds
    buffer_load_dwordx4 v2, s[12:15], s32 offen offset:1024 sc1 lds
    buffer_load_dwordx4 v2, s[12:15], s32 offen offset:2048 sc1 lds
    buffer_load_dwordx4 v2, s[12:15], s32 offen offset:3072 sc1 lds
    s_add_u32 m0, s33, 69632
    s_mov_b32 s32, 114688
    buffer_load_dwordx4 v2, s[12:15], s32 offen offset:0 sc1 lds
    buffer_load_dwordx4 v2, s[12:15], s32 offen offset:1024 sc1 lds
    buffer_load_dwordx4 v2, s[12:15], s32 offen offset:2048 sc1 lds
    buffer_load_dwordx4 v2, s[12:15], s32 offen offset:3072 sc1 lds
    s_cmp_eq_u32 s22, 8
    s_cbranch_scc1 L2_n1b
    s_mov_b64 exec, 1
    buffer_store_dwordx2 v[48:49], v50, s[8:11], 0 offen sc1
    s_mov_b64 exec, -1
L2_n1b:
    s_waitcnt vmcnt(40)
    s_barrier
    s_add_u32 m0, s33, 81920
    s_mov_b32 s32, 53248
    buffer_load_dwordx4 v2, s[12:15], s32 offen offset:0 sc1 lds
    buffer_load_dwordx4 v2, s[12:15], s32 offen offset:1024 sc1 lds
    buffer_load_dwordx4 v2, s[12:15], s32 offen offset:2048 sc1 lds
    buffer_load_dwordx4 v2, s[12:15], s32 offen offset:3072 sc1 lds
    s_add_u32 m0, s33, 86016
    s_mov_b32 s32, 118784
    buffer_load_dwordx4 v2, s[12:15], s32 offen offset:0 sc1 lds
    buffer_load_dwordx4 v2, s[12:15], s32 offen offset:1024 sc1 lds
    buffer_load_dwordx4 v2, s[12:15], s32 offen offset:2048 sc1 lds
    buffer_load_dwordx4 v2, s[12:15], s32 offen offset:3072 sc1 lds
    s_waitcnt vmcnt(40)
    s_barrier
    s_add_u32 m0, s33, 98304
    s_mov_b32 s32, 57344
    buffer_load_dwordx4 v2, s[12:15], s32 offen offset:0 sc1 lds
    buffer_load_dwordx4 v2, s[12:15], s32 offen offset:1024 sc1 lds
    buffer_load_dwordx4 v2, s[12:15], s32 offen offset:2048 sc1 lds
    buffer_load_dwordx4 v2, s[12:15], s32 offen offset:3072 sc1 lds
    s_add_u32 m0, s33, 102400
    s_mov_b32 s32, 122880
    buffer_load_dwordx4 v2, s[12:15], s32 offen offset:0 sc1 lds
    buffer_load_dwordx4 v2, s[12:15], s32 offen offset:1024 sc1 lds
    buffer_load_dwordx4 v2, s[12:15], s32 offen offset:2048 sc1 lds
    buffer_load_dwordx4 v2, s[12:15], s32 offen offset:3072 sc1 lds
    s_waitcnt vmcnt(40)
    s_barrier
    s_add_u32 m0, s33, 114688
    s_mov_b32 s32, 61440
    buffer_load_dwordx4 v2, s[12:15], s32 offen offset:0 sc1 lds
    buffer_load_dwordx4 v2, s[12:15], s32 offen offset:1024 sc1 lds
    buffer_load_dwordx4 v2, s[12:15], s32 offen offset:2048 sc1 lds
    buffer_load_dwordx4 v2, s[12:15], s32 offen offset:3072 sc1 lds
    s_add_u32 m0, s33, 118784
    s_mov_b32 s32, 126976
    buffer_load_dwordx4 v2, s[12:15], s32 offen offset:0 sc1 lds
    buffer_load_dwordx4 v2, s[12:15], s32 offen offset:1024 sc1 lds
    buffer_load_dwordx4 v2, s[12:15], s32 offen offset:2048 sc1 lds
    buffer_load_dwordx4 v2, s[12:15], s32 offen offset:3072 sc1 lds
    s_waitcnt vmcnt(40)
    s_barrier
    s_waitcnt vmcnt(32)
    s_barrier
    buffer_load_dwordx4 v[16:19], v14, s[40:43], 0 offen offset:0
    buffer_load_dwordx4 v[20:23], v14, s[40:43], 0 offen offset:1024
    buffer_load_dwordx4 v[24:27], v14, s[40:43], 0 offen offset:2048
    buffer_load_dwordx4 v[28:31], v14, s[40:43], 0 offen offset:3072
    buffer_load_dwordx4 v[32:35], v15, s[40:43], 0 offen offset:0
    buffer_load_dwordx4 v[36:39], v15, s[40:43], 0 offen offset:1024
    buffer_load_dwordx4 v[40:43], v15, s[40:43], 0 offen offset:2048
    s_waitcnt vmcnt(31)
    s_barrier
    s_waitcnt vmcnt(23)
    s_barrier
    s_waitcnt vmcnt(15)
    s_barrier
    s_waitcnt vmcnt(7)
    s_barrier
    s_waitcnt vmcnt(7)
    s_barrier
    s_endpgm
L2_fft:
    s_setprio 3
    s_sub_u32 s36, s22, 10
    s_getpc_b64 s[6:7]
    s_add_u32 s6, s6, ffttab@rel32@lo+4
    s_addc_u32 s7, s7, ffttab@rel32@hi+12
    s_mov_b32 s16, s6
    s_and_b32 s17, s7, 0xffff
    s_mov_b32 s18, 63488
    s_mov_b32 s19, 0x20000
    v_lshlrev_b32 v2, 4, v1
    s_mul_i32 s25, s36, 448
    s_add_u32 s25, s25, s2
    s_lshl_b32 s25, s25, 11
    s_add_u32 s26, s25, 6291456
    s_add_u32 s27, s25, 6750208
    s_add_u32 s38, s25, 12582912
    s_add_u32 s39, s25, 13041664
    s_lshl_b32 s28, s2, 1
    s_add_u32 s28, s28, s36
    s_lshl_b32 s28, s28, 12
    s_add_u32 s28, s28, 8388608
    s_mul_i32 s29, s36, 28672
    s_add_u32 s29, s29, 6144
    s_cmp_eq_u32 s2, 0
    s_cselect_b32 s37, 1, 0
    s_cmp_eq_u32 s2, 224
    s_cselect_b32 s37, 1, s37
    s_waitcnt lgkmcnt(0)
    s_mov_b32 s8, s4
    s_and_b32 s9, s5, 0xffff
    s_mov_b32 s10, 16777216
    s_mov_b32 s11, 0x20000
    s_barrier
    s_waitcnt vmcnt(0)
    v_lshl_or_b32 v64, v72, 16, v64
    v_lshl_or_b32 v65, v73, 16, v65
    v_lshl_or_b32 v66, v74, 16, v66
    v_lshl_or_b32 v67, v75, 16, v67
    v_lshl_or_b32 v68, v76, 16, v68
    v_lshl_or_b32 v69, v77, 16, v69
    v_lshl_or_b32 v70, v78, 16, v70
    v_lshl_or_b32 v71, v79, 16, v71
    ds_bpermute_b32 v80, v100, v64 offset:0
    ds_bpermute_b32 v81, v100, v65 offset:0
    ds_bpermute_b32 v82, v100, v66 offset:0
    ds_bpermute_b32 v83, v100, v67 offset:0
    ds_bpermute_b32 v84, v100, v68 offset:0
    ds_bpermute_b32 v85, v100, v69 offset:0
    ds_bpermute_b32 v86, v100, v70 offset:0
    ds_bpermute_b32 v87, v100, v71 offset:0
    ds_bpermute_b32 v88, v100, v64 offset:32
    ds_bpermute_b32 v89, v100, v65 offset:32
    ds_bpermute_b32 v90, v100, v66 offset:32
    ds_bpermute_b32 v91, v100, v67 offset:32
    ds_bpermute_b32 v92, v100, v68 offset:32
    ds_bpermute_b32 v93, v100, v69 offset:32
    ds_bpermute_b32 v94, v100, v70 offset:32
    ds_bpermute_b32 v95, v100, v71 offset:32
    s_waitcnt lgkmcnt(0)
    v_cndmask_b32 v80, v80, v84, s[86:87]
    v_cndmask_b32 v81, v81, v85, s[86:87]
    v_cndmask_b32 v82, v82, v86, s[86:87]
    v_cndmask_b32 v83, v83, v87, s[86:87]
    v_cndmask_b32 v88, v88, v92, s[86:87]
    v_cndmask_b32 v89, v89, v93, s[86:87]
    v_cndmask_b32 v90, v90, v94, s[86:87]
    v_cndmask_b32 v91, v91, v95, s[86:87]
    s_barrier
    v_mov_b32 v8, 139456
    ds_read_b64 v[10:11], v8
    s_waitcnt lgkmcnt(0)
    v_readfirstlane_b32 s96, v10
    v_readfirstlane_b32 s97, v11
    v_mov_b32 v160, v10
    v_mov_b32 v161, v11
    v_lshlrev_b32 v163, 7, v1
    v_add_u32 v163, 14610432, v163
    v_lshlrev_b32 v162, 5, v1
    v_add_u32 v162, 14651392, v162
    s_barrier
    buffer_load_dwordx2 v[32:33], v163, s[8:11], 0 offen sc1
    s_add_u32 s40, s29, 6144
    buffer_load_dwordx4 v[112:115], v2, s[16:19], s40 offen
    s_add_u32 s40, s29, 7168
    buffer_load_dwordx4 v[116:119], v2, s[16:19], s40 offen
    s_add_u32 s40, s29, 8192
    buffer_load_dwordx4 v[120:123], v2, s[16:19], s40 offen
    s_add_u32 s40, s29, 9216
    buffer_load_dwordx4 v[124:127], v2, s[16:19], s40 offen
    s_add_u32 s40, s29, 10240
    buffer_load_dwordx4 v[128:131], v2, s[16:19], s40 offen
    s_add_u32 s40, s29, 11264
    buffer_load_dwordx4 v[132:135], v2, s[16:19], s40 offen
    s_add_u32 s40, s29, 12288
    buffer_load_dwordx4 v[136:139], v2, s[16:19], s40 offen
    s_add_u32 s40, s29, 13312
    buffer_load_dwordx4 v[140:143], v2, s[16:19], s40 offen
    s_barrier
    s_mov_b64 exec, s[88:89]
    s_cbranch_execz L2_wsf0
    buffer_store_dwordx4 v[80:83], v101, s[8:11], s92 offen sc1
L2_wsf0:
    s_mov_b64 exec, -1
    s_mov_b64 exec, s[90:91]
    s_cbranch_execz L2_wsf1
    buffer_store_dwordx4 v[88:91], v101, s[8:11], s93 offen sc1
L2_wsf1:
    s_mov_b64 exec, -1
    s_cmp_ge_u32 s2, 225
    s_cbranch_scc1 L2_f3
    s_barrier
    s_waitcnt vmcnt(8)
    s_mov_b32 s41, 0
L2_fpl:
    v_cmp_ne_u64 vcc, v[32:33], v[160:161]
    s_cmp_gt_u32 s41, 0x100000
    s_cbranch_scc1 L2_fpd
    s_cbranch_vccz L2_fpd
    buffer_load_dwordx2 v[32:33], v163, s[8:11], 0 offen sc1
    s_add_u32 s41, s41, 1
    s_waitcnt vmcnt(0)
    s_branch L2_fpl
L2_fpd:
    buffer_load_dwordx4 v[16:19], v2, s[8:11], s26 offen sc1
    buffer_load_dwordx4 v[20:23], v2, s[8:11], s26 offen offset:1024 sc1
    buffer_load_dwordx4 v[24:27], v2, s[8:11], s27 offen sc1
    buffer_load_dwordx4 v[28:31], v2, s[8:11], s27 offen offset:1024 sc1
    s_add_u32 s40, s29, 0
    buffer_load_dwordx4 v[64:67], v2, s[16:19], s40 offen
    s_add_u32 s40, s29, 1024
    buffer_load_dwordx4 v[68:71], v2, s[16:19], s40 offen
    s_add_u32 s40, s29, 2048
    buffer_load_dwordx4 v[72:75], v2, s[16:19], s40 offen
    s_add_u32 s40, s29, 3072
    buffer_load_dwordx4 v[76:79], v2, s[16:19], s40 offen
    s_barrier
    s_waitcnt vmcnt(8)
    s_add_u32 s40, s29, 4096
    buffer_load_dwordx4 v[80:83], v2, s[16:19], s40 offen
    s_add_u32 s40, s29, 5120
    buffer_load_dwordx4 v[84:87], v2, s[16:19], s40 offen
    s_mov_b32 s40, 0
    buffer_load_dwordx4 v[88:91], v2, s[16:19], s40 offen
    s_mov_b32 s40, 1024
    buffer_load_dwordx4 v[92:95], v2, s[16:19], s40 offen
    s_mov_b32 s40, 2048
    buffer_load_dwordx4 v[96:99], v2, s[16:19], s40 offen
    s_mov_b32 s40, 3072
    buffer_load_dwordx4 v[100:103], v2, s[16:19], s40 offen
    s_mov_b32 s40, 4096
    buffer_load_dwordx4 v[104:107], v2, s[16:19], s40 offen
    s_mov_b32 s40, 5120
    buffer_load_dwordx4 v[108:111], v2, s[16:19], s40 offen
    s_barrier
    s_waitcnt vmcnt(6)
    s_cmp_eq_u32 s37, 0
    s_cbranch_scc1 L2_f1
    v_mov_b32 v24, 0
    v_mov_b32 v25, 0
    v_mov_b32 v26, 0
    v_mov_b32 v27, 0
    v_mov_b32 v28, 0
    v_mov_b32 v29, 0
    v_mov_b32 v30, 0
    v_mov_b32 v31, 0
L2_f1:
    s_nop 1
    v_mfma_f32_32x32x16_bf16 v[32:47], v[16:19], v[64:67], 0
    v_mfma_f32_32x32x16_bf16 v[32:47], v[20:23], v[68:71], v[32:47]
    v_mfma_f32_32x32x16_bf16 v[48:63], v[16:19], v[72:75], 0
    v_mfma_f32_32x32x16_bf16 v[48:63], v[20:23], v[76:79], v[48:63]
    v_mfma_f32_32x32x16_bf16 v[32:47], v[24:27], v[80:83], v[32:47]
    v_mfma_f32_32x32x16_bf16 v[32:47], v[28:31], v[84:87], v[32:47]
    v_mfma_f32_32x32x16_bf16 v[48:63], v[24:27], v[64:67], v[48:63]
    s_barrier
    v_mfma_f32_32x32x16_bf16 v[48:63], v[28:31], v[68:71], v[48:63]
    s_nop 15
    s_waitcnt vmcnt(10)
    v_mul_f32 v8, v48, v128
    v_mul_f32 v10, v48, v112
    v_fma_f32 v8, v32, v112, -v8
    v_fma_f32 v10, v32, v128, v10
    v_mul_f32 v9, v49, v129
    v_mul_f32 v11, v49, v113
    v_fma_f32 v9, v33, v113, -v9
    v_fma_f32 v11, v33, v129, v11
    v_cvt_pk_bf16_f32 v16, v8, v9
    v_cvt_pk_bf16_f32 v24, v10, v11
    v_mul_f32 v8, v50, v130
    v_mul_f32 v10, v50, v114
    v_fma_f32 v8, v34, v114, -v8
    v_fma_f32 v10, v34, v130, v10
    v_mul_f32 v9, v51, v131
    v_mul_f32 v11, v51, v115
    v_fma_f32 v9, v35, v115, -v9
    v_fma_f32 v11, v35, v131, v11
    v_cvt_pk_bf16_f32 v17, v8, v9
    v_cvt_pk_bf16_f32 v25, v10, v11
    v_mul_f32 v8, v52, v132
    v_mul_f32 v10, v52, v116
    v_fma_f32 v8, v36, v116, -v8
    v_fma_f32 v10, v36, v132, v10
    v_mul_f32 v9, v53, v133
    v_mul_f32 v11, v53, v117
    v_fma_f32 v9, v37, v117, -v9
    v_fma_f32 v11, v37, v133, v11
    v_cvt_pk_bf16_f32 v18, v8, v9
    v_cvt_pk_bf16_f32 v26, v10, v11
    v_mul_f32 v8, v54, v134
    v_mul_f32 v10, v54, v118
    v_fma_f32 v8, v38, v118, -v8
    v_fma_f32 v10, v38, v134, v10
    v_mul_f32 v9, v55, v135
    v_mul_f32 v11, v55, v119
    v_fma_f32 v9, v39, v119, -v9
    v_fma_f32 v11, v39, v135, v11
    v_cvt_pk_bf16_f32 v19, v8, v9
    v_cvt_pk_bf16_f32 v27, v10, v11
    s_barrier
    v_mul_f32 v8, v56, v136
    v_mul_f32 v10, v56, v120
    v_fma_f32 v8, v40, v120, -v8
    v_fma_f32 v10, v40, v136, v10
    v_mul_f32 v9, v57, v137
    v_mul_f32 v11, v57, v121
    v_fma_f32 v9, v41, v121, -v9
    v_fma_f32 v11, v41, v137, v11
    v_cvt_pk_bf16_f32 v20, v8, v9
    v_cvt_pk_bf16_f32 v28, v10, v11
    v_mul_f32 v8, v58, v138
    v_mul_f32 v10, v58, v122
    v_fma_f32 v8, v42, v122, -v8
    v_fma_f32 v10, v42, v138, v10
    v_mul_f32 v9, v59, v139
    v_mul_f32 v11, v59, v123
    v_fma_f32 v9, v43, v123, -v9
    v_fma_f32 v11, v43, v139, v11
    v_cvt_pk_bf16_f32 v21, v8, v9
    v_cvt_pk_bf16_f32 v29, v10, v11
    v_mul_f32 v8, v60, v140
    v_mul_f32 v10, v60, v124
    v_fma_f32 v8, v44, v124, -v8
    v_fma_f32 v10, v44, v140, v10
    v_mul_f32 v9, v61, v141
    v_mul_f32 v11, v61, v125
    v_fma_f32 v9, v45, v125, -v9
    v_fma_f32 v11, v45, v141, v11
    v_cvt_pk_bf16_f32 v22, v8, v9
    v_cvt_pk_bf16_f32 v30, v10, v11
    v_mul_f32 v8, v62, v142
    v_mul_f32 v10, v62, v126
    v_fma_f32 v8, v46, v126, -v8
    v_fma_f32 v10, v46, v142, v10
    v_mul_f32 v9, v63, v143
    v_mul_f32 v11, v63, v127
    v_fma_f32 v9, v47, v127, -v9
    v_fma_f32 v11, v47, v143, v11
    v_cvt_pk_bf16_f32 v23, v8, v9
    v_cvt_pk_bf16_f32 v31, v10, v11
    s_nop 1
    s_add_u32 s40, s29, 14336
    buffer_load_dwordx4 v[112:115], v2, s[16:19], s40 offen
    s_add_u32 s40, s29, 15360
    buffer_load_dwordx4 v[116:119], v2, s[16:19], s40 offen
    s_add_u32 s40, s29, 16384
    buffer_load_dwordx4 v[120:123], v2, s[16:19], s40 offen
    s_add_u32 s40, s29, 17408
    buffer_load_dwordx4 v[124:127], v2, s[16:19], s40 offen
    s_add_u32 s40, s29, 18432
    buffer_load_dwordx4 v[128:131], v2, s[16:19], s40 offen
    s_add_u32 s40, s29, 19456
    buffer_load_dwordx4 v[132:135], v2, s[16:19], s40 offen
    s_add_u32 s40, s29, 20480
    buffer_load_dwordx4 v[136:139], v2, s[16:19], s40 offen
    s_add_u32 s40, s29, 21504
    buffer_load_dwordx4 v[140:143], v2, s[16:19], s40 offen
    s_add_u32 s40, s29, 22528
    buffer_load_dwordx4 v[64:67], v2, s[16:19], s40 offen
    s_add_u32 s40, s29, 23552
    buffer_load_dwordx4 v[68:71], v2, s[16:19], s40 offen
    s_add_u32 s40, s29, 24576
    buffer_load_dwordx4 v[72:75], v2, s[16:19], s40 offen
    s_add_u32 s40, s29, 25600
    buffer_load_dwordx4 v[76:79], v2, s[16:19], s40 offen
    s_add_u32 s40, s29, 26624
    buffer_load_dwordx4 v[80:83], v2, s[16:19], s40 offen
    s_barrier
    s_add_u32 s40, s29, 27648
    buffer_load_dwordx4 v[84:87], v2, s[16:19], s40 offen
    s_movk_i32 s40, 0
    buffer_load_dwordx2 v[144:145], v162, s[8:11], s40 offen sc1
    s_movk_i32 s40, 2048
    buffer_load_dwordx2 v[146:147], v162, s[8:11], s40 offen sc1
    s_movk_i32 s40, 4096
    buffer_load_dwordx2 v[148:149], v162, s[8:11], s40 offen sc1
    s_movk_i32 s40, 6144
    buffer_load_dwordx2 v[150:151], v162, s[8:11], s40 offen sc1
    s_waitcnt vmcnt(18)
    v_mfma_f32_32x32x16_bf16 v[32:47], v[88:91], v[16:19], 0
    v_mfma_f32_32x32x16_bf16 v[32:47], v[92:95], v[20:23], v[32:47]
    v_mfma_f32_32x32x16_bf16 v[48:63], v[96:99], v[16:19], 0
    v_mfma_f32_32x32x16_bf16 v[48:63], v[100:103], v[20:23], v[48:63]
    v_mfma_f32_32x32x16_bf16 v[32:47], v[104:107], v[24:27], v[32:47]
    v_mfma_f32_32x32x16_bf16 v[32:47], v[108:111], v[28:31], v[32:47]
    v_mfma_f32_32x32x16_bf16 v[48:63], v[88:91], v[24:27], v[48:63]
    s_barrier
    v_mfma_f32_32x32x16_bf16 v[48:63], v[92:95], v[28:31], v[48:63]
    s_nop 15
    s_mov_b32 s41, 0
    s_waitcnt vmcnt(0)
    s_cmp_eq_u32 s41, 1
    s_cbranch_scc1 L2_gpd
L2_gpl:
    v_cmp_ne_u64 s[42:43], v[144:145], v[160:161]
    v_cmp_ne_u64 vcc, v[146:147], v[160:161]
    s_or_b64 s[42:43], s[42:43], vcc
    v_cmp_ne_u64 vcc, v[148:149], v[160:161]
    s_or_b64 s[42:43], s[42:43], vcc
    v_cmp_ne_u64 vcc, v[150:151], v[160:161]
    s_or_b64 s[42:43], s[42:43], vcc
    s_cmp_gt_u32 s41, 0x100000
    s_cbranch_scc1 L2_gpd
    s_cmp_eq_u64 s[42:43], 0
    s_cbranch_scc1 L2_gpd
    s_movk_i32 s40, 0
    buffer_load_dwordx2 v[144:145], v162, s[8:11], s40 offen sc1
    s_movk_i32 s40, 2048
    buffer_load_dwordx2 v[146:147], v162, s[8:11], s40 offen sc1
    s_movk_i32 s40, 4096
    buffer_load_dwordx2 v[148:149], v162, s[8:11], s40 offen sc1
    s_movk_i32 s40, 6144
    buffer_load_dwordx2 v[150:151], v162, s[8:11], s40 offen sc1
    s_add_u32 s41, s41, 1
    s_waitcnt vmcnt(0)
    s_branch L2_gpl
L2_gpd:
    buffer_load_dwordx4 v[144:147], v2, s[8:11], s28 offen offset:0 sc1
    buffer_load_dwordx4 v[148:151], v2, s[8:11], s28 offen offset:1024 sc1
    buffer_load_dwordx4 v[152:155], v2, s[8:11], s28 offen offset:2048 sc1
    buffer_load_dwordx4 v[156:159], v2, s[8:11], s28 offen offset:3072 sc1
    s_barrier
    s_waitcnt vmcnt(0)
    v_lshlrev_b32 v12, 16, v144
    v_and_b32 v14, 0xffff0000, v144
    v_mul_f32 v8, v48, v14
    v_mul_f32 v10, v48, v12
    v_fma_f32 v8, v32, v12, -v8
    v_fma_f32 v10, v32, v14, v10
    v_lshlrev_b32 v13, 16, v145
    v_and_b32 v15, 0xffff0000, v145
    s_barrier
    v_mul_f32 v9, v49, v15
    v_mul_f32 v11, v49, v13
    v_fma_f32 v9, v33, v13, -v9
    v_fma_f32 v11, v33, v15, v11
    v_cvt_pk_bf16_f32 v16, v8, v9
    v_cvt_pk_bf16_f32 v24, v10, v11
    v_lshlrev_b32 v12, 16, v146
    v_and_b32 v14, 0xffff0000, v146
    v_mul_f32 v8, v50, v14
    v_mul_f32 v10, v50, v12
    v_fma_f32 v8, v34, v12, -v8
    v_fma_f32 v10, v34, v14, v10
    v_lshlrev_b32 v13, 16, v147
    v_and_b32 v15, 0xffff0000, v147
    v_mul_f32 v9, v51, v15
    v_mul_f32 v11, v51, v13
    v_fma_f32 v9, v35, v13, -v9
    v_fma_f32 v11, v35, v15, v11
    v_cvt_pk_bf16_f32 v17, v8, v9
    v_cvt_pk_bf16_f32 v25, v10, v11
    v_lshlrev_b32 v12, 16, v148
    v_and_b32 v14, 0xffff0000, v148
    v_mul_f32 v8, v52, v14
    v_mul_f32 v10, v52, v12
    v_fma_f32 v8, v36, v12, -v8
    v_fma_f32 v10, v36, v14, v10
    v_lshlrev_b32 v13, 16, v149
    v_and_b32 v15, 0xffff0000, v149
    v_mul_f32 v9, v53, v15
    v_mul_f32 v11, v53, v13
    v_fma_f32 v9, v37, v13, -v9
    v_fma_f32 v11, v37, v15, v11
    v_cvt_pk_bf16_f32 v18, v8, v9
    v_cvt_pk_bf16_f32 v26, v10, v11
    v_lshlrev_b32 v12, 16, v150
    v_and_b32 v14, 0xffff0000, v150
    v_mul_f32 v8, v54, v14
    v_mul_f32 v10, v54, v12
    v_fma_f32 v8, v38, v12, -v8
    v_fma_f32 v10, v38, v14, v10
    v_lshlrev_b32 v13, 16, v151
    v_and_b32 v15, 0xffff0000, v151
    v_mul_f32 v9, v55, v15
    v_mul_f32 v11, v55, v13
    v_fma_f32 v9, v39, v13, -v9
    v_fma_f32 v11, v39, v15, v11
    v_cvt_pk_bf16_f32 v19, v8, v9
    v_cvt_pk_bf16_f32 v27, v10, v11
    v_lshlrev_b32 v12, 16, v152
    v_and_b32 v14, 0xffff0000, v152
    v_mul_f32 v8, v56, v14
    v_mul_f32 v10, v56, v12
    v_fma_f32 v8, v40, v12, -v8
    v_fma_f32 v10, v40, v14, v10
    v_lshlrev_b32 v13, 16, v153
    v_and_b32 v15, 0xffff0000, v153
    v_mul_f32 v9, v57, v15
    v_mul_f32 v11, v57, v13
    v_fma_f32 v9, v41, v13, -v9
    v_fma_f32 v11, v41, v15, v11
    v_cvt_pk_bf16_f32 v20, v8, v9
    v_cvt_pk_bf16_f32 v28, v10, v11
    v_lshlrev_b32 v12, 16, v154
    v_and_b32 v14, 0xffff0000, v154
    v_mul_f32 v8, v58, v14
    v_mul_f32 v10, v58, v12
    v_fma_f32 v8, v42, v12, -v8
    s_barrier
    v_fma_f32 v10, v42, v14, v10
    v_lshlrev_b32 v13, 16, v155
    v_and_b32 v15, 0xffff0000, v155
    v_mul_f32 v9, v59, v15
    v_mul_f32 v11, v59, v13
    v_fma_f32 v9, v43, v13, -v9
    v_fma_f32 v11, v43, v15, v11
    v_cvt_pk_bf16_f32 v21, v8, v9
    v_cvt_pk_bf16_f32 v29, v10, v11
    v_lshlrev_b32 v12, 16, v156
    v_and_b32 v14, 0xffff0000, v156
    v_mul_f32 v8, v60, v14
    v_mul_f32 v10, v60, v12
    v_fma_f32 v8, v44, v12, -v8
    v_fma_f32 v10, v44, v14, v10
    v_lshlrev_b32 v13, 16, v157
    v_and_b32 v15, 0xffff0000, v157
    v_mul_f32 v9, v61, v15
    v_mul_f32 v11, v61, v13
    v_fma_f32 v9, v45, v13, -v9
    v_fma_f32 v11, v45, v15, v11
    v_cvt_pk_bf16_f32 v22, v8, v9
    v_cvt_pk_bf16_f32 v30, v10, v11
    v_lshlrev_b32 v12, 16, v158
    v_and_b32 v14, 0xffff0000, v158
    v_mul_f32 v8, v62, v14
    v_mul_f32 v10, v62, v12
    v_fma_f32 v8, v46, v12, -v8
    v_fma_f32 v10, v46, v14, v10
    v_lshlrev_b32 v13, 16, v159
    v_and_b32 v15, 0xffff0000, v159
    v_mul_f32 v9, v63, v15
    v_mul_f32 v11, v63, v13
    v_fma_f32 v9, v47, v13, -v9
    v_fma_f32 v11, v47, v15, v11
    v_cvt_pk_bf16_f32 v23, v8, v9
    v_cvt_pk_bf16_f32 v31, v10, v11
    s_nop 1
    v_mfma_f32_32x32x16_bf16 v[32:47], v[16:19], v[88:91], 0
    v_mfma_f32_32x32x16_bf16 v[32:47], v[20:23], v[92:95], v[32:47]
    v_mfma_f32_32x32x16_bf16 v[48:63], v[16:19], v[104:107], 0
    v_mfma_f32_32x32x16_bf16 v[48:63], v[20:23], v[108:111], v[48:63]
    s_barrier
    v_mfma_f32_32x32x16_bf16 v[32:47], v[24:27], v[96:99], v[32:47]
    v_mfma_f32_32x32x16_bf16 v[32:47], v[28:31], v[100:103], v[32:47]
    v_mfma_f32_32x32x16_bf16 v[48:63], v[24:27], v[88:91], v[48:63]
    v_mfma_f32_32x32x16_bf16 v[48:63], v[28:31], v[92:95], v[48:63]
    s_nop 15
    s_waitcnt vmcnt(6)
    v_mul_f32 v8, v48, v128
    v_mul_f32 v10, v48, v112
    v_fma_f32 v8, v32, v112, -v8
    v_fma_f32 v10, v32, v128, v10
    v_mul_f32 v9, v49, v129
    v_mul_f32 v11, v49, v113
    v_fma_f32 v9, v33, v113, -v9
    v_fma_f32 v11, v33, v129, v11
    v_cvt_pk_bf16_f32 v16, v8, v9
    v_cvt_pk_bf16_f32 v24, v10, v11
    v_mul_f32 v8, v50, v130
    v_mul_f32 v10, v50, v114
    v_fma_f32 v8, v34, v114, -v8
    v_fma_f32 v10, v34, v130, v10
    s_barrier
    v_mul_f32 v9, v51, v131
    v_mul_f32 v11, v51, v115
    v_fma_f32 v9, v35, v115, -v9
    v_fma_f32 v11, v35, v131, v11
    v_cvt_pk_bf16_f32 v17, v8, v9
    v_cvt_pk_bf16_f32 v25, v10, v11
    v_mul_f32 v8, v52, v132
    v_mul_f32 v10, v52, v116
    v_fma_f32 v8, v36, v116, -v8
    v_fma_f32 v10, v36, v132, v10
    v_mul_f32 v9, v53, v133
    v_mul_f32 v11, v53, v117
    v_fma_f32 v9, v37, v117, -v9
    v_fma_f32 v11, v37, v133, v11
    v_cvt_pk_bf16_f32 v18, v8, v9
    v_cvt_pk_bf16_f32 v26, v10, v11
    v_mul_f32 v8, v54, v134
    v_mul_f32 v10, v54, v118
    v_fma_f32 v8, v38, v118, -v8
    v_fma_f32 v10, v38, v134, v10
    v_mul_f32 v9, v55, v135
    v_mul_f32 v11, v55, v119
    v_fma_f32 v9, v39, v119, -v9
    v_fma_f32 v11, v39, v135, v11
    v_cvt_pk_bf16_f32 v19, v8, v9
    v_cvt_pk_bf16_f32 v27, v10, v11
    v_mul_f32 v8, v56, v136
    v_mul_f32 v10, v56, v120
    v_fma_f32 v8, v40, v120, -v8
    v_fma_f32 v10, v40, v136, v10
    v_mul_f32 v9, v57, v137
    v_mul_f32 v11, v57, v121
    v_fma_f32 v9, v41, v121, -v9
    v_fma_f32 v11, v41, v137, v11
    v_cvt_pk_bf16_f32 v20, v8, v9
    v_cvt_pk_bf16_f32 v28, v10, v11
    v_mul_f32 v8, v58, v138
    v_mul_f32 v10, v58, v122
    v_fma_f32 v8, v42, v122, -v8
    v_fma_f32 v10, v42, v138, v10
    v_mul_f32 v9, v59, v139
    v_mul_f32 v11, v59, v123
    v_fma_f32 v9, v43, v123, -v9
    v_fma_f32 v11, v43, v139, v11
    v_cvt_pk_bf16_f32 v21, v8, v9
    v_cvt_pk_bf16_f32 v29, v10, v11
    v_mul_f32 v8, v60, v140
    v_mul_f32 v10, v60, v124
    v_fma_f32 v8, v44, v124, -v8
    v_fma_f32 v10, v44, v140, v10
    v_mul_f32 v9, v61, v141
    v_mul_f32 v11, v61, v125
    v_fma_f32 v9, v45, v125, -v9
    v_fma_f32 v11, v45, v141, v11
    v_cvt_pk_bf16_f32 v22, v8, v9
    v_cvt_pk_bf16_f32 v30, v10, v11
    v_mul_f32 v8, v62, v142
    v_mul_f32 v10, v62, v126
    v_fma_f32 v8, v46, v126, -v8
    v_fma_f32 v10, v46, v142, v10
    v_mul_f32 v9, v63, v143
    v_mul_f32 v11, v63, v127
    v_fma_f32 v9, v47, v127, -v9
    v_fma_f32 v11, v47, v143, v11
    v_cvt_pk_bf16_f32 v23, v8, v9
    v_cvt_pk_bf16_f32 v31, v10, v11
    s_nop 1
    s_barrier
    s_waitcnt vmcnt(0)
    v_mfma_f32_32x32x16_bf16 v[32:47], v[16:19], v[64:67], 0
    v_mfma_f32_32x32x16_bf16 v[32:47], v[20:23], v[68:71], v[32:47]
    v_mfma_f32_32x32x16_bf16 v[48:63], v[16:19], v[72:75], 0
    v_mfma_f32_32x32x16_bf16 v[48:63], v[20:23], v[76:79], v[48:63]
    v_mfma_f32_32x32x16_bf16 v[32:47], v[24:27], v[80:83], v[32:47]
    v_mfma_f32_32x32x16_bf16 v[32:47], v[28:31], v[84:87], v[32:47]
    v_mfma_f32_32x32x16_bf16 v[48:63], v[24:27], v[64:67], v[48:63]
    v_mfma_f32_32x32x16_bf16 v[48:63], v[28:31], v[68:71], v[48:63]
    s_nop 15
    s_barrier
    s_cmp_eq_u32 s37, 0
    s_cbranch_scc1 L2_f2
    v_mul_f32 v32, 0.5, v32
    v_mul_f32 v33, 0.5, v33
    v_mul_f32 v34, 0.5, v34
    v_mul_f32 v35, 0.5, v35
    v_mul_f32 v36, 0.5, v36
    v_mul_f32 v37, 0.5, v37
    v_mul_f32 v38, 0.5, v38
    v_mul_f32 v39, 0.5, v39
    v_mul_f32 v40, 0.5, v40
    v_mul_f32 v41, 0.5, v41
    v_mul_f32 v42, 0.5, v42
    v_mul_f32 v43, 0.5, v43
    v_mul_f32 v44, 0.5, v44
    v_mul_f32 v45, 0.5, v45
    v_mul_f32 v46, 0.5, v46
    v_mul_f32 v47, 0.5, v47
L2_f2:
    v_cvt_pk_bf16_f32 v16, v32, v33
    v_cvt_pk_bf16_f32 v24, v48, v49
    v_cvt_pk_bf16_f32 v17, v34, v35
    v_cvt_pk_bf16_f32 v25, v50, v51
    v_cvt_pk_bf16_f32 v18, v36, v37
    v_cvt_pk_bf16_f32 v26, v52, v53
    v_cvt_pk_bf16_f32 v19, v38, v39
    v_cvt_pk_bf16_f32 v27, v54, v55
    v_cvt_pk_bf16_f32 v20, v40, v41
    v_cvt_pk_bf16_f32 v28, v56, v57
    v_cvt_pk_bf16_f32 v21, v42, v43
    v_cvt_pk_bf16_f32 v29, v58, v59
    v_cvt_pk_bf16_f32 v22, v44, v45
    v_cvt_pk_bf16_f32 v30, v60, v61
    v_cvt_pk_bf16_f32 v23, v46, v47
    v_cvt_pk_bf16_f32 v31, v62, v63
    buffer_store_dwordx4 v[16:19], v2, s[8:11], s38 offen sc1
    buffer_store_dwordx4 v[20:23], v2, s[8:11], s38 offen offset:1024 sc1
    s_cmp_lg_u32 s37, 0
    s_cbranch_scc1 L2_f3
    buffer_store_dwordx4 v[24:27], v2, s[8:11], s39 offen sc1
    buffer_store_dwordx4 v[28:31], v2, s[8:11], s39 offen offset:1024 sc1
L2_f3:
    s_lshl_b32 s25, s2, 1
    s_add_u32 s25, s25, s36
    s_lshl_b32 s25, s25, 3
    s_add_u32 s25, s25, 14581760
    v_mov_b32 v8, s25
    v_mov_b32 v10, s96
    v_mov_b32 v11, s97
    s_waitcnt vmcnt(0)
    s_mov_b64 exec, 1
    buffer_store_dwordx2 v[10:11], v8, s[8:11], 0 offen sc1
L2_end:
    s_endpgm
L3_entry:
    s_cmp_ge_u32 s2, 224
    s_cbranch_scc1 L3_end
    s_load_dwordx2 s[4:5], s[0:1], 16
    s_load_dwordx2 s[6:7], s[0:1], 48
    s_load_dwordx2 s[8:9], s[0:1], 64
    v_lshrrev_b32 v4, 6, v0
    v_and_b32 v1, 63, v0
    v_readfirstlane_b32 s48, v4
    v_and_b32 v2, 15, v0
    v_lshrrev_b32 v3, 4, v1
    v_lshlrev_b32 v12, 4, v1
    s_and_b32 s21, s2, 7
    s_lshr_b32 s22, s2, 3
    s_and_b32 s23, s21, 3
    s_lshl_b32 s23, s23, 2
    s_and_b32 s37, s22, 3
    s_add_u32 s23, s23, s37
    s_lshr_b32 s36, s22, 2
    s_and_b32 s20, s48, 3
    s_cmp_lt_u32 s48, 4
    s_cbranch_scc1 L3_comp
    s_getpc_b64 s[10:11]
    s_add_u32 s10, s10, ftab2@rel32@lo+4
    s_addc_u32 s11, s11, ftab2@rel32@hi+12
    s_lshl_b32 s37, s37, 1
    s_add_u32 s46, s37, s36
    s_sub_u32 s38, s46, 7
    s_cmp_ge_u32 s46, 7
    s_cselect_b32 s46, s38, s46
    v_lshrrev_b32 v4, 3, v1
    v_and_b32 v5, 3, v4
    v_lshrrev_b32 v6, 2, v4
    v_lshl_add_u32 v5, v6, 3, v5
    v_and_b32 v6, 6, v4
    v_and_b32 v7, 7, v1
    v_xor_b32 v6, v6, v7
    v_lshlrev_b32 v6, 4, v6
    s_lshl_b32 s44, s20, 11
    s_cmp_ge_u32 s21, 4
    s_cbranch_scc1 L3_lb
    v_mul_u32_u24 v5, 896, v5
    v_add_u32 v14, v5, v6
    s_lshl_b32 s37, s23, 3
    s_lshl_b32 s38, s20, 1
    s_add_u32 s37, s37, s38
    s_mul_i32 s45, s37, 14336
    s_lshl_b32 s38, s36, 7
    s_mul_i32 s43, s20, 14336
    s_add_u32 s43, s43, s38
    s_lshl_b32 s40, s20, 12
    s_waitcnt lgkmcnt(0)
    s_add_u32 s24, s8, 10485760
    s_addc_u32 s25, s9, 0
    s_and_b32 s25, s25, 0xffff
    s_mov_b32 s26, 1835008
    s_mov_b32 s27, 0x20000
    s_mov_b32 s28, s4
    s_and_b32 s29, s5, 0xffff
    s_mov_b32 s30, 401408
    s_mov_b32 s31, 0x20000
    s_mov_b32 s49, s46
    s_mul_i32 s47, s46, 57344
    s_add_u32 s47, s47, s43
    s_add_u32 m0, s44, 16384
    s_add_u32 s39, s47, 0
    buffer_load_dwordx4 v14, s[28:31], s39 offen lds
    s_add_u32 m0, s44, 17408
    s_add_u32 s39, s47, 3584
    buffer_load_dwordx4 v14, s[28:31], s39 offen lds
    s_add_u32 s46, s46, 1
    s_cmp_eq_u32 s46, 7
    s_cselect_b32 s46, 0, s46
    s_mul_i32 s47, s46, 57344
    s_add_u32 s47, s47, s43
    s_add_u32 m0, s44, 40960
    s_add_u32 s39, s47, 0
    buffer_load_dwordx4 v14, s[28:31], s39 offen lds
    s_add_u32 m0, s44, 41984
    s_add_u32 s39, s47, 3584
    buffer_load_dwordx4 v14, s[28:31], s39 offen lds
    s_add_u32 s46, s46, 1
    s_cmp_eq_u32 s46, 7
    s_cselect_b32 s46, 0, s46
    s_mul_i32 s47, s46, 57344
    s_add_u32 s47, s47, s43
    s_add_u32 m0, s44, 65536
    s_add_u32 s39, s47, 0
    buffer_load_dwordx4 v14, s[28:31], s39 offen lds
    s_add_u32 m0, s44, 66560
    s_add_u32 s39, s47, 3584
    buffer_load_dwordx4 v14, s[28:31], s39 offen lds
    s_add_u32 s46, s46, 1
    s_cmp_eq_u32 s46, 7
    s_cselect_b32 s46, 0, s46
    s_mul_i32 s47, s46, 57344
    s_add_u32 s47, s47, s43
    s_add_u32 m0, s44, 90112
    s_add_u32 s39, s47, 0
    buffer_load_dwordx4 v14, s[28:31], s39 offen lds
    s_add_u32 m0, s44, 91136
    s_add_u32 s39, s47, 3584
    buffer_load_dwordx4 v14, s[28:31], s39 offen lds
    s_add_u32 s46, s46, 1
    s_cmp_eq_u32 s46, 7
    s_cselect_b32 s46, 0, s46
    s_mul_i32 s47, s46, 57344
    s_add_u32 s47, s47, s43
    s_add_u32 m0, s44, 114688
    s_add_u32 s39, s47, 0
    buffer_load_dwordx4 v14, s[28:31], s39 offen lds
    s_add_u32 m0, s44, 115712
    s_add_u32 s39, s47, 3584
    buffer_load_dwordx4 v14, s[28:31], s39 offen lds
    s_add_u32 s46, s46, 1
    s_cmp_eq_u32 s46, 7
    s_cselect_b32 s46, 0, s46
    s_mul_i32 s47, s46, 57344
    s_add_u32 s47, s47, s43
    s_add_u32 m0, s44, 139264
    s_add_u32 s39, s47, 0
    buffer_load_dwordx4 v14, s[28:31], s39 offen lds
    s_add_u32 m0, s44, 140288
    s_add_u32 s39, s47, 3584
    buffer_load_dwordx4 v14, s[28:31], s39 offen lds
    s_add_u32 s46, s46, 1
    s_cmp_eq_u32 s46, 7
    s_cselect_b32 s46, 0, s46
    s_mov_b32 s46, s49
    s_cmp_lg_u32 s20, 0
    s_cbranch_scc1 L3_pdA
    s_mov_b32 s52, s8
    s_and_b32 s53, s9, 0xffff
    s_mov_b32 s54, 16777216
    s_mov_b32 s55, 0x20000
    s_lshl_b32 s57, s23, 11
    s_add_u32 s57, s57, 14548992
    v_lshlrev_b32 v11, 7, v2
    v_add_u32 v11, s57, v11
    v_mov_b32 v10, 0
    v_mov_b32 v30, s96
    v_mov_b32 v31, s97
    s_mov_b32 s56, 0
Lpp3:
    buffer_load_dwordx2 v[32:33], v11, s[52:55], 0 offen sc1
    s_waitcnt vmcnt(0)
    v_cmp_ne_u64 vcc, v[32:33], v[30:31]
    s_cbranch_vccz Lpd3
    s_add_u32 s56, s56, 1
    s_cmp_lt_u32 s56, 0x80000
    s_cbranch_scc1 Lpp3
Lpd3:
    s_branch L3_pdA
    s_mov_b32 s56, 0
L3_plA:
    v_mov_b32 v30, s96
    v_mov_b32 v31, s97
    buffer_load_dwordx2 v[32:33], v11, s[52:55], 0 offen offset:0 sc1
    s_add_u32 s56, s56, 1
    s_waitcnt vmcnt(0)
    v_cmp_ne_u64 s[58:59], v[32:33], v[30:31]
    s_mov_b64 vcc, s[58:59]
    s_cmp_gt_u32 s56, 0x100000
    s_cbranch_scc1 L3_pdA
    s_cbranch_vccz L3_pdA
    s_sleep 1
    s_branch L3_plA
L3_pdA:
    s_barrier
    s_lshl_b32 s47, s46, 11
    s_add_u32 s47, s47, s45
    s_add_u32 m0, s40, 0
    s_nop 0
    buffer_load_dwordx4 v12, s[24:27], s47 offen offset:0 sc1 lds
    buffer_load_dwordx4 v12, s[24:27], s47 offen offset:1024 sc1 lds
    s_add_u32 m0, s40, 2048
    s_add_u32 s47, s47, 14336
    buffer_load_dwordx4 v12, s[24:27], s47 offen offset:0 sc1 lds
    buffer_load_dwordx4 v12, s[24:27], s47 offen offset:1024 sc1 lds
    s_add_u32 s46, s46, 1
    s_cmp_eq_u32 s46, 7
    s_cselect_b32 s46, 0, s46
    s_lshl_b32 s47, s46, 11
    s_add_u32 s47, s47, s45
    s_add_u32 m0, s40, 24576
    s_nop 0
    buffer_load_dwordx4 v12, s[24:27], s47 offen offset:0 sc1 lds
    buffer_load_dwordx4 v12, s[24:27], s47 offen offset:1024 sc1 lds
    s_add_u32 m0, s40, 26624
    s_add_u32 s47, s47, 14336
    buffer_load_dwordx4 v12, s[24:27], s47 offen offset:0 sc1 lds
    buffer_load_dwordx4 v12, s[24:27], s47 offen offset:1024 sc1 lds
    s_add_u32 s46, s46, 1
    s_cmp_eq_u32 s46, 7
    s_cselect_b32 s46, 0, s46
    s_lshl_b32 s47, s46, 11
    s_add_u32 s47, s47, s45
    s_add_u32 m0, s40, 49152
    s_nop 0
    buffer_load_dwordx4 v12, s[24:27], s47 offen offset:0 sc1 lds
    buffer_load_dwordx4 v12, s[24:27], s47 offen offset:1024 sc1 lds
    s_add_u32 m0, s40, 51200
    s_add_u32 s47, s47, 14336
    buffer_load_dwordx4 v12, s[24:27], s47 offen offset:0 sc1 lds
    buffer_load_dwordx4 v12, s[24:27], s47 offen offset:1024 sc1 lds
    s_add_u32 s46, s46, 1
    s_cmp_eq_u32 s46, 7
    s_cselect_b32 s46, 0, s46
    s_waitcnt vmcnt(8)
    s_barrier
    s_lshl_b32 s47, s46, 11
    s_add_u32 s47, s47, s45
    s_add_u32 m0, s40, 73728
    s_nop 0
    buffer_load_dwordx4 v12, s[24:27], s47 offen offset:0 sc1 lds
    buffer_load_dwordx4 v12, s[24:27], s47 offen offset:1024 sc1 lds
    s_add_u32 m0, s40, 75776
    s_add_u32 s47, s47, 14336
    buffer_load_dwordx4 v12, s[24:27], s47 offen offset:0 sc1 lds
    buffer_load_dwordx4 v12, s[24:27], s47 offen offset:1024 sc1 lds
    s_add_u32 s46, s46, 1
    s_cmp_eq_u32 s46, 7
    s_cselect_b32 s46, 0, s46
    s_lshl_b32 s47, s46, 11
    s_add_u32 s47, s47, s45
    s_add_u32 m0, s40, 98304
    s_nop 0
    buffer_load_dwordx4 v12, s[24:27], s47 offen offset:0 sc1 lds
    buffer_load_dwordx4 v12, s[24:27], s47 offen offset:1024 sc1 lds
    s_add_u32 m0, s40, 100352
    s_add_u32 s47, s47, 14336
    buffer_load_dwordx4 v12, s[24:27], s47 offen offset:0 sc1 lds
    buffer_load_dwordx4 v12, s[24:27], s47 offen offset:1024 sc1 lds
    s_add_u32 s46, s46, 1
    s_cmp_eq_u32 s46, 7
    s_cselect_b32 s46, 0, s46
    s_waitcnt vmcnt(12)
    s_barrier
    s_lshl_b32 s47, s46, 11
    s_add_u32 s47, s47, s45
    s_add_u32 m0, s40, 122880
    s_nop 0
    buffer_load_dwordx4 v12, s[24:27], s47 offen offset:0 sc1 lds
    buffer_load_dwordx4 v12, s[24:27], s47 offen offset:1024 sc1 lds
    s_add_u32 m0, s40, 124928
    s_add_u32 s47, s47, 14336
    buffer_load_dwordx4 v12, s[24:27], s47 offen offset:0 sc1 lds
    buffer_load_dwordx4 v12, s[24:27], s47 offen offset:1024 sc1 lds
    s_add_u32 s46, s46, 1
    s_cmp_eq_u32 s46, 7
    s_cselect_b32 s46, 0, s46
    s_waitcnt vmcnt(12)
    s_barrier
    s_lshl_b32 s47, s46, 11
    s_add_u32 s47, s47, s45
    s_add_u32 m0, s40, 0
    s_nop 0
    buffer_load_dwordx4 v12, s[24:27], s47 offen offset:0 sc1 lds
    buffer_load_dwordx4 v12, s[24:27], s47 offen offset:1024 sc1 lds
    s_add_u32 m0, s40, 2048
    s_add_u32 s47, s47, 14336
    buffer_load_dwordx4 v12, s[24:27], s47 offen offset:0 sc1 lds
    buffer_load_dwordx4 v12, s[24:27], s47 offen offset:1024 sc1 lds
    s_mul_i32 s47, s46, 57344
    s_add_u32 s47, s47, s43
    s_add_u32 m0, s44, 16384
    s_add_u32 s39, s47, 0
    buffer_load_dwordx4 v14, s[28:31], s39 offen lds
    s_add_u32 m0, s44, 17408
    s_add_u32 s39, s47, 3584
    buffer_load_dwordx4 v14, s[28:31], s39 offen lds
    s_add_u32 s46, s46, 1
    s_cmp_eq_u32 s46, 7
    s_cselect_b32 s46, 0, s46
    s_waitcnt vmcnt(14)
    s_barrier
    s_waitcnt vmcnt(10)
    s_barrier
    s_waitcnt vmcnt(6)
    s_barrier
    s_waitcnt vmcnt(0)
    s_barrier
    s_endpgm
L3_lb:
    v_lshlrev_b32 v5, 11, v5
    v_add_u32 v14, v5, v6
    s_lshl_b32 s37, s36, 2
    s_add_u32 s37, s37, s20
    s_mul_i32 s45, s37, 14336
    s_lshl_b32 s43, s20, 15
    s_lshl_b32 s38, s23, 7
    s_add_u32 s43, s43, s38
    s_mov_b32 s24, s10
    s_and_b32 s25, s11, 0xffff
    s_mov_b32 s26, 401408
    s_mov_b32 s27, 0x20000
    s_waitcnt lgkmcnt(0)
    s_add_u32 s28, s8, 12582912
    s_addc_u32 s29, s9, 0
    s_and_b32 s29, s29, 0xffff
    s_mov_b32 s30, 1835008
    s_mov_b32 s31, 0x20000
    s_mov_b32 s49, s46
    s_lshl_b32 s47, s46, 11
    s_add_u32 m0, s44, 0
    s_add_u32 s47, s47, s45
    buffer_load_dwordx4 v12, s[24:27], s47 offen offset:0 lds
    buffer_load_dwordx4 v12, s[24:27], s47 offen offset:1024 lds
    s_add_u32 s46, s46, 1
    s_cmp_eq_u32 s46, 7
    s_cselect_b32 s46, 0, s46
    s_lshl_b32 s47, s46, 11
    s_add_u32 m0, s44, 24576
    s_add_u32 s47, s47, s45
    buffer_load_dwordx4 v12, s[24:27], s47 offen offset:0 lds
    buffer_load_dwordx4 v12, s[24:27], s47 offen offset:1024 lds
    s_add_u32 s46, s46, 1
    s_cmp_eq_u32 s46, 7
    s_cselect_b32 s46, 0, s46
    s_lshl_b32 s47, s46, 11
    s_add_u32 m0, s44, 49152
    s_add_u32 s47, s47, s45
    buffer_load_dwordx4 v12, s[24:27], s47 offen offset:0 lds
    buffer_load_dwordx4 v12, s[24:27], s47 offen offset:1024 lds
    s_add_u32 s46, s46, 1
    s_cmp_eq_u32 s46, 7
    s_cselect_b32 s46, 0, s46
    s_lshl_b32 s47, s46, 11
    s_add_u32 m0, s44, 73728
    s_add_u32 s47, s47, s45
    buffer_load_dwordx4 v12, s[24:27], s47 offen offset:0 lds
    buffer_load_dwordx4 v12, s[24:27], s47 offen offset:1024 lds
    s_add_u32 s46, s46, 1
    s_cmp_eq_u32 s46, 7
    s_cselect_b32 s46, 0, s46
    s_lshl_b32 s47, s46, 11
    s_add_u32 m0, s44, 98304
    s_add_u32 s47, s47, s45
    buffer_load_dwordx4 v12, s[24:27], s47 offen offset:0 lds
    buffer_load_dwordx4 v12, s[24:27], s47 offen offset:1024 lds
    s_add_u32 s46, s46, 1
    s_cmp_eq_u32 s46, 7
    s_cselect_b32 s46, 0, s46
    s_lshl_b32 s47, s46, 11
    s_add_u32 m0, s44, 122880
    s_add_u32 s47, s47, s45
    buffer_load_dwordx4 v12, s[24:27], s47 offen offset:0 lds
    buffer_load_dwordx4 v12, s[24:27], s47 offen offset:1024 lds
    s_add_u32 s46, s46, 1
    s_cmp_eq_u32 s46, 7
    s_cselect_b32 s46, 0, s46
    s_mov_b32 s46, s49
    s_cmp_lg_u32 s20, 0
    s_cbranch_scc1 L3_pdB
    s_mov_b32 s52, s8
    s_and_b32 s53, s9, 0xffff
    s_mov_b32 s54, 16777216
    s_mov_b32 s55, 0x20000
    v_add_u32 v11, 14581760, v12
    v_mov_b32 v10, 0
    s_mov_b32 s56, 0
L3_plB:
    v_mov_b32 v30, s96
    v_mov_b32 v31, s97
    buffer_load_dwordx4 v[32:35], v11, s[52:55], 0 offen offset:0 sc1
    buffer_load_dwordx4 v[36:39], v11, s[52:55], 0 offen offset:1024 sc1
    buffer_load_dwordx4 v[40:43], v11, s[52:55], 0 offen offset:2048 sc1
    buffer_load_dwordx4 v[44:47], v11, s[52:55], 0 offen offset:3072 sc1
    s_add_u32 s56, s56, 1
    s_waitcnt vmcnt(0)
    v_cmp_ne_u64 s[58:59], v[32:33], v[30:31]
    v_cmp_ne_u64 vcc, v[34:35], v[30:31]
    s_or_b64 s[58:59], s[58:59], vcc
    v_cmp_ne_u64 vcc, v[36:37], v[30:31]
    s_or_b64 s[58:59], s[58:59], vcc
    v_cmp_ne_u64 vcc, v[38:39], v[30:31]
    s_or_b64 s[58:59], s[58:59], vcc
    v_cmp_ne_u64 vcc, v[40:41], v[30:31]
    s_or_b64 s[58:59], s[58:59], vcc
    v_cmp_ne_u64 vcc, v[42:43], v[30:31]
    s_or_b64 s[58:59], s[58:59], vcc
    v_cmp_ne_u64 vcc, v[44:45], v[30:31]
    s_or_b64 s[58:59], s[58:59], vcc
    v_cmp_ne_u64 vcc, v[46:47], v[30:31]
    s_or_b64 s[58:59], s[58:59], vcc
    s_mov_b64 vcc, s[58:59]
    s_cmp_gt_u32 s56, 0x100000
    s_cbranch_scc1 L3_pdB
    s_cbranch_vccz L3_pdB
    s_sleep 1
    s_branch L3_plB
L3_pdB:
    s_barrier
    s_mul_i32 s47, s46, 131072
    s_add_u32 s47, s47, s43
    s_add_u32 m0, s44, 8192
    s_add_u32 s39, s47, 0
    buffer_load_dwordx4 v14, s[28:31], s39 offen sc1 lds
    s_add_u32 m0, s44, 9216
    s_add_u32 s39, s47, 8192
    buffer_load_dwordx4 v14, s[28:31], s39 offen sc1 lds
    s_add_u32 m0, s44, 16384
    s_add_u32 s39, s47, 917504
    buffer_load_dwordx4 v14, s[28:31], s39 offen sc1 lds
    s_add_u32 m0, s44, 17408
    s_add_u32 s39, s47, 925696
    buffer_load_dwordx4 v14, s[28:31], s39 offen sc1 lds
    s_add_u32 s46, s46, 1
    s_cmp_eq_u32 s46, 7
    s_cselect_b32 s46, 0, s46
    s_mul_i32 s47, s46, 131072
    s_add_u32 s47, s47, s43
    s_add_u32 m0, s44, 32768
    s_add_u32 s39, s47, 0
    buffer_load_dwordx4 v14, s[28:31], s39 offen sc1 lds
    s_add_u32 m0, s44, 33792
    s_add_u32 s39, s47, 8192
    buffer_load_dwordx4 v14, s[28:31], s39 offen sc1 lds
    s_add_u32 m0, s44, 40960
    s_add_u32 s39, s47, 917504
    buffer_load_dwordx4 v14, s[28:31], s39 offen sc1 lds
    s_add_u32 m0, s44, 41984
    s_add_u32 s39, s47, 925696
    buffer_load_dwordx4 v14, s[28:31], s39 offen sc1 lds
    s_add_u32 s46, s46, 1
    s_cmp_eq_u32 s46, 7
    s_cselect_b32 s46, 0, s46
    s_mul_i32 s47, s46, 131072
    s_add_u32 s47, s47, s43
    s_add_u32 m0, s44, 57344
    s_add_u32 s39, s47, 0
    buffer_load_dwordx4 v14, s[28:31], s39 offen sc1 lds
    s_add_u32 m0, s44, 58368
    s_add_u32 s39, s47, 8192
    buffer_load_dwordx4 v14, s[28:31], s39 offen sc1 lds
    s_add_u32 m0, s44, 65536
    s_add_u32 s39, s47, 917504
    buffer_load_dwordx4 v14, s[28:31], s39 offen sc1 lds
    s_add_u32 m0, s44, 66560
    s_add_u32 s39, s47, 925696
    buffer_load_dwordx4 v14, s[28:31], s39 offen sc1 lds
    s_add_u32 s46, s46, 1
    s_cmp_eq_u32 s46, 7
    s_cselect_b32 s46, 0, s46
    s_waitcnt vmcnt(8)
    s_barrier
    s_mul_i32 s47, s46, 131072
    s_add_u32 s47, s47, s43
    s_add_u32 m0, s44, 81920
    s_add_u32 s39, s47, 0
    buffer_load_dwordx4 v14, s[28:31], s39 offen sc1 lds
    s_add_u32 m0, s44, 82944
    s_add_u32 s39, s47, 8192
    buffer_load_dwordx4 v14, s[28:31], s39 offen sc1 lds
    s_add_u32 m0, s44, 90112
    s_add_u32 s39, s47, 917504
    buffer_load_dwordx4 v14, s[28:31], s39 offen sc1 lds
    s_add_u32 m0, s44, 91136
    s_add_u32 s39, s47, 925696
    buffer_load_dwordx4 v14, s[28:31], s39 offen sc1 lds
    s_add_u32 s46, s46, 1
    s_cmp_eq_u32 s46, 7
    s_cselect_b32 s46, 0, s46
    s_mul_i32 s47, s46, 131072
    s_add_u32 s47, s47, s43
    s_add_u32 m0, s44, 106496
    s_add_u32 s39, s47, 0
    buffer_load_dwordx4 v14, s[28:31], s39 offen sc1 lds
    s_add_u32 m0, s44, 107520
    s_add_u32 s39, s47, 8192
    buffer_load_dwordx4 v14, s[28:31], s39 offen sc1 lds
    s_add_u32 m0, s44, 114688
    s_add_u32 s39, s47, 917504
    buffer_load_dwordx4 v14, s[28:31], s39 offen sc1 lds
    s_add_u32 m0, s44, 115712
    s_add_u32 s39, s47, 925696
    buffer_load_dwordx4 v14, s[28:31], s39 offen sc1 lds
    s_add_u32 s46, s46, 1
    s_cmp_eq_u32 s46, 7
    s_cselect_b32 s46, 0, s46
    s_waitcnt vmcnt(12)
    s_barrier
    s_mul_i32 s47, s46, 131072
    s_add_u32 s47, s47, s43
    s_add_u32 m0, s44, 131072
    s_add_u32 s39, s47, 0
    buffer_load_dwordx4 v14, s[28:31], s39 offen sc1 lds
    s_add_u32 m0, s44, 132096
    s_add_u32 s39, s47, 8192
    buffer_load_dwordx4 v14, s[28:31], s39 offen sc1 lds
    s_add_u32 m0, s44, 139264
    s_add_u32 s39, s47, 917504
    buffer_load_dwordx4 v14, s[28:31], s39 offen sc1 lds
    s_add_u32 m0, s44, 140288
    s_add_u32 s39, s47, 925696
    buffer_load_dwordx4 v14, s[28:31], s39 offen sc1 lds
    s_add_u32 s46, s46, 1
    s_cmp_eq_u32 s46, 7
    s_cselect_b32 s46, 0, s46
    s_waitcnt vmcnt(12)
    s_barrier
    s_mul_i32 s47, s46, 131072
    s_add_u32 s47, s47, s43
    s_add_u32 m0, s44, 8192
    s_add_u32 s39, s47, 0
    buffer_load_dwordx4 v14, s[28:31], s39 offen sc1 lds
    s_add_u32 m0, s44, 9216
    s_add_u32 s39, s47, 8192
    buffer_load_dwordx4 v14, s[28:31], s39 offen sc1 lds
    s_add_u32 m0, s44, 16384
    s_add_u32 s39, s47, 917504
    buffer_load_dwordx4 v14, s[28:31], s39 offen sc1 lds
    s_add_u32 m0, s44, 17408
    s_add_u32 s39, s47, 925696
    buffer_load_dwordx4 v14, s[28:31], s39 offen sc1 lds
    s_lshl_b32 s47, s46, 11
    s_add_u32 m0, s44, 0
    s_add_u32 s47, s47, s45
    buffer_load_dwordx4 v12, s[24:27], s47 offen offset:0 lds
    buffer_load_dwordx4 v12, s[24:27], s47 offen offset:1024 lds
    s_add_u32 s46, s46, 1
    s_cmp_eq_u32 s46, 7
    s_cselect_b32 s46, 0, s46
    s_waitcnt vmcnt(14)
    s_barrier
    s_waitcnt vmcnt(10)
    s_barrier
    s_waitcnt vmcnt(6)
    s_barrier
    s_waitcnt vmcnt(0)
    s_barrier
    s_endpgm
L3_comp:
    v_lshrrev_b32 v8, 1, v3
    v_and_b32 v9, 1, v3
    v_lshrrev_b32 v10, 2, v2
    v_lshl_add_u32 v11, v9, 2, v10
    v_lshl_add_u32 v8, v8, 4, v11
    v_lshlrev_b32 v8, 7, v8
    v_and_b32 v9, 3, v2
    v_lshl_add_u32 v8, v9, 3, v8
    v_lshrrev_b32 v11, 1, v11
    v_lshlrev_b32 v11, 5, v11
    v_mov_b32 v32, 0
    v_mov_b32 v33, 0
    v_mov_b32 v34, 0
    v_mov_b32 v35, 0
    v_mov_b32 v36, 0
    v_mov_b32 v37, 0
    v_mov_b32 v38, 0
    v_mov_b32 v39, 0
    v_mov_b32 v40, 0
    v_mov_b32 v41, 0
    v_mov_b32 v42, 0
    v_mov_b32 v43, 0
    v_mov_b32 v44, 0
    v_mov_b32 v45, 0
    v_mov_b32 v46, 0
    v_mov_b32 v47, 0
    v_mov_b32 v48, 0
    v_mov_b32 v49, 0
    v_mov_b32 v50, 0
    v_mov_b32 v51, 0
    v_mov_b32 v52, 0
    v_mov_b32 v53, 0
    v_mov_b32 v54, 0
    v_mov_b32 v55, 0
    v_mov_b32 v56, 0
    v_mov_b32 v57, 0
    v_mov_b32 v58, 0
    v_mov_b32 v59, 0
    v_mov_b32 v60, 0
    v_mov_b32 v61, 0
    v_mov_b32 v62, 0
    v_mov_b32 v63, 0
    s_cmp_ge_u32 s21, 4
    s_cbranch_scc1 L3_b
    v_xor_b32 v9, 0, v11
    v_add3_u32 v112, v8, v9, 0
    v_add_u32 v112, 16384, v112
    v_xor_b32 v9, 32, v11
    v_add3_u32 v113, v8, v9, 0
    v_add_u32 v113, 16384, v113
    v_xor_b32 v9, 64, v11
    v_add3_u32 v114, v8, v9, 0
    v_add_u32 v114, 16384, v114
    v_xor_b32 v9, 96, v11
    v_add3_u32 v115, v8, v9, 0
    v_add_u32 v115, 16384, v115
    s_lshl_b32 s40, s20, 12
    v_add_u32 v16, s40, v12
    v_add_u32 v116, 49152, v112
    v_add_u32 v117, 49152, v113
    v_add_u32 v118, 49152, v114
    v_add_u32 v119, 49152, v115
    v_add_u32 v17, 49152, v16
    v_add_u32 v120, 98304, v112
    v_add_u32 v121, 98304, v113
    v_add_u32 v122, 98304, v114
    v_add_u32 v123, 98304, v115
    v_add_u32 v18, 98304, v16
    s_lshl_b32 s37, s23, 3
    s_lshl_b32 s38, s20, 1
    s_add_u32 s37, s37, s38
    s_lshl_b32 s38, s36, 7
    s_mul_i32 s40, s20, 4608
    s_add_u32 s40, s40, 49152
    v_mul_u32_u24 v20, 144, v2
    v_lshl_add_u32 v20, v3, 3, v20
    v_add_u32 v20, s40, v20
    v_lshrrev_b32 v9, 3, v1
    v_and_b32 v10, 7, v1
    v_mul_u32_u24 v21, 144, v9
    v_lshl_add_u32 v21, v10, 4, v21
    v_add_u32 v21, s40, v21
    v_mul_u32_u24 v22, 1792, v9
    v_lshl_add_u32 v22, v10, 4, v22
    s_mul_i32 s41, s37, 28672
    s_add_u32 s41, s41, s38
    s_waitcnt lgkmcnt(0)
    s_mov_b32 s32, s6
    s_and_b32 s33, s7, 0xffff
    s_mov_b32 s34, 3670016
    s_mov_b32 s35, 0x20000
    s_barrier
    s_barrier
    ds_read_b128 v[96:99], v16 offset:0
    ds_read_b128 v[100:103], v16 offset:2048
    ds_read_b64_tr_b16 v[64:65], v112 offset:0
    ds_read_b64_tr_b16 v[66:67], v112 offset:1024
    ds_read_b64_tr_b16 v[68:69], v113 offset:0
    ds_read_b64_tr_b16 v[70:71], v113 offset:1024
    ds_read_b64_tr_b16 v[72:73], v114 offset:0
    ds_read_b64_tr_b16 v[74:75], v114 offset:1024
    ds_read_b64_tr_b16 v[76:77], v115 offset:0
    ds_read_b64_tr_b16 v[78:79], v115 offset:1024
    s_waitcnt lgkmcnt(0)
    v_mfma_f32_16x16x32_bf16 v[32:35], v[64:67], v[96:99], v[32:35]
    ds_read_b128 v[104:107], v16 offset:1024
    ds_read_b128 v[108:111], v16 offset:3072
    v_mfma_f32_16x16x32_bf16 v[48:51], v[64:67], v[100:103], v[48:51]
    ds_read_b64_tr_b16 v[80:81], v112 offset:4096
    ds_read_b64_tr_b16 v[82:83], v112 offset:5120
    v_mfma_f32_16x16x32_bf16 v[36:39], v[68:71], v[96:99], v[36:39]
    ds_read_b64_tr_b16 v[84:85], v113 offset:4096
    ds_read_b64_tr_b16 v[86:87], v113 offset:5120
    v_mfma_f32_16x16x32_bf16 v[52:55], v[68:71], v[100:103], v[52:55]
    ds_read_b64_tr_b16 v[88:89], v114 offset:4096
    ds_read_b64_tr_b16 v[90:91], v114 offset:5120
    v_mfma_f32_16x16x32_bf16 v[40:43], v[72:75], v[96:99], v[40:43]
    ds_read_b64_tr_b16 v[92:93], v115 offset:4096
    ds_read_b64_tr_b16 v[94:95], v115 offset:5120
    v_mfma_f32_16x16x32_bf16 v[56:59], v[72:75], v[100:103], v[56:59]
    v_mfma_f32_16x16x32_bf16 v[44:47], v[76:79], v[96:99], v[44:47]
    v_mfma_f32_16x16x32_bf16 v[60:63], v[76:79], v[100:103], v[60:63]
    s_barrier
    s_waitcnt lgkmcnt(0)
    v_mfma_f32_16x16x32_bf16 v[32:35], v[80:83], v[104:107], v[32:35]
    ds_read_b128 v[96:99], v16 offset:24576
    ds_read_b128 v[100:103], v16 offset:26624
    v_mfma_f32_16x16x32_bf16 v[48:51], v[80:83], v[108:111], v[48:51]
    ds_read_b64_tr_b16 v[64:65], v112 offset:24576
    ds_read_b64_tr_b16 v[66:67], v112 offset:25600
    v_mfma_f32_16x16x32_bf16 v[36:39], v[84:87], v[104:107], v[36:39]
    ds_read_b64_tr_b16 v[68:69], v113 offset:24576
    ds_read_b64_tr_b16 v[70:71], v113 offset:25600
    v_mfma_f32_16x16x32_bf16 v[52:55], v[84:87], v[108:111], v[52:55]
    ds_read_b64_tr_b16 v[72:73], v114 offset:24576
    ds_read_b64_tr_b16 v[74:75], v114 offset:25600
    v_mfma_f32_16x16x32_bf16 v[40:43], v[88:91], v[104:107], v[40:43]
    ds_read_b64_tr_b16 v[76:77], v115 offset:24576
    ds_read_b64_tr_b16 v[78:79], v115 offset:25600
    v_mfma_f32_16x16x32_bf16 v[56:59], v[88:91], v[108:111], v[56:59]
    v_mfma_f32_16x16x32_bf16 v[44:47], v[92:95], v[104:107], v[44:47]
    v_mfma_f32_16x16x32_bf16 v[60:63], v[92:95], v[108:111], v[60:63]
    s_waitcnt lgkmcnt(0)
    v_mfma_f32_16x16x32_bf16 v[32:35], v[64:67], v[96:99], v[32:35]
    ds_read_b128 v[104:107], v16 offset:25600
    ds_read_b128 v[108:111], v16 offset:27648
    v_mfma_f32_16x16x32_bf16 v[48:51], v[64:67], v[100:103], v[48:51]
    ds_read_b64_tr_b16 v[80:81], v112 offset:28672
    ds_read_b64_tr_b16 v[82:83], v112 offset:29696
    v_mfma_f32_16x16x32_bf16 v[36:39], v[68:71], v[96:99], v[36:39]
    ds_read_b64_tr_b16 v[84:85], v113 offset:28672
    ds_read_b64_tr_b16 v[86:87], v113 offset:29696
    v_mfma_f32_16x16x32_bf16 v[52:55], v[68:71], v[100:103], v[52:55]
    ds_read_b64_tr_b16 v[88:89], v114 offset:28672
    ds_read_b64_tr_b16 v[90:91], v114 offset:29696
    v_mfma_f32_16x16x32_bf16 v[40:43], v[72:75], v[96:99], v[40:43]
    ds_read_b64_tr_b16 v[92:93], v115 offset:28672
    ds_read_b64_tr_b16 v[94:95], v115 offset:29696
    v_mfma_f32_16x16x32_bf16 v[56:59], v[72:75], v[100:103], v[56:59]
    v_mfma_f32_16x16x32_bf16 v[44:47], v[76:79], v[96:99], v[44:47]
    v_mfma_f32_16x16x32_bf16 v[60:63], v[76:79], v[100:103], v[60:63]
    s_barrier
    s_waitcnt lgkmcnt(0)
    v_mfma_f32_16x16x32_bf16 v[32:35], v[80:83], v[104:107], v[32:35]
    ds_read_b128 v[96:99], v17 offset:0
    ds_read_b128 v[100:103], v17 offset:2048
    v_mfma_f32_16x16x32_bf16 v[48:51], v[80:83], v[108:111], v[48:51]
    ds_read_b64_tr_b16 v[64:65], v116 offset:0
    ds_read_b64_tr_b16 v[66:67], v116 offset:1024
    v_mfma_f32_16x16x32_bf16 v[36:39], v[84:87], v[104:107], v[36:39]
    ds_read_b64_tr_b16 v[68:69], v117 offset:0
    ds_read_b64_tr_b16 v[70:71], v117 offset:1024
    v_mfma_f32_16x16x32_bf16 v[52:55], v[84:87], v[108:111], v[52:55]
    ds_read_b64_tr_b16 v[72:73], v118 offset:0
    ds_read_b64_tr_b16 v[74:75], v118 offset:1024
    v_mfma_f32_16x16x32_bf16 v[40:43], v[88:91], v[104:107], v[40:43]
    ds_read_b64_tr_b16 v[76:77], v119 offset:0
    ds_read_b64_tr_b16 v[78:79], v119 offset:1024
    v_mfma_f32_16x16x32_bf16 v[56:59], v[88:91], v[108:111], v[56:59]
    v_mfma_f32_16x16x32_bf16 v[44:47], v[92:95], v[104:107], v[44:47]
    v_mfma_f32_16x16x32_bf16 v[60:63], v[92:95], v[108:111], v[60:63]
    s_waitcnt lgkmcnt(0)
    v_mfma_f32_16x16x32_bf16 v[32:35], v[64:67], v[96:99], v[32:35]
    ds_read_b128 v[104:107], v17 offset:1024
    ds_read_b128 v[108:111], v17 offset:3072
    v_mfma_f32_16x16x32_bf16 v[48:51], v[64:67], v[100:103], v[48:51]
    ds_read_b64_tr_b16 v[80:81], v116 offset:4096
    ds_read_b64_tr_b16 v[82:83], v116 offset:5120
    v_mfma_f32_16x16x32_bf16 v[36:39], v[68:71], v[96:99], v[36:39]
    ds_read_b64_tr_b16 v[84:85], v117 offset:4096
    ds_read_b64_tr_b16 v[86:87], v117 offset:5120
    v_mfma_f32_16x16x32_bf16 v[52:55], v[68:71], v[100:103], v[52:55]
    ds_read_b64_tr_b16 v[88:89], v118 offset:4096
    ds_read_b64_tr_b16 v[90:91], v118 offset:5120
    v_mfma_f32_16x16x32_bf16 v[40:43], v[72:75], v[96:99], v[40:43]
    ds_read_b64_tr_b16 v[92:93], v119 offset:4096
    ds_read_b64_tr_b16 v[94:95], v119 offset:5120
    v_mfma_f32_16x16x32_bf16 v[56:59], v[72:75], v[100:103], v[56:59]
    v_mfma_f32_16x16x32_bf16 v[44:47], v[76:79], v[96:99], v[44:47]
    v_mfma_f32_16x16x32_bf16 v[60:63], v[76:79], v[100:103], v[60:63]
    s_barrier
    s_waitcnt lgkmcnt(0)
    v_mfma_f32_16x16x32_bf16 v[32:35], v[80:83], v[104:107], v[32:35]
    ds_read_b128 v[96:99], v17 offset:24576
    ds_read_b128 v[100:103], v17 offset:26624
    v_mfma_f32_16x16x32_bf16 v[48:51], v[80:83], v[108:111], v[48:51]
    ds_read_b64_tr_b16 v[64:65], v116 offset:24576
    ds_read_b64_tr_b16 v[66:67], v116 offset:25600
    v_mfma_f32_16x16x32_bf16 v[36:39], v[84:87], v[104:107], v[36:39]
    ds_read_b64_tr_b16 v[68:69], v117 offset:24576
    ds_read_b64_tr_b16 v[70:71], v117 offset:25600
    v_mfma_f32_16x16x32_bf16 v[52:55], v[84:87], v[108:111], v[52:55]
    ds_read_b64_tr_b16 v[72:73], v118 offset:24576
    ds_read_b64_tr_b16 v[74:75], v118 offset:25600
    v_mfma_f32_16x16x32_bf16 v[40:43], v[88:91], v[104:107], v[40:43]
    ds_read_b64_tr_b16 v[76:77], v119 offset:24576
    ds_read_b64_tr_b16 v[78:79], v119 offset:25600
    v_mfma_f32_16x16x32_bf16 v[56:59], v[88:91], v[108:111], v[56:59]
    v_mfma_f32_16x16x32_bf16 v[44:47], v[92:95], v[104:107], v[44:47]
    v_mfma_f32_16x16x32_bf16 v[60:63], v[92:95], v[108:111], v[60:63]
    s_waitcnt lgkmcnt(0)
    v_mfma_f32_16x16x32_bf16 v[32:35], v[64:67], v[96:99], v[32:35]
    ds_read_b128 v[104:107], v17 offset:25600
    ds_read_b128 v[108:111], v17 offset:27648
    v_mfma_f32_16x16x32_bf16 v[48:51], v[64:67], v[100:103], v[48:51]
    ds_read_b64_tr_b16 v[80:81], v116 offset:28672
    ds_read_b64_tr_b16 v[82:83], v116 offset:29696
    v_mfma_f32_16x16x32_bf16 v[36:39], v[68:71], v[96:99], v[36:39]
    ds_read_b64_tr_b16 v[84:85], v117 offset:28672
    ds_read_b64_tr_b16 v[86:87], v117 offset:29696
    v_mfma_f32_16x16x32_bf16 v[52:55], v[68:71], v[100:103], v[52:55]
    ds_read_b64_tr_b16 v[88:89], v118 offset:28672
    ds_read_b64_tr_b16 v[90:91], v118 offset:29696
    v_mfma_f32_16x16x32_bf16 v[40:43], v[72:75], v[96:99], v[40:43]
    ds_read_b64_tr_b16 v[92:93], v119 offset:28672
    ds_read_b64_tr_b16 v[94:95], v119 offset:29696
    v_mfma_f32_16x16x32_bf16 v[56:59], v[72:75], v[100:103], v[56:59]
    v_mfma_f32_16x16x32_bf16 v[44:47], v[76:79], v[96:99], v[44:47]
    v_mfma_f32_16x16x32_bf16 v[60:63], v[76:79], v[100:103], v[60:63]
    s_barrier
    s_waitcnt lgkmcnt(0)
    v_mfma_f32_16x16x32_bf16 v[32:35], v[80:83], v[104:107], v[32:35]
    ds_read_b128 v[96:99], v18 offset:0
    ds_read_b128 v[100:103], v18 offset:2048
    v_mfma_f32_16x16x32_bf16 v[48:51], v[80:83], v[108:111], v[48:51]
    ds_read_b64_tr_b16 v[64:65], v120 offset:0
    ds_read_b64_tr_b16 v[66:67], v120 offset:1024
    v_mfma_f32_16x16x32_bf16 v[36:39], v[84:87], v[104:107], v[36:39]
    ds_read_b64_tr_b16 v[68:69], v121 offset:0
    ds_read_b64_tr_b16 v[70:71], v121 offset:1024
    v_mfma_f32_16x16x32_bf16 v[52:55], v[84:87], v[108:111], v[52:55]
    ds_read_b64_tr_b16 v[72:73], v122 offset:0
    ds_read_b64_tr_b16 v[74:75], v122 offset:1024
    v_mfma_f32_16x16x32_bf16 v[40:43], v[88:91], v[104:107], v[40:43]
    ds_read_b64_tr_b16 v[76:77], v123 offset:0
    ds_read_b64_tr_b16 v[78:79], v123 offset:1024
    v_mfma_f32_16x16x32_bf16 v[56:59], v[88:91], v[108:111], v[56:59]
    v_mfma_f32_16x16x32_bf16 v[44:47], v[92:95], v[104:107], v[44:47]
    v_mfma_f32_16x16x32_bf16 v[60:63], v[92:95], v[108:111], v[60:63]
    s_waitcnt lgkmcnt(0)
    v_mfma_f32_16x16x32_bf16 v[32:35], v[64:67], v[96:99], v[32:35]
    ds_read_b128 v[104:107], v18 offset:1024
    ds_read_b128 v[108:111], v18 offset:3072
    v_mfma_f32_16x16x32_bf16 v[48:51], v[64:67], v[100:103], v[48:51]
    ds_read_b64_tr_b16 v[80:81], v120 offset:4096
    ds_read_b64_tr_b16 v[82:83], v120 offset:5120
    v_mfma_f32_16x16x32_bf16 v[36:39], v[68:71], v[96:99], v[36:39]
    ds_read_b64_tr_b16 v[84:85], v121 offset:4096
    ds_read_b64_tr_b16 v[86:87], v121 offset:5120
    v_mfma_f32_16x16x32_bf16 v[52:55], v[68:71], v[100:103], v[52:55]
    ds_read_b64_tr_b16 v[88:89], v122 offset:4096
    ds_read_b64_tr_b16 v[90:91], v122 offset:5120
    v_mfma_f32_16x16x32_bf16 v[40:43], v[72:75], v[96:99], v[40:43]
    ds_read_b64_tr_b16 v[92:93], v123 offset:4096
    ds_read_b64_tr_b16 v[94:95], v123 offset:5120
    v_mfma_f32_16x16x32_bf16 v[56:59], v[72:75], v[100:103], v[56:59]
    v_mfma_f32_16x16x32_bf16 v[44:47], v[76:79], v[96:99], v[44:47]
    v_mfma_f32_16x16x32_bf16 v[60:63], v[76:79], v[100:103], v[60:63]
    s_barrier
    s_waitcnt lgkmcnt(0)
    v_mfma_f32_16x16x32_bf16 v[32:35], v[80:83], v[104:107], v[32:35]
    ds_read_b128 v[96:99], v18 offset:24576
    ds_read_b128 v[100:103], v18 offset:26624
    v_mfma_f32_16x16x32_bf16 v[48:51], v[80:83], v[108:111], v[48:51]
    ds_read_b64_tr_b16 v[64:65], v120 offset:24576
    ds_read_b64_tr_b16 v[66:67], v120 offset:25600
    v_mfma_f32_16x16x32_bf16 v[36:39], v[84:87], v[104:107], v[36:39]
    ds_read_b64_tr_b16 v[68:69], v121 offset:24576
    ds_read_b64_tr_b16 v[70:71], v121 offset:25600
    v_mfma_f32_16x16x32_bf16 v[52:55], v[84:87], v[108:111], v[52:55]
    ds_read_b64_tr_b16 v[72:73], v122 offset:24576
    ds_read_b64_tr_b16 v[74:75], v122 offset:25600
    v_mfma_f32_16x16x32_bf16 v[40:43], v[88:91], v[104:107], v[40:43]
    ds_read_b64_tr_b16 v[76:77], v123 offset:24576
    ds_read_b64_tr_b16 v[78:79], v123 offset:25600
    v_mfma_f32_16x16x32_bf16 v[56:59], v[88:91], v[108:111], v[56:59]
    v_mfma_f32_16x16x32_bf16 v[44:47], v[92:95], v[104:107], v[44:47]
    v_mfma_f32_16x16x32_bf16 v[60:63], v[92:95], v[108:111], v[60:63]
    s_waitcnt lgkmcnt(0)
    v_mfma_f32_16x16x32_bf16 v[32:35], v[64:67], v[96:99], v[32:35]
    ds_read_b128 v[104:107], v18 offset:25600
    ds_read_b128 v[108:111], v18 offset:27648
    v_mfma_f32_16x16x32_bf16 v[48:51], v[64:67], v[100:103], v[48:51]
    ds_read_b64_tr_b16 v[80:81], v120 offset:28672
    ds_read_b64_tr_b16 v[82:83], v120 offset:29696
    v_mfma_f32_16x16x32_bf16 v[36:39], v[68:71], v[96:99], v[36:39]
    ds_read_b64_tr_b16 v[84:85], v121 offset:28672
    ds_read_b64_tr_b16 v[86:87], v121 offset:29696
    v_mfma_f32_16x16x32_bf16 v[52:55], v[68:71], v[100:103], v[52:55]
    ds_read_b64_tr_b16 v[88:89], v122 offset:28672
    ds_read_b64_tr_b16 v[90:91], v122 offset:29696
    v_mfma_f32_16x16x32_bf16 v[40:43], v[72:75], v[96:99], v[40:43]
    ds_read_b64_tr_b16 v[92:93], v123 offset:28672
    ds_read_b64_tr_b16 v[94:95], v123 offset:29696
    v_mfma_f32_16x16x32_bf16 v[56:59], v[72:75], v[100:103], v[56:59]
    v_mfma_f32_16x16x32_bf16 v[44:47], v[76:79], v[96:99], v[44:47]
    v_mfma_f32_16x16x32_bf16 v[60:63], v[76:79], v[100:103], v[60:63]
    s_barrier
    s_waitcnt lgkmcnt(0)
    v_mfma_f32_16x16x32_bf16 v[32:35], v[80:83], v[104:107], v[32:35]
    ds_read_b128 v[96:99], v16 offset:0
    ds_read_b128 v[100:103], v16 offset:2048
    v_mfma_f32_16x16x32_bf16 v[48:51], v[80:83], v[108:111], v[48:51]
    ds_read_b64_tr_b16 v[64:65], v112 offset:0
    ds_read_b64_tr_b16 v[66:67], v112 offset:1024
    v_mfma_f32_16x16x32_bf16 v[36:39], v[84:87], v[104:107], v[36:39]
    ds_read_b64_tr_b16 v[68:69], v113 offset:0
    ds_read_b64_tr_b16 v[70:71], v113 offset:1024
    v_mfma_f32_16x16x32_bf16 v[52:55], v[84:87], v[108:111], v[52:55]
    ds_read_b64_tr_b16 v[72:73], v114 offset:0
    ds_read_b64_tr_b16 v[74:75], v114 offset:1024
    v_mfma_f32_16x16x32_bf16 v[40:43], v[88:91], v[104:107], v[40:43]
    ds_read_b64_tr_b16 v[76:77], v115 offset:0
    ds_read_b64_tr_b16 v[78:79], v115 offset:1024
    v_mfma_f32_16x16x32_bf16 v[56:59], v[88:91], v[108:111], v[56:59]
    v_mfma_f32_16x16x32_bf16 v[44:47], v[92:95], v[104:107], v[44:47]
    v_mfma_f32_16x16x32_bf16 v[60:63], v[92:95], v[108:111], v[60:63]
    s_waitcnt lgkmcnt(0)
    v_mfma_f32_16x16x32_bf16 v[32:35], v[64:67], v[96:99], v[32:35]
    ds_read_b128 v[104:107], v16 offset:1024
    ds_read_b128 v[108:111], v16 offset:3072
    v_mfma_f32_16x16x32_bf16 v[48:51], v[64:67], v[100:103], v[48:51]
    ds_read_b64_tr_b16 v[80:81], v112 offset:4096
    ds_read_b64_tr_b16 v[82:83], v112 offset:5120
    v_mfma_f32_16x16x32_bf16 v[36:39], v[68:71], v[96:99], v[36:39]
    ds_read_b64_tr_b16 v[84:85], v113 offset:4096
    ds_read_b64_tr_b16 v[86:87], v113 offset:5120
    v_mfma_f32_16x16x32_bf16 v[52:55], v[68:71], v[100:103], v[52:55]
    ds_read_b64_tr_b16 v[88:89], v114 offset:4096
    ds_read_b64_tr_b16 v[90:91], v114 offset:5120
    v_mfma_f32_16x16x32_bf16 v[40:43], v[72:75], v[96:99], v[40:43]
    ds_read_b64_tr_b16 v[92:93], v115 offset:4096
    ds_read_b64_tr_b16 v[94:95], v115 offset:5120
    v_mfma_f32_16x16x32_bf16 v[56:59], v[72:75], v[100:103], v[56:59]
    v_mfma_f32_16x16x32_bf16 v[44:47], v[76:79], v[96:99], v[44:47]
    v_mfma_f32_16x16x32_bf16 v[60:63], v[76:79], v[100:103], v[60:63]
    s_waitcnt lgkmcnt(0)
    v_mfma_f32_16x16x32_bf16 v[32:35], v[80:83], v[104:107], v[32:35]
    v_mfma_f32_16x16x32_bf16 v[48:51], v[80:83], v[108:111], v[48:51]
    v_mfma_f32_16x16x32_bf16 v[36:39], v[84:87], v[104:107], v[36:39]
    v_mfma_f32_16x16x32_bf16 v[52:55], v[84:87], v[108:111], v[52:55]
    v_mfma_f32_16x16x32_bf16 v[40:43], v[88:91], v[104:107], v[40:43]
    v_mfma_f32_16x16x32_bf16 v[56:59], v[88:91], v[108:111], v[56:59]
    v_mfma_f32_16x16x32_bf16 v[44:47], v[92:95], v[104:107], v[44:47]
    v_mfma_f32_16x16x32_bf16 v[60:63], v[92:95], v[108:111], v[60:63]
    s_nop 7
    v_cvt_pk_bf16_f32 v32, v32, v33
    v_cvt_pk_bf16_f32 v33, v34, v35
    ds_write_b64 v20, v[32:33] offset:0
    v_cvt_pk_bf16_f32 v48, v48, v49
    v_cvt_pk_bf16_f32 v49, v50, v51
    ds_write_b64 v20, v[48:49] offset:2304
    v_cvt_pk_bf16_f32 v36, v36, v37
    v_cvt_pk_bf16_f32 v37, v38, v39
    ds_write_b64 v20, v[36:37] offset:32
    v_cvt_pk_bf16_f32 v52, v52, v53
    v_cvt_pk_bf16_f32 v53, v54, v55
    ds_write_b64 v20, v[52:53] offset:2336
    v_cvt_pk_bf16_f32 v40, v40, v41
    v_cvt_pk_bf16_f32 v41, v42, v43
    ds_write_b64 v20, v[40:41] offset:64
    v_cvt_pk_bf16_f32 v56, v56, v57
    v_cvt_pk_bf16_f32 v57, v58, v59
    ds_write_b64 v20, v[56:57] offset:2368
    v_cvt_pk_bf16_f32 v44, v44, v45
    v_cvt_pk_bf16_f32 v45, v46, v47
    ds_write_b64 v20, v[44:45] offset:96
    v_cvt_pk_bf16_f32 v60, v60, v61
    v_cvt_pk_bf16_f32 v61, v62, v63
    ds_write_b64 v20, v[60:61] offset:2400
    s_waitcnt lgkmcnt(0)
    ds_read_b128 v[64:67], v21 offset:0
    ds_read_b128 v[68:71], v21 offset:1152
    ds_read_b128 v[72:75], v21 offset:2304
    ds_read_b128 v[76:79], v21 offset:3456
    s_waitcnt lgkmcnt(3)
    buffer_store_dwordx4 v[64:67], v22, s[32:35], s41 offen
    s_add_u32 s41, s41, 14336
    s_waitcnt lgkmcnt(2)
    buffer_store_dwordx4 v[68:71], v22, s[32:35], s41 offen
    s_add_u32 s41, s41, 14336
    s_waitcnt lgkmcnt(1)
    buffer_store_dwordx4 v[72:75], v22, s[32:35], s41 offen
    s_add_u32 s41, s41, 14336
    s_waitcnt lgkmcnt(0)
    buffer_store_dwordx4 v[76:79], v22, s[32:35], s41 offen
    s_add_u32 s41, s41, 14336
    s_endpgm
L3_b:
    s_lshr_b32 s40, s20, 1
    s_and_b32 s41, s20, 1
    s_lshl_b32 s37, s36, 2
    s_lshl_b32 s38, s41, 1
    s_add_u32 s37, s37, s38
    s_lshl_b32 s42, s40, 6
    s_add_u32 s38, s42, 0
    v_xor_b32 v9, s38, v11
    v_add_u32 v9, v8, v9
    v_add_u32 v112, 8192, v9
    s_add_u32 s38, s42, 32
    v_xor_b32 v9, s38, v11
    v_add_u32 v9, v8, v9
    v_add_u32 v113, 8192, v9
    s_add_u32 s38, s42, 0
    v_xor_b32 v9, s38, v11
    v_add_u32 v9, v8, v9
    v_add_u32 v114, 16384, v9
    s_add_u32 s38, s42, 32
    v_xor_b32 v9, s38, v11
    v_add_u32 v9, v8, v9
    v_add_u32 v115, 16384, v9
    s_lshl_b32 s38, s41, 12
    v_add_u32 v16, s38, v12
    v_add_u32 v116, 49152, v112
    v_add_u32 v117, 49152, v113
    v_add_u32 v118, 49152, v114
    v_add_u32 v119, 49152, v115
    v_add_u32 v17, 49152, v16
    v_add_u32 v120, 98304, v112
    v_add_u32 v121, 98304, v113
    v_add_u32 v122, 98304, v114
    v_add_u32 v123, 98304, v115
    v_add_u32 v18, 98304, v16
    s_mul_i32 s38, s20, 4608
    s_add_u32 s38, s38, 49152
    v_mul_u32_u24 v20, 72, v2
    v_lshl_add_u32 v20, v3, 3, v20
    v_add_u32 v20, s38, v20
    v_lshrrev_b32 v9, 2, v1
    v_and_b32 v10, 3, v1
    v_mul_u32_u24 v21, 72, v9
    v_lshl_add_u32 v21, v10, 4, v21
    v_add_u32 v21, s38, v21
    s_lshl_b32 s38, s23, 3
    s_lshl_b32 s39, s40, 2
    s_add_u32 s38, s38, s39
    s_lshr_b32 s39, s38, 6
    s_bfe_u32 s42, s38, 0x10005
    s_and_b32 s38, s38, 31
    s_lshl_b32 s38, s38, 5
    s_lshl_b32 s39, s39, 4
    s_add_u32 s38, s38, s39
    s_lshl_b32 s42, s42, 2
    s_add_u32 s38, s38, s42
    v_and_b32 v4, 3, v9
    v_bfe_u32 v5, v9, 2, 1
    v_lshl_add_u32 v4, v5, 3, v4
    v_lshrrev_b32 v5, 3, v9
    v_lshl_add_u32 v4, v5, 5, v4
    v_mul_u32_u24 v22, 1792, v4
    v_lshl_add_u32 v22, v10, 4, v22
    s_mul_i32 s38, s38, 1792
    s_lshl_b32 s37, s37, 5
    s_add_u32 s38, s38, s37
    s_add_u32 s41, s38, 896
    s_waitcnt lgkmcnt(0)
    s_mov_b32 s32, s6
    s_and_b32 s33, s7, 0xffff
    s_mov_b32 s34, 3670016
    s_mov_b32 s35, 0x20000
    s_barrier
    s_barrier
    ds_read_b128 v[96:99], v16 offset:0
    ds_read_b128 v[100:103], v16 offset:2048
    ds_read_b64_tr_b16 v[64:65], v112 offset:0
    ds_read_b64_tr_b16 v[66:67], v112 offset:1024
    ds_read_b64_tr_b16 v[68:69], v113 offset:0
    ds_read_b64_tr_b16 v[70:71], v113 offset:1024
    ds_read_b64_tr_b16 v[72:73], v114 offset:0
    ds_read_b64_tr_b16 v[74:75], v114 offset:1024
    ds_read_b64_tr_b16 v[76:77], v115 offset:0
    ds_read_b64_tr_b16 v[78:79], v115 offset:1024
    s_waitcnt lgkmcnt(0)
    v_mfma_f32_16x16x32_bf16 v[32:35], v[96:99], v[64:67], v[32:35]
    ds_read_b128 v[104:107], v16 offset:1024
    ds_read_b128 v[108:111], v16 offset:3072
    v_mfma_f32_16x16x32_bf16 v[48:51], v[100:103], v[64:67], v[48:51]
    ds_read_b64_tr_b16 v[80:81], v112 offset:4096
    ds_read_b64_tr_b16 v[82:83], v112 offset:5120
    v_mfma_f32_16x16x32_bf16 v[36:39], v[96:99], v[68:71], v[36:39]
    ds_read_b64_tr_b16 v[84:85], v113 offset:4096
    ds_read_b64_tr_b16 v[86:87], v113 offset:5120
    v_mfma_f32_16x16x32_bf16 v[52:55], v[100:103], v[68:71], v[52:55]
    ds_read_b64_tr_b16 v[88:89], v114 offset:4096
    ds_read_b64_tr_b16 v[90:91], v114 offset:5120
    v_mfma_f32_16x16x32_bf16 v[40:43], v[96:99], v[72:75], v[40:43]
    ds_read_b64_tr_b16 v[92:93], v115 offset:4096
    ds_read_b64_tr_b16 v[94:95], v115 offset:5120
    v_mfma_f32_16x16x32_bf16 v[56:59], v[100:103], v[72:75], v[56:59]
    v_mfma_f32_16x16x32_bf16 v[44:47], v[96:99], v[76:79], v[44:47]
    v_mfma_f32_16x16x32_bf16 v[60:63], v[100:103], v[76:79], v[60:63]
    s_barrier
    s_waitcnt lgkmcnt(0)
    v_mfma_f32_16x16x32_bf16 v[32:35], v[104:107], v[80:83], v[32:35]
    ds_read_b128 v[96:99], v16 offset:24576
    ds_read_b128 v[100:103], v16 offset:26624
    v_mfma_f32_16x16x32_bf16 v[48:51], v[108:111], v[80:83], v[48:51]
    ds_read_b64_tr_b16 v[64:65], v112 offset:24576
    ds_read_b64_tr_b16 v[66:67], v112 offset:25600
    v_mfma_f32_16x16x32_bf16 v[36:39], v[104:107], v[84:87], v[36:39]
    ds_read_b64_tr_b16 v[68:69], v113 offset:24576
    ds_read_b64_tr_b16 v[70:71], v113 offset:25600
    v_mfma_f32_16x16x32_bf16 v[52:55], v[108:111], v[84:87], v[52:55]
    ds_read_b64_tr_b16 v[72:73], v114 offset:24576
    ds_read_b64_tr_b16 v[74:75], v114 offset:25600
    v_mfma_f32_16x16x32_bf16 v[40:43], v[104:107], v[88:91], v[40:43]
    ds_read_b64_tr_b16 v[76:77], v115 offset:24576
    ds_read_b64_tr_b16 v[78:79], v115 offset:25600
    v_mfma_f32_16x16x32_bf16 v[56:59], v[108:111], v[88:91], v[56:59]
    v_mfma_f32_16x16x32_bf16 v[44:47], v[104:107], v[92:95], v[44:47]
    v_mfma_f32_16x16x32_bf16 v[60:63], v[108:111], v[92:95], v[60:63]
    s_waitcnt lgkmcnt(0)
    v_mfma_f32_16x16x32_bf16 v[32:35], v[96:99], v[64:67], v[32:35]
    ds_read_b128 v[104:107], v16 offset:25600
    ds_read_b128 v[108:111], v16 offset:27648
    v_mfma_f32_16x16x32_bf16 v[48:51], v[100:103], v[64:67], v[48:51]
    ds_read_b64_tr_b16 v[80:81], v112 offset:28672
    ds_read_b64_tr_b16 v[82:83], v112 offset:29696
    v_mfma_f32_16x16x32_bf16 v[36:39], v[96:99], v[68:71], v[36:39]
    ds_read_b64_tr_b16 v[84:85], v113 offset:28672
    ds_read_b64_tr_b16 v[86:87], v113 offset:29696
    v_mfma_f32_16x16x32_bf16 v[52:55], v[100:103], v[68:71], v[52:55]
    ds_read_b64_tr_b16 v[88:89], v114 offset:28672
    ds_read_b64_tr_b16 v[90:91], v114 offset:29696
    v_mfma_f32_16x16x32_bf16 v[40:43], v[96:99], v[72:75], v[40:43]
    ds_read_b64_tr_b16 v[92:93], v115 offset:28672
    ds_read_b64_tr_b16 v[94:95], v115 offset:29696
    v_mfma_f32_16x16x32_bf16 v[56:59], v[100:103], v[72:75], v[56:59]
    v_mfma_f32_16x16x32_bf16 v[44:47], v[96:99], v[76:79], v[44:47]
    v_mfma_f32_16x16x32_bf16 v[60:63], v[100:103], v[76:79], v[60:63]
    s_barrier
    s_waitcnt lgkmcnt(0)
    v_mfma_f32_16x16x32_bf16 v[32:35], v[104:107], v[80:83], v[32:35]
    ds_read_b128 v[96:99], v17 offset:0
    ds_read_b128 v[100:103], v17 offset:2048
    v_mfma_f32_16x16x32_bf16 v[48:51], v[108:111], v[80:83], v[48:51]
    ds_read_b64_tr_b16 v[64:65], v116 offset:0
    ds_read_b64_tr_b16 v[66:67], v116 offset:1024
    v_mfma_f32_16x16x32_bf16 v[36:39], v[104:107], v[84:87], v[36:39]
    ds_read_b64_tr_b16 v[68:69], v117 offset:0
    ds_read_b64_tr_b16 v[70:71], v117 offset:1024
    v_mfma_f32_16x16x32_bf16 v[52:55], v[108:111], v[84:87], v[52:55]
    ds_read_b64_tr_b16 v[72:73], v118 offset:0
    ds_read_b64_tr_b16 v[74:75], v118 offset:1024
    v_mfma_f32_16x16x32_bf16 v[40:43], v[104:107], v[88:91], v[40:43]
    ds_read_b64_tr_b16 v[76:77], v119 offset:0
    ds_read_b64_tr_b16 v[78:79], v119 offset:1024
    v_mfma_f32_16x16x32_bf16 v[56:59], v[108:111], v[88:91], v[56:59]
    v_mfma_f32_16x16x32_bf16 v[44:47], v[104:107], v[92:95], v[44:47]
    v_mfma_f32_16x16x32_bf16 v[60:63], v[108:111], v[92:95], v[60:63]
    s_waitcnt lgkmcnt(0)
    v_mfma_f32_16x16x32_bf16 v[32:35], v[96:99], v[64:67], v[32:35]
    ds_read_b128 v[104:107], v17 offset:1024
    ds_read_b128 v[108:111], v17 offset:3072
    v_mfma_f32_16x16x32_bf16 v[48:51], v[100:103], v[64:67], v[48:51]
    ds_read_b64_tr_b16 v[80:81], v116 offset:4096
    ds_read_b64_tr_b16 v[82:83], v116 offset:5120
    v_mfma_f32_16x16x32_bf16 v[36:39], v[96:99], v[68:71], v[36:39]
    ds_read_b64_tr_b16 v[84:85], v117 offset:4096
    ds_read_b64_tr_b16 v[86:87], v117 offset:5120
    v_mfma_f32_16x16x32_bf16 v[52:55], v[100:103], v[68:71], v[52:55]
    ds_read_b64_tr_b16 v[88:89], v118 offset:4096
    ds_read_b64_tr_b16 v[90:91], v118 offset:5120
    v_mfma_f32_16x16x32_bf16 v[40:43], v[96:99], v[72:75], v[40:43]
    ds_read_b64_tr_b16 v[92:93], v119 offset:4096
    ds_read_b64_tr_b16 v[94:95], v119 offset:5120
    v_mfma_f32_16x16x32_bf16 v[56:59], v[100:103], v[72:75], v[56:59]
    v_mfma_f32_16x16x32_bf16 v[44:47], v[96:99], v[76:79], v[44:47]
    v_mfma_f32_16x16x32_bf16 v[60:63], v[100:103], v[76:79], v[60:63]
    s_barrier
    s_waitcnt lgkmcnt(0)
    v_mfma_f32_16x16x32_bf16 v[32:35], v[104:107], v[80:83], v[32:35]
    ds_read_b128 v[96:99], v17 offset:24576
    ds_read_b128 v[100:103], v17 offset:26624
    v_mfma_f32_16x16x32_bf16 v[48:51], v[108:111], v[80:83], v[48:51]
    ds_read_b64_tr_b16 v[64:65], v116 offset:24576
    ds_read_b64_tr_b16 v[66:67], v116 offset:25600
    v_mfma_f32_16x16x32_bf16 v[36:39], v[104:107], v[84:87], v[36:39]
    ds_read_b64_tr_b16 v[68:69], v117 offset:24576
    ds_read_b64_tr_b16 v[70:71], v117 offset:25600
    v_mfma_f32_16x16x32_bf16 v[52:55], v[108:111], v[84:87], v[52:55]
    ds_read_b64_tr_b16 v[72:73], v118 offset:24576
    ds_read_b64_tr_b16 v[74:75], v118 offset:25600
    v_mfma_f32_16x16x32_bf16 v[40:43], v[104:107], v[88:91], v[40:43]
    ds_read_b64_tr_b16 v[76:77], v119 offset:24576
    ds_read_b64_tr_b16 v[78:79], v119 offset:25600
    v_mfma_f32_16x16x32_bf16 v[56:59], v[108:111], v[88:91], v[56:59]
    v_mfma_f32_16x16x32_bf16 v[44:47], v[104:107], v[92:95], v[44:47]
    v_mfma_f32_16x16x32_bf16 v[60:63], v[108:111], v[92:95], v[60:63]
    s_waitcnt lgkmcnt(0)
    v_mfma_f32_16x16x32_bf16 v[32:35], v[96:99], v[64:67], v[32:35]
    ds_read_b128 v[104:107], v17 offset:25600
    ds_read_b128 v[108:111], v17 offset:27648
    v_mfma_f32_16x16x32_bf16 v[48:51], v[100:103], v[64:67], v[48:51]
    ds_read_b64_tr_b16 v[80:81], v116 offset:28672
    ds_read_b64_tr_b16 v[82:83], v116 offset:29696
    v_mfma_f32_16x16x32_bf16 v[36:39], v[96:99], v[68:71], v[36:39]
    ds_read_b64_tr_b16 v[84:85], v117 offset:28672
    ds_read_b64_tr_b16 v[86:87], v117 offset:29696
    v_mfma_f32_16x16x32_bf16 v[52:55], v[100:103], v[68:71], v[52:55]
    ds_read_b64_tr_b16 v[88:89], v118 offset:28672
    ds_read_b64_tr_b16 v[90:91], v118 offset:29696
    v_mfma_f32_16x16x32_bf16 v[40:43], v[96:99], v[72:75], v[40:43]
    ds_read_b64_tr_b16 v[92:93], v119 offset:28672
    ds_read_b64_tr_b16 v[94:95], v119 offset:29696
    v_mfma_f32_16x16x32_bf16 v[56:59], v[100:103], v[72:75], v[56:59]
    v_mfma_f32_16x16x32_bf16 v[44:47], v[96:99], v[76:79], v[44:47]
    v_mfma_f32_16x16x32_bf16 v[60:63], v[100:103], v[76:79], v[60:63]
    s_barrier
    s_waitcnt lgkmcnt(0)
    v_mfma_f32_16x16x32_bf16 v[32:35], v[104:107], v[80:83], v[32:35]
    ds_read_b128 v[96:99], v18 offset:0
    ds_read_b128 v[100:103], v18 offset:2048
    v_mfma_f32_16x16x32_bf16 v[48:51], v[108:111], v[80:83], v[48:51]
    ds_read_b64_tr_b16 v[64:65], v120 offset:0
    ds_read_b64_tr_b16 v[66:67], v120 offset:1024
    v_mfma_f32_16x16x32_bf16 v[36:39], v[104:107], v[84:87], v[36:39]
    ds_read_b64_tr_b16 v[68:69], v121 offset:0
    ds_read_b64_tr_b16 v[70:71], v121 offset:1024
    v_mfma_f32_16x16x32_bf16 v[52:55], v[108:111], v[84:87], v[52:55]
    ds_read_b64_tr_b16 v[72:73], v122 offset:0
    ds_read_b64_tr_b16 v[74:75], v122 offset:1024
    v_mfma_f32_16x16x32_bf16 v[40:43], v[104:107], v[88:91], v[40:43]
    ds_read_b64_tr_b16 v[76:77], v123 offset:0
    ds_read_b64_tr_b16 v[78:79], v123 offset:1024
    v_mfma_f32_16x16x32_bf16 v[56:59], v[108:111], v[88:91], v[56:59]
    v_mfma_f32_16x16x32_bf16 v[44:47], v[104:107], v[92:95], v[44:47]
    v_mfma_f32_16x16x32_bf16 v[60:63], v[108:111], v[92:95], v[60:63]
    s_waitcnt lgkmcnt(0)
    v_mfma_f32_16x16x32_bf16 v[32:35], v[96:99], v[64:67], v[32:35]
    ds_read_b128 v[104:107], v18 offset:1024
    ds_read_b128 v[108:111], v18 offset:3072
    v_mfma_f32_16x16x32_bf16 v[48:51], v[100:103], v[64:67], v[48:51]
    ds_read_b64_tr_b16 v[80:81], v120 offset:4096
    ds_read_b64_tr_b16 v[82:83], v120 offset:5120
    v_mfma_f32_16x16x32_bf16 v[36:39], v[96:99], v[68:71], v[36:39]
    ds_read_b64_tr_b16 v[84:85], v121 offset:4096
    ds_read_b64_tr_b16 v[86:87], v121 offset:5120
    v_mfma_f32_16x16x32_bf16 v[52:55], v[100:103], v[68:71], v[52:55]
    ds_read_b64_tr_b16 v[88:89], v122 offset:4096
    ds_read_b64_tr_b16 v[90:91], v122 offset:5120
    v_mfma_f32_16x16x32_bf16 v[40:43], v[96:99], v[72:75], v[40:43]
    ds_read_b64_tr_b16 v[92:93], v123 offset:4096
    ds_read_b64_tr_b16 v[94:95], v123 offset:5120
    v_mfma_f32_16x16x32_bf16 v[56:59], v[100:103], v[72:75], v[56:59]
    v_mfma_f32_16x16x32_bf16 v[44:47], v[96:99], v[76:79], v[44:47]
    v_mfma_f32_16x16x32_bf16 v[60:63], v[100:103], v[76:79], v[60:63]
    s_barrier
    s_waitcnt lgkmcnt(0)
    v_mfma_f32_16x16x32_bf16 v[32:35], v[104:107], v[80:83], v[32:35]
    ds_read_b128 v[96:99], v18 offset:24576
    ds_read_b128 v[100:103], v18 offset:26624
    v_mfma_f32_16x16x32_bf16 v[48:51], v[108:111], v[80:83], v[48:51]
    ds_read_b64_tr_b16 v[64:65], v120 offset:24576
    ds_read_b64_tr_b16 v[66:67], v120 offset:25600
    v_mfma_f32_16x16x32_bf16 v[36:39], v[104:107], v[84:87], v[36:39]
    ds_read_b64_tr_b16 v[68:69], v121 offset:24576
    ds_read_b64_tr_b16 v[70:71], v121 offset:25600
    v_mfma_f32_16x16x32_bf16 v[52:55], v[108:111], v[84:87], v[52:55]
    ds_read_b64_tr_b16 v[72:73], v122 offset:24576
    ds_read_b64_tr_b16 v[74:75], v122 offset:25600
    v_mfma_f32_16x16x32_bf16 v[40:43], v[104:107], v[88:91], v[40:43]
    ds_read_b64_tr_b16 v[76:77], v123 offset:24576
    ds_read_b64_tr_b16 v[78:79], v123 offset:25600
    v_mfma_f32_16x16x32_bf16 v[56:59], v[108:111], v[88:91], v[56:59]
    v_mfma_f32_16x16x32_bf16 v[44:47], v[104:107], v[92:95], v[44:47]
    v_mfma_f32_16x16x32_bf16 v[60:63], v[108:111], v[92:95], v[60:63]
    s_waitcnt lgkmcnt(0)
    v_mfma_f32_16x16x32_bf16 v[32:35], v[96:99], v[64:67], v[32:35]
    ds_read_b128 v[104:107], v18 offset:25600
    ds_read_b128 v[108:111], v18 offset:27648
    v_mfma_f32_16x16x32_bf16 v[48:51], v[100:103], v[64:67], v[48:51]
    ds_read_b64_tr_b16 v[80:81], v120 offset:28672
    ds_read_b64_tr_b16 v[82:83], v120 offset:29696
    v_mfma_f32_16x16x32_bf16 v[36:39], v[96:99], v[68:71], v[36:39]
    ds_read_b64_tr_b16 v[84:85], v121 offset:28672
    ds_read_b64_tr_b16 v[86:87], v121 offset:29696
    v_mfma_f32_16x16x32_bf16 v[52:55], v[100:103], v[68:71], v[52:55]
    ds_read_b64_tr_b16 v[88:89], v122 offset:28672
    ds_read_b64_tr_b16 v[90:91], v122 offset:29696
    v_mfma_f32_16x16x32_bf16 v[40:43], v[96:99], v[72:75], v[40:43]
    ds_read_b64_tr_b16 v[92:93], v123 offset:28672
    ds_read_b64_tr_b16 v[94:95], v123 offset:29696
    v_mfma_f32_16x16x32_bf16 v[56:59], v[100:103], v[72:75], v[56:59]
    v_mfma_f32_16x16x32_bf16 v[44:47], v[96:99], v[76:79], v[44:47]
    v_mfma_f32_16x16x32_bf16 v[60:63], v[100:103], v[76:79], v[60:63]
    s_barrier
    s_waitcnt lgkmcnt(0)
    v_mfma_f32_16x16x32_bf16 v[32:35], v[104:107], v[80:83], v[32:35]
    ds_read_b128 v[96:99], v16 offset:0
    ds_read_b128 v[100:103], v16 offset:2048
    v_mfma_f32_16x16x32_bf16 v[48:51], v[108:111], v[80:83], v[48:51]
    ds_read_b64_tr_b16 v[64:65], v112 offset:0
    ds_read_b64_tr_b16 v[66:67], v112 offset:1024
    v_mfma_f32_16x16x32_bf16 v[36:39], v[104:107], v[84:87], v[36:39]
    ds_read_b64_tr_b16 v[68:69], v113 offset:0
    ds_read_b64_tr_b16 v[70:71], v113 offset:1024
    v_mfma_f32_16x16x32_bf16 v[52:55], v[108:111], v[84:87], v[52:55]
    ds_read_b64_tr_b16 v[72:73], v114 offset:0
    ds_read_b64_tr_b16 v[74:75], v114 offset:1024
    v_mfma_f32_16x16x32_bf16 v[40:43], v[104:107], v[88:91], v[40:43]
    ds_read_b64_tr_b16 v[76:77], v115 offset:0
    ds_read_b64_tr_b16 v[78:79], v115 offset:1024
    v_mfma_f32_16x16x32_bf16 v[56:59], v[108:111], v[88:91], v[56:59]
    v_mfma_f32_16x16x32_bf16 v[44:47], v[104:107], v[92:95], v[44:47]
    v_mfma_f32_16x16x32_bf16 v[60:63], v[108:111], v[92:95], v[60:63]
    s_waitcnt lgkmcnt(0)
    v_mfma_f32_16x16x32_bf16 v[32:35], v[96:99], v[64:67], v[32:35]
    ds_read_b128 v[104:107], v16 offset:1024
    ds_read_b128 v[108:111], v16 offset:3072
    v_mfma_f32_16x16x32_bf16 v[48:51], v[100:103], v[64:67], v[48:51]
    ds_read_b64_tr_b16 v[80:81], v112 offset:4096
    ds_read_b64_tr_b16 v[82:83], v112 offset:5120
    v_mfma_f32_16x16x32_bf16 v[36:39], v[96:99], v[68:71], v[36:39]
    ds_read_b64_tr_b16 v[84:85], v113 offset:4096
    ds_read_b64_tr_b16 v[86:87], v113 offset:5120
    v_mfma_f32_16x16x32_bf16 v[52:55], v[100:103], v[68:71], v[52:55]
    ds_read_b64_tr_b16 v[88:89], v114 offset:4096
    ds_read_b64_tr_b16 v[90:91], v114 offset:5120
    v_mfma_f32_16x16x32_bf16 v[40:43], v[96:99], v[72:75], v[40:43]
    ds_read_b64_tr_b16 v[92:93], v115 offset:4096
    ds_read_b64_tr_b16 v[94:95], v115 offset:5120
    v_mfma_f32_16x16x32_bf16 v[56:59], v[100:103], v[72:75], v[56:59]
    v_mfma_f32_16x16x32_bf16 v[44:47], v[96:99], v[76:79], v[44:47]
    v_mfma_f32_16x16x32_bf16 v[60:63], v[100:103], v[76:79], v[60:63]
    s_waitcnt lgkmcnt(0)
    v_mfma_f32_16x16x32_bf16 v[32:35], v[104:107], v[80:83], v[32:35]
    v_mfma_f32_16x16x32_bf16 v[48:51], v[108:111], v[80:83], v[48:51]
    v_mfma_f32_16x16x32_bf16 v[36:39], v[104:107], v[84:87], v[36:39]
    v_mfma_f32_16x16x32_bf16 v[52:55], v[108:111], v[84:87], v[52:55]
    v_mfma_f32_16x16x32_bf16 v[40:43], v[104:107], v[88:91], v[40:43]
    v_mfma_f32_16x16x32_bf16 v[56:59], v[108:111], v[88:91], v[56:59]
    v_mfma_f32_16x16x32_bf16 v[44:47], v[104:107], v[92:95], v[44:47]
    v_mfma_f32_16x16x32_bf16 v[60:63], v[108:111], v[92:95], v[60:63]
    s_nop 7
    v_add_f32 v64, v32, v40
    v_sub_f32 v40, v32, v40
    v_add_f32 v65, v33, v41
    v_sub_f32 v41, v33, v41
    v_add_f32 v66, v34, v42
    v_sub_f32 v42, v34, v42
    v_add_f32 v67, v35, v43
    v_sub_f32 v43, v35, v43
    v_cvt_pk_bf16_f32 v32, v64, v65
    v_cvt_pk_bf16_f32 v33, v66, v67
    v_cvt_pk_bf16_f32 v34, v40, v41
    v_cvt_pk_bf16_f32 v35, v42, v43
    ds_write_b64 v20, v[32:33] offset:0
    ds_write_b64 v20, v[34:35] offset:2304
    v_add_f32 v68, v48, v56
    v_sub_f32 v56, v48, v56
    v_add_f32 v69, v49, v57
    v_sub_f32 v57, v49, v57
    v_add_f32 v70, v50, v58
    v_sub_f32 v58, v50, v58
    v_add_f32 v71, v51, v59
    v_sub_f32 v59, v51, v59
    v_cvt_pk_bf16_f32 v48, v68, v69
    v_cvt_pk_bf16_f32 v49, v70, v71
    v_cvt_pk_bf16_f32 v50, v56, v57
    v_cvt_pk_bf16_f32 v51, v58, v59
    ds_write_b64 v20, v[48:49] offset:32
    ds_write_b64 v20, v[50:51] offset:2336
    v_add_f32 v72, v36, v44
    v_sub_f32 v44, v36, v44
    v_add_f32 v73, v37, v45
    v_sub_f32 v45, v37, v45
    v_add_f32 v74, v38, v46
    v_sub_f32 v46, v38, v46
    v_add_f32 v75, v39, v47
    v_sub_f32 v47, v39, v47
    v_cvt_pk_bf16_f32 v36, v72, v73
    v_cvt_pk_bf16_f32 v37, v74, v75
    v_cvt_pk_bf16_f32 v38, v44, v45
    v_cvt_pk_bf16_f32 v39, v46, v47
    ds_write_b64 v20, v[36:37] offset:1152
    ds_write_b64 v20, v[38:39] offset:3456
    v_add_f32 v76, v52, v60
    v_sub_f32 v60, v52, v60
    v_add_f32 v77, v53, v61
    v_sub_f32 v61, v53, v61
    v_add_f32 v78, v54, v62
    v_sub_f32 v62, v54, v62
    v_add_f32 v79, v55, v63
    v_sub_f32 v63, v55, v63
    v_cvt_pk_bf16_f32 v52, v76, v77
    v_cvt_pk_bf16_f32 v53, v78, v79
    v_cvt_pk_bf16_f32 v54, v60, v61
    v_cvt_pk_bf16_f32 v55, v62, v63
    ds_write_b64 v20, v[52:53] offset:1184
    ds_write_b64 v20, v[54:55] offset:3488
    s_waitcnt lgkmcnt(0)
    ds_read_b64 v[80:81], v21 offset:0
    ds_read_b64 v[82:83], v21 offset:8
    ds_read_b64 v[84:85], v21 offset:1152
    ds_read_b64 v[86:87], v21 offset:1160
    ds_read_b64 v[88:89], v21 offset:2304
    ds_read_b64 v[90:91], v21 offset:2312
    ds_read_b64 v[92:93], v21 offset:3456
    ds_read_b64 v[94:95], v21 offset:3464
    s_add_u32 s39, s41, 0
    s_waitcnt lgkmcnt(6)
    buffer_store_dwordx4 v[80:83], v22, s[32:35], s39 offen
    s_add_u32 s39, s41, 114688
    s_waitcnt lgkmcnt(4)
    buffer_store_dwordx4 v[84:87], v22, s[32:35], s39 offen
    s_add_u32 s39, s41, 1835008
    s_waitcnt lgkmcnt(2)
    buffer_store_dwordx4 v[88:91], v22, s[32:35], s39 offen
    s_add_u32 s39, s41, 1949696
    s_waitcnt lgkmcnt(0)
    buffer_store_dwordx4 v[92:95], v22, s[32:35], s39 offen
L3_end:
    s_endpgm
L_code_end:
.section .rodata,"a"
.p2align 6
.amdhsa_kernel concat_heads__mha_block__spectral_gfnet__prompt_kernel
  .amdhsa_next_free_vgpr 168
  .amdhsa_next_free_sgpr 102
  .amdhsa_accum_offset 168
  .amdhsa_group_segment_fixed_size 0
  .amdhsa_kernarg_size 72
  .amdhsa_user_sgpr_count 2
  .amdhsa_user_sgpr_kernarg_segment_ptr 1
  .amdhsa_system_sgpr_workgroup_id_x 1
.end_amdhsa_kernel
.p2align 8
ffttab:
.quad 0x3f803f803f803f80,0x3f803f803f803f80,0x3f553f6d3f7b3f80,0xbf0ebec4be48248d,0x3ec43f353f6d3f80,0xbec4bf35bf6dbf80,0xbe483ec43f553f80,0x3f7b3f6d3f0ea554
.quad 0xbf35248d3f353f80,0xbf3525b03f353f80,0xbf7bbec43f0e3f80,0xbe48bf6dbf5525b0,0xbf6dbf353ec43f80,0x3f6d3f35bec4bf80,0xbf0ebf6d3e483f80,0xbf553ec43f7ba5f7
.quad 0xa554bf80248d3f80,0xa731bf80261f3f80,0x3f0ebf6dbe483f80,0x3f553ec4bf7b261f,0x3f6dbf35bec43f80,0xbf6d3f353ec4bf80,0x3f7bbec4bf0e3f80,0x3e48bf6d3f55a731
.quad 0x3f35a554bf353f80,0x3f35a742bf353f80,0x3e483ec4bf553f80,0xbf7b3f6dbf0ea68d,0xbec43f35bf6d3f80,0x3ec4bf353f6dbf80,0xbf553f6dbf7b3f80,0x3f0ebec43e48a742
.quad 0xbf803f80bf803f80,0xbf803f80bf803f80,0xbf553f6dbf7b3f80,0x3f0ebec43e48a654,0xbec43f35bf6d3f80,0x3ec4bf353f6dbf80,0x3e483ec4bf553f80,0xbf7b3f6dbf0ea754
.quad 0x3f3525b0bf353f80,0x3f35a58ebf353f80,0x3f7bbec4bf0e3f80,0x3e48bf6d3f55a60d,0x3f6dbf35bec43f80,0xbf6d3f353ec4bf80,0x3f0ebf6dbe483f80,0x3f553ec4bf7ba765
.quad 0x261fbf80a5543f80,0x258dbf80a7773f80,0xbf0ebf6d3e483f80,0xbf553ec43f7ba58e,0xbf6dbf353ec43f80,0x3f6d3f35bec4bf80,0xbf7bbec43f0e3f80,0xbe48bf6dbf55a777
.quad 0xbf35a5f73f353f80,0xbf35a78d3f353f80,0xbe483ec43f553f80,0x3f7b3f6d3f0ea137,0x3ec43f353f6d3f80,0xbec4bf35bf6dbf80,0x3f553f6d3f7b3f80,0xbf0ebec4be48a784
.quad 0x3f803f803f803f80,0x3f803f803f803f80,0x3e483ec43f0e3f35,0xbf7bbf6dbf55bf35,0xbf6dbf35bec4248d,0x3f6d3f353ec4a554,0xbf0ebf6dbf7bbf35,0xbf55bec43e483f35
.quad 0x3f35a554bf35bf80,0x3f35a5f7bf35bf80,0x3f553f6d3e48bf35,0xbf0e3ec43f7b3f35,0xbec43f353f6da554,0x3ec4bf35bf6d261f,0xbf7bbec43f553f35,0xbe483f6d3f0ebf35
.quad 0xa5f7bf8025b03f80,0xa742bf80a68d3f80,0x3f7bbec4bf553f35,0x3e483f6dbf0ebf35,0x3ec43f35bf6d25b0,0xbec4bf353f6da742,0xbf553f6dbe48bf35,0x3f0e3ec4bf7b3f35
.quad 0xbf35261f3f35bf80,0xbf35a60d3f35bf80,0x3f0ebf6d3f7bbf35,0x3f55bec4be483f35,0x3f6dbf353ec4a5f7,0xbf6d3f35bec4a60d,0xbe483ec4bf0e3f35,0x3f7bbf6d3f55bf35
.quad 0xbf803f80bf803f80,0xbf803f80bf803f80,0xbe483ec4bf0e3f35,0x3f7bbf6d3f55bf35,0x3f6dbf353ec4261f,0xbf6d3f35bec4a777,0x3f0ebf6d3f7bbf35,0x3f55bec4be483f35
.quad 0xbf35a7423f35bf80,0xbf35a78d3f35bf80,0xbf553f6dbe48bf35,0x3f0e3ec4bf7b3f35,0x3ec43f35bf6da731,0xbec4bf353f6d2804,0x3f7bbec4bf553f35,0x3e483f6dbf0ebf35
.quad 0xa60dbf80a7423f80,0x268dbf80a7963f80,0xbf7bbec43f553f35,0xbe483f6d3f0ebf35,0xbec43f353f6da68d,0x3ec4bf35bf6d2754,0x3f553f6d3e48bf35,0xbf0e3ec43f7b3f35
.quad 0x3f35a60dbf35bf80,0x3f352816bf35bf80,0xbf0ebf6dbf7bbf35,0xbf55bec43e483f35,0xbf6dbf35bec4a742,0x3f6d3f353ec42889,0x3e483ec43f0e3f35,0xbf7bbf6dbf55bf35
.quad 0x3f803f803f803f80,0x3f803f803f803f80,0xbf55bf6dbf7bbf80,0x3f0e3ec43e48a554,0x3ec43f353f6d3f80,0xbec4bf35bf6dbf80,0x3e48bec4bf55bf80,0xbf7bbf6dbf0e261f
.quad 0xbf35261f3f353f80,0xbf35a68d3f353f80,0x3f7b3ec4bf0ebf80,0x3e483f6d3f55a742,0xbf6dbf353ec43f80,0x3f6d3f35bec4bf80,0x3f0e3f6dbe48bf80,0x3f55bec4bf7ba60d
.quad 0xa754bf80a6543f80,0xa777bf80a58e3f80,0xbf0e3f6d3e48bf80,0xbf55bec43f7ba777,0x3f6dbf35bec43f80,0xbf6d3f353ec4bf80,0xbf7b3ec43f0ebf80,0xbe483f6dbf552804
.quad 0x3f35a777bf353f80,0x3f35a796bf353f80,0xbe48bec43f55bf80,0x3f7bbf6d3f0e2754,0xbec43f35bf6d3f80,0x3ec4bf353f6dbf80,0x3f55bf6d3f7bbf80,0xbf0e3ec4be482889
.quad 0xbf803f80bf803f80,0xbf803f80bf803f80,0x3f55bf6d3f7bbf80,0xbf0e3ec4be482828,0xbec43f35bf6d3f80,0x3ec4bf353f6dbf80,0xbe48bec43f55bf80,0x3f7bbf6d3f0e281f
.quad 0x3f35268dbf353f80,0x3f352828bf353f80,0xbf7b3ec43f0ebf80,0xbe483f6dbf5526d4,0x3f6dbf35bec43f80,0xbf6d3f353ec4bf80,0xbf0e3f6d3e48bf80,0xbf55bec43f7b2730
.quad 0x281fbf80a7b13f80,0x2839bf80a7e53f80,0x3f0e3f6dbe48bf80,0x3f55bec4bf7ba7e5,0xbf6dbf353ec43f80,0x3f6d3f35bec4bf80,0x3f7b3ec4bf0ebf80,0x3e483f6d3f552839
.quad 0xbf3526d43f353f80,0xbf35a8043f353f80,0x3e48bec4bf55bf80,0xbf7bbf6dbf0ea880,0x3ec43f353f6d3f80,0xbec4bf35bf6dbf80,0xbf55bf6dbf7bbf80,0x3f0e3ec43e4828a3
.quad 0x3f803f803f803f80,0x3f803f803f803f80,0xbe48bec4bf0ebf35,0x3f7b3f6d3f553f35,0xbf6dbf35bec425b0,0x3f6d3f353ec4a5f7,0x3f0e3f6d3f7b3f35,0x3f553ec4be48bf35
.quad 0x3f35a731bf35bf80,0x3f35a742bf35bf80,0xbf55bf6dbe483f35,0x3f0ebec4bf7bbf35,0xbec43f353f6da742,0x3ec4bf35bf6da60d,0x3f7b3ec4bf55bf35,0x3e48bf6dbf0e3f35
.quad 0xa765bf80a60d3f80,0xa784bf80a1373f80,0xbf7b3ec43f55bf35,0xbe48bf6d3f0e3f35,0x3ec43f35bf6da58e,0xbec4bf353f6da78d,0x3f55bf6d3e483f35,0xbf0ebec43f7bbf35
.quad 0xbf35258d3f35bf80,0xbf35268d3f35bf80,0xbf0e3f6dbf7b3f35,0xbf553ec43e48bf35,0x3f6dbf353ec4a78d,0xbf6d3f35bec42816,0x3e48bec43f0ebf35,0xbf7b3f6dbf553f35
.quad 0xbf803f80bf803f80,0xbf803f80bf803f80,0x3e48bec43f0ebf35,0xbf7b3f6dbf553f35,0x3f6dbf353ec4268d,0xbf6d3f35bec426d4,0xbf0e3f6dbf7b3f35,0xbf553ec43e48bf35
.quad 0xbf35270d3f35bf80,0xbf35a7e53f35bf80,0x3f55bf6d3e483f35,0xbf0ebec43f7bbf35,0x3ec43f35bf6da85d,0xbec4bf353f6d289a,0xbf7b3ec43f55bf35,0xbe48bf6d3f0e3f35
.quad 0x2730bf8026d43f80,0x28a3bf80a8803f80,0x3f7b3ec4bf55bf35,0x3e48bf6dbf0e3f35,0xbec43f353f6da7b1,0x3ec4bf35bf6d28be,0xbf55bf6dbe483f35,0x3f0ebec4bf7bbf35
.quad 0x3f352754bf35bf80,0x3f35a731bf35bf80,0x3f0e3f6d3f7b3f35,0x3f553ec4be48bf35,0xbf6dbf35bec4a7e5,0x3f6d3f353ec428ea,0xbe48bec4bf0ebf35,0x3f7b3f6d3f553f35
.quad 0x8000800080008000,0x8000800080008000,0xbf0ebec4be488000,0xbf55bf6dbf7bbf80,0xbf6dbf35bec48000,0x3f6d3f353ec4a50d,0xbf7bbf6dbf0e8000,0xbe483ec43f553f80
.quad 0xbf35bf80bf358000,0xbf35bf80bf35258d,0xbe48bf6dbf558000,0x3f7b3ec4bf0ebf80,0x3ec4bf35bf6d8000,0xbec43f353f6da5d4,0x3f55bec4bf7b8000,0xbf0ebf6d3e483f80
.quad 0x3f80a50dbf808000,0x3f80a630bf80260d,0x3f553ec4bf7b8000,0xbf0e3f6d3e48bf80,0x3ec43f35bf6d8000,0xbec4bf353f6da630,0xbe483f6dbf558000,0x3f7bbec4bf0e3f80
.quad 0xbf353f80bf358000,0xbf353f80bf352654,0xbf7b3f6dbf0e8000,0xbe48bec43f55bf80,0xbf6d3f35bec48000,0x3f6dbf353ec4a677,0xbf0e3ec4be488000,0xbf553f6dbf7b3f80
.quad 0xa5d4258da50d8000,0xa7b126b0a69f268d,0x3f0ebec43e488000,0x3f55bf6d3f7bbf80,0x3f6dbf353ec48000,0xbf6d3f35bec4a69f,0x3f7bbf6d3f0e8000,0x3e483ec4bf553f80
.quad 0x3f35bf803f358000,0x3f35bf803f3526b0,0x3e48bf6d3f558000,0xbf7b3ec43f0ebf80,0xbec4bf353f6d8000,0x3ec43f35bf6da7b1,0xbf55bec43f7b8000,0x3f0ebf6dbe483f80
.quad 0xbf80a5d43f808000,0xbf80a7c23f8026d4,0xbf553ec43f7b8000,0x3f0e3f6dbe48bf80,0xbec43f353f6d8000,0x3ec4bf35bf6d270d,0x3e483f6d3f558000,0xbf7bbec43f0e3f80
.quad 0x3f353f803f358000,0x3f353f803f3526f7,0x3f7b3f6d3f0e8000,0x3e48bec4bf55bf80,0x3f6d3f353ec48000,0xbf6dbf35bec4a7c2,0x3f0e3ec43e488000,0x3f553f6d3f7b3f80
.quad 0x8000800080008000,0x8000800080008000,0xbf7bbf6dbf55bf35,0xbe48bec4bf0ebf35,0xbec4bf35bf6dbf80,0x3ec43f353f6d3f80,0x3f553ec4be48bf35,0xbf0ebf6dbf7bbf35
.quad 0x3f353f803f35a50d,0x3f353f803f35a5d4,0xbf0e3ec43f7b3f35,0xbf55bf6dbe483f35,0xbf6dbf353ec43f80,0x3f6d3f35bec4bf80,0x3e48bf6dbf0e3f35,0xbf7bbec43f553f35
.quad 0x3f80a5d4bf80258d,0x3f80a677bf802654,0x3e483f6dbf0ebf35,0xbf7b3ec43f55bf35,0xbf6d3f353ec4bf80,0x3f6dbf35bec43f80,0xbf0ebec43f7bbf35,0xbf553f6dbe48bf35
.quad 0x3f35bf803f35a5d4,0x3f35bf803f35a69f,0x3f55bec4be483f35,0xbf0e3f6dbf7b3f35,0xbec43f35bf6d3f80,0x3ec4bf353f6dbf80,0xbf7b3f6dbf553f35,0xbe483ec4bf0e3f35
.quad 0xa6772654a630260d,0xa7c226f7270d26d4,0x3f7bbf6d3f55bf35,0x3e48bec43f0ebf35,0x3ec4bf353f6dbf80,0xbec43f35bf6d3f80,0xbf553ec43e48bf35,0x3f0ebf6d3f7bbf35
.quad 0xbf353f80bf35a630,0xbf353f80bf35a7c2,0x3f0e3ec4bf7b3f35,0x3f55bf6d3e483f35,0x3f6dbf35bec43f80,0xbf6d3f353ec4bf80,0xbe48bf6d3f0e3f35,0x3f7bbec4bf553f35
.quad 0xbf80a69f3f802654,0xbf80268d3f80271f,0xbe483f6d3f0ebf35,0x3f7b3ec4bf55bf35,0x3f6d3f35bec4bf80,0xbf6dbf353ec43f80,0x3f0ebec4bf7bbf35,0x3f553f6d3e48bf35
.quad 0xbf35bf80bf35a677,0xbf35bf80bf35268d,0xbf55bec43e483f35,0x3f0e3f6d3f7b3f35,0x3ec43f353f6d3f80,0xbec4bf35bf6dbf80,0x3f7b3f6d3f553f35,0x3e483ec43f0e3f35
.quad 0x8000800080008000,0x8000800080008000,0x3f0e3ec43e48a50d,0x3f553f6d3f7b3f80,0xbf6dbf35bec4258d,0x3f6d3f353ec4a5d4,0x3f7b3f6d3f0ea5d4,0x3e48bec4bf55bf80
.quad 0xbf35bf80bf35260d,0xbf35bf80bf352654,0x3e483f6d3f55a630,0xbf7bbec43f0e3f80,0x3ec4bf35bf6d2654,0xbec43f353f6da69f,0xbf553ec43f7ba677,0x3f0e3f6dbe48bf80
.quad 0x3f80a69fbf80268d,0x3f80270dbf8026d4,0xbf55bec43f7ba69f,0x3f0ebf6dbe483f80,0x3ec43f35bf6d26b0,0xbec4bf353f6da7c2,0x3e48bf6d3f55a7b1,0xbf7b3ec43f0ebf80
.quad 0xbf353f80bf3526d4,0xbf353f80bf35271f,0x3f7bbf6d3f0e270d,0x3e483ec4bf553f80,0xbf6d3f35bec426f7,0x3f6dbf353ec4268d,0x3f0ebec43e48a7c2,0x3f55bf6d3f7bbf80
.quad 0xa7d4271f26d4270d,0xa7f7a78d260e2754,0xbf0e3ec4be4826d4,0xbf553f6dbf7b3f80,0x3f6dbf353ec4271f,0xbf6d3f35bec4a7f7,0xbf7b3f6dbf0ea7d4,0xbe48bec43f55bf80
.quad 0x3f35bf803f352730,0x3f35bf803f352842,0xbe483f6dbf55268d,0x3f7bbec4bf0e3f80,0xbec4bf353f6d2831,0x3ec43f35bf6da884,0x3f553ec4bf7ba7e5,0xbf0e3f6d3e48bf80
.quad 0xbf80a7f73f802754,0xbf80a8163f80279f,0x3f55bec4bf7b260e,0xbf0ebf6d3e483f80,0xbec43f353f6da78d,0x3ec4bf35bf6d27d4,0xbe48bf6dbf55a7f7,0x3f7b3ec4bf0ebf80
.quad 0x3f353f803f352777,0x3f353f803f35a70d,0xbf7bbf6dbf0e21b7,0xbe483ec43f553f80,0x3f6d3f353ec42842,0xbf6dbf35bec4a909,0xbf0ebec4be48a804,0xbf55bf6dbf7bbf80
.quad 0x8000800080008000,0x8000800080008000,0x3f7b3f6d3f553f35,0x3e483ec43f0e3f35,0xbec4bf35bf6dbf80,0x3ec43f353f6d3f80,0xbf55bec43e483f35,0x3f0e3f6d3f7b3f35
.quad 0x3f353f803f35a630,0x3f353f803f35a677,0x3f0ebec4bf7bbf35,0x3f553f6d3e48bf35,0xbf6dbf353ec43f80,0x3f6d3f35bec4bf80,0xbe483f6d3f0ebf35,0x3f7b3ec4bf55bf35
.quad 0x3f80a7b1bf8026b0,0x3f80a7c2bf8026f7,0xbe48bf6d3f0e3f35,0x3f7bbec4bf553f35,0xbf6d3f353ec4bf80,0x3f6dbf35bec43f80,0x3f0e3ec4bf7b3f35,0x3f55bf6d3e483f35
.quad 0x3f35bf803f35a7c2,0x3f35bf803f35268d,0xbf553ec43e48bf35,0x3f0ebf6d3f7bbf35,0xbec43f35bf6d3f80,0x3ec4bf353f6dbf80,0x3f7bbf6d3f55bf35,0x3e48bec43f0ebf35
.quad 0xa7e52831268d2730,0xa804284221b72777,0xbf7b3f6dbf553f35,0xbe483ec4bf0e3f35,0x3ec4bf353f6dbf80,0xbec43f35bf6d3f80,0x3f55bec4be483f35,0xbf0e3f6dbf7b3f35
.quad 0xbf353f80bf35260e,0xbf353f80bf35a80d,0xbf0ebec43f7bbf35,0xbf553f6dbe48bf35,0x3f6dbf35bec43f80,0xbf6d3f353ec4bf80,0x3e483f6dbf0ebf35,0xbf7b3ec43f55bf35
.quad 0xbf80a60d3f802842,0xbf80a70d3f80a70d,0x3e48bf6dbf0e3f35,0xbf7bbec43f553f35,0x3f6d3f35bec4bf80,0xbf6dbf353ec43f80,0xbf0e3ec43f7b3f35,0xbf55bf6dbe483f35
.quad 0xbf35bf80bf35a80d,0xbf35bf80bf35a896,0x3f553ec4be48bf35,0xbf0ebf6dbf7bbf35,0x3ec43f353f6d3f80,0xbec4bf35bf6dbf80,0xbf7bbf6dbf55bf35,0xbe48bec4bf0ebf35
.quad 0x0,0x0,0x3f0e3ec43e480000,0x3f553f6d3f7b3f80,0x3f6d3f353ec40000,0xbf6dbf35bec4250d,0x3f7b3f6d3f0e0000,0x3e48bec4bf55bf80
.quad 0x3f353f803f350000,0x3f353f803f35a58d,0x3e483f6d3f550000,0xbf7bbec43f0e3f80,0xbec43f353f6d0000,0x3ec4bf35bf6d25d4,0xbf553ec43f7b0000,0x3f0e3f6dbe48bf80
.quad 0xbf80250d3f800000,0xbf8026303f80a60d,0xbf55bec43f7b0000,0x3f0ebf6dbe483f80,0xbec4bf353f6d0000,0x3ec43f35bf6d2630,0x3e48bf6d3f550000,0xbf7b3ec43f0ebf80
.quad 0x3f35bf803f350000,0x3f35bf803f35a654,0x3f7bbf6d3f0e0000,0x3e483ec4bf553f80,0x3f6dbf353ec40000,0xbf6d3f35bec42677,0x3f0ebec43e480000,0x3f55bf6d3f7bbf80
.quad 0x25d4a58d250d0000,0x27b1a6b0269fa68d,0xbf0e3ec4be480000,0xbf553f6dbf7b3f80,0xbf6d3f35bec40000,0x3f6dbf353ec4269f,0xbf7b3f6dbf0e0000,0xbe48bec43f55bf80
.quad 0xbf353f80bf350000,0xbf353f80bf35a6b0,0xbe483f6dbf550000,0x3f7bbec4bf0e3f80,0x3ec43f35bf6d0000,0xbec4bf353f6d27b1,0x3f553ec4bf7b0000,0xbf0e3f6d3e48bf80
.quad 0x3f8025d4bf800000,0x3f8027c2bf80a6d4,0x3f55bec4bf7b0000,0xbf0ebf6d3e483f80,0x3ec4bf35bf6d0000,0xbec43f353f6da70d,0xbe48bf6dbf550000,0x3f7b3ec4bf0ebf80
.quad 0xbf35bf80bf350000,0xbf35bf80bf35a6f7,0xbf7bbf6dbf0e0000,0xbe483ec43f553f80,0xbf6dbf35bec40000,0x3f6d3f353ec427c2,0xbf0ebec4be480000,0xbf55bf6dbf7bbf80
.quad 0x0,0x0,0x3f7b3f6d3f553f35,0x3e483ec43f0e3f35,0x3ec43f353f6d3f80,0xbec4bf35bf6dbf80,0xbf55bec43e483f35,0x3f0e3f6d3f7b3f35
.quad 0xbf35bf80bf35250d,0xbf35bf80bf3525d4,0x3f0ebec4bf7bbf35,0x3f553f6d3e48bf35,0x3f6d3f35bec4bf80,0xbf6dbf353ec43f80,0xbe483f6d3f0ebf35,0x3f7b3ec4bf55bf35
.quad 0xbf8025d43f80a58d,0xbf8026773f80a654,0xbe48bf6d3f0e3f35,0x3f7bbec4bf553f35,0x3f6dbf35bec43f80,0xbf6d3f353ec4bf80,0x3f0e3ec4bf7b3f35,0x3f55bf6d3e483f35
.quad 0xbf353f80bf3525d4,0xbf353f80bf35269f,0xbf553ec43e48bf35,0x3f0ebf6d3f7bbf35,0x3ec4bf353f6dbf80,0xbec43f35bf6d3f80,0x3f7bbf6d3f55bf35,0x3e48bec43f0ebf35
.quad 0x2677a6542630a60d,0x27c2a6f7a70da6d4,0xbf7b3f6dbf553f35,0xbe483ec4bf0e3f35,0xbec43f35bf6d3f80,0x3ec4bf353f6dbf80,0x3f55bec4be483f35,0xbf0e3f6dbf7b3f35
.quad 0x3f35bf803f352630,0x3f35bf803f3527c2,0xbf0ebec43f7bbf35,0xbf553f6dbe48bf35,0xbf6d3f353ec4bf80,0x3f6dbf35bec43f80,0x3e483f6dbf0ebf35,0xbf7b3ec43f55bf35
.quad 0x3f80269fbf80a654,0x3f80a68dbf80a71f,0x3e48bf6dbf0e3f35,0xbf7bbec43f553f35,0xbf6dbf353ec43f80,0x3f6d3f35bec4bf80,0xbf0e3ec43f7b3f35,0xbf55bf6dbe483f35
.quad 0x3f353f803f352677,0x3f353f803f35a68d,0x3f553ec4be48bf35,0xbf0ebf6dbf7bbf35,0xbec4bf35bf6dbf80,0x3ec43f353f6d3f80,0xbf7bbf6dbf55bf35,0xbe48bec4bf0ebf35
.quad 0x0,0x0,0xbf0ebec4be48250d,0xbf55bf6dbf7bbf80,0x3f6d3f353ec4a58d,0xbf6dbf35bec425d4,0xbf7bbf6dbf0e25d4,0xbe483ec43f553f80
.quad 0x3f353f803f35a60d,0x3f353f803f35a654,0xbe48bf6dbf552630,0x3f7b3ec4bf0ebf80,0xbec43f353f6da654,0x3ec4bf35bf6d269f,0x3f55bec4bf7b2677,0xbf0ebf6d3e483f80
.quad 0xbf80269f3f80a68d,0xbf80a70d3f80a6d4,0x3f553ec4bf7b269f,0xbf0e3f6d3e48bf80,0xbec4bf353f6da6b0,0x3ec43f35bf6d27c2,0xbe483f6dbf5527b1,0x3f7bbec4bf0e3f80
.quad 0x3f35bf803f35a6d4,0x3f35bf803f35a71f,0xbf7b3f6dbf0ea70d,0xbe48bec43f55bf80,0x3f6dbf353ec4a6f7,0xbf6d3f35bec4a68d,0xbf0e3ec4be4827c2,0xbf553f6dbf7b3f80
.quad 0x27d4a71fa6d4a70d,0x27f7278da60ea754,0x3f0ebec43e48a6d4,0x3f55bf6d3f7bbf80,0xbf6d3f35bec4a71f,0x3f6dbf353ec427f7,0x3f7bbf6d3f0e27d4,0x3e483ec4bf553f80
.quad 0xbf353f80bf35a730,0xbf353f80bf35a842,0x3e48bf6d3f55a68d,0xbf7b3ec43f0ebf80,0x3ec43f35bf6da831,0xbec4bf353f6d2884,0xbf55bec43f7b27e5,0x3f0ebf6dbe483f80
.quad 0x3f8027f7bf80a754,0x3f802816bf80a79f,0xbf553ec43f7ba60e,0x3f0e3f6dbe48bf80,0x3ec4bf35bf6d278d,0xbec43f353f6da7d4,0x3e483f6d3f5527f7,0xbf7bbec43f0e3f80
.quad 0xbf35bf80bf35a777,0xbf35bf80bf35270d,0x3f7b3f6d3f0ea1b7,0x3e48bec4bf55bf80,0xbf6dbf35bec4a842,0x3f6d3f353ec42909,0x3f0e3ec43e482804,0x3f553f6d3f7b3f80
.quad 0x0,0x0,0xbf7bbf6dbf55bf35,0xbe48bec4bf0ebf35,0x3ec43f353f6d3f80,0xbec4bf35bf6dbf80,0x3f553ec4be48bf35,0xbf0ebf6dbf7bbf35
.quad 0xbf35bf80bf352630,0xbf35bf80bf352677,0xbf0e3ec43f7b3f35,0xbf55bf6dbe483f35,0x3f6d3f35bec4bf80,0xbf6dbf353ec43f80,0x3e48bf6dbf0e3f35,0xbf7bbec43f553f35
.quad 0xbf8027b13f80a6b0,0xbf8027c23f80a6f7,0x3e483f6dbf0ebf35,0xbf7b3ec43f55bf35,0x3f6dbf35bec43f80,0xbf6d3f353ec4bf80,0xbf0ebec43f7bbf35,0xbf553f6dbe48bf35
.quad 0xbf353f80bf3527c2,0xbf353f80bf35a68d,0x3f55bec4be483f35,0xbf0e3f6dbf7b3f35,0x3ec4bf353f6dbf80,0xbec43f35bf6d3f80,0xbf7b3f6dbf553f35,0xbe483ec4bf0e3f35
.quad 0x27e5a831a68da730,0x2804a842a1b7a777,0x3f7bbf6d3f55bf35,0x3e48bec43f0ebf35,0xbec43f35bf6d3f80,0x3ec4bf353f6dbf80,0xbf553ec43e48bf35,0x3f0ebf6d3f7bbf35
.quad 0x3f35bf803f35a60e,0x3f35bf803f35280d,0x3f0e3ec4bf7b3f35,0x3f55bf6d3e483f35,0xbf6d3f353ec4bf80,0x3f6dbf35bec43f80,0xbe48bf6d3f0e3f35,0x3f7bbec4bf553f35
.quad 0x3f80260dbf80a842,0x3f80270dbf80270d,0xbe483f6d3f0ebf35,0x3f7b3ec4bf55bf35,0xbf6dbf353ec43f80,0x3f6d3f35bec4bf80,0x3f0ebec4bf7bbf35,0x3f553f6d3e48bf35
.quad 0x3f353f803f35280d,0x3f353f803f352896,0xbf55bec43e483f35,0x3f0e3f6d3f7b3f35,0xbec4bf35bf6dbf80,0x3ec43f353f6d3f80,0x3f7b3f6d3f553f35,0x3e483ec43f0e3f35
.quad 0x3f803f803f803f80,0x3f803f803f803f80,0x3f553f6d3f7b3f80,0x3e483ec43f0e3f35,0x3ec43f353f6d3f80,0xbf6dbf35bec4248d,0xbe483ec43f553f80,0xbf0ebf6dbf7bbf35
.quad 0xbf35248d3f353f80,0x3f35a554bf35bf80,0xbf7bbec43f0e3f80,0x3f553f6d3e48bf35,0xbf6dbf353ec43f80,0xbec43f353f6da554,0xbf0ebf6d3e483f80,0xbf7bbec43f553f35
.quad 0xa554bf80248d3f80,0xa5f7bf8025b03f80,0x3f0ebf6dbe483f80,0x3f7bbec4bf553f35,0x3f6dbf35bec43f80,0x3ec43f35bf6d25b0,0x3f7bbec4bf0e3f80,0xbf553f6dbe48bf35
.quad 0x3f35a554bf353f80,0xbf35261f3f35bf80,0x3e483ec4bf553f80,0x3f0ebf6d3f7bbf35,0xbec43f35bf6d3f80,0x3f6dbf353ec4a5f7,0xbf553f6dbf7b3f80,0xbe483ec4bf0e3f35
.quad 0xbf803f80bf803f80,0xbf803f80bf803f80,0xbf553f6dbf7b3f80,0xbe483ec4bf0e3f35,0xbec43f35bf6d3f80,0x3f6dbf353ec4261f,0x3e483ec4bf553f80,0x3f0ebf6d3f7bbf35
.quad 0x3f3525b0bf353f80,0xbf35a7423f35bf80,0x3f7bbec4bf0e3f80,0xbf553f6dbe48bf35,0x3f6dbf35bec43f80,0x3ec43f35bf6da731,0x3f0ebf6dbe483f80,0x3f7bbec4bf553f35
.quad 0x261fbf80a5543f80,0xa60dbf80a7423f80,0xbf0ebf6d3e483f80,0xbf7bbec43f553f35,0xbf6dbf353ec43f80,0xbec43f353f6da68d,0xbf7bbec43f0e3f80,0x3f553f6d3e48bf35
.quad 0xbf35a5f73f353f80,0x3f35a60dbf35bf80,0xbe483ec43f553f80,0xbf0ebf6dbf7bbf35,0x3ec43f353f6d3f80,0xbf6dbf35bec4a742,0x3f553f6d3f7b3f80,0x3e483ec43f0e3f35
.quad 0x3f803f803f803f80,0x3f803f803f803f80,0xbf0ebec4be48248d,0xbf7bbf6dbf55bf35,0xbec4bf35bf6dbf80,0x3f6d3f353ec4a554,0x3f7b3f6d3f0ea554,0xbf55bec43e483f35
.quad 0xbf3525b03f353f80,0x3f35a5f7bf35bf80,0xbe48bf6dbf5525b0,0xbf0e3ec43f7b3f35,0x3f6d3f35bec4bf80,0x3ec4bf35bf6d261f,0xbf553ec43f7ba5f7,0xbe483f6d3f0ebf35
.quad 0xa731bf80261f3f80,0xa742bf80a68d3f80,0x3f553ec4bf7b261f,0x3e483f6dbf0ebf35,0xbf6d3f353ec4bf80,0xbec4bf353f6da742,0x3e48bf6d3f55a731,0x3f0e3ec4bf7b3f35
.quad 0x3f35a742bf353f80,0xbf35a60d3f35bf80,0xbf7b3f6dbf0ea68d,0x3f55bec4be483f35,0x3ec4bf353f6dbf80,0xbf6d3f35bec4a60d,0x3f0ebec43e48a742,0x3f7bbf6d3f55bf35
.quad 0xbf803f80bf803f80,0xbf803f80bf803f80,0x3f0ebec43e48a654,0x3f7bbf6d3f55bf35,0x3ec4bf353f6dbf80,0xbf6d3f35bec4a777,0xbf7b3f6dbf0ea754,0x3f55bec4be483f35
.quad 0x3f35a58ebf353f80,0xbf35a78d3f35bf80,0x3e48bf6d3f55a60d,0x3f0e3ec4bf7b3f35,0xbf6d3f353ec4bf80,0xbec4bf353f6d258d,0x3f553ec4bf7ba765,0x3e483f6dbf0ebf35
.quad 0x2804bf80a7773f80,0x2889bf8027543f80,0xbf553ec43f7ba58e,0xbe483f6d3f0ebf35,0x3f6d3f35bec4bf80,0x3ec4bf35bf6da796,0xbe48bf6dbf55a777,0xbf0e3ec43f7b3f35
.quad 0xbf35a78d3f353f80,0x3f352816bf35bf80,0x3f7b3f6d3f0ea137,0xbf55bec43e483f35,0xbec4bf35bf6dbf80,0x3f6d3f353ec4268d,0xbf0ebec4be48a784,0xbf7bbf6dbf55bf35
.quad 0x3f803f803f803f80,0x3f803f803f803f80,0xbf55bf6dbf7bbf80,0xbe48bec4bf0ebf35,0x3ec43f353f6d3f80,0xbf6dbf35bec425b0,0x3e48bec4bf55bf80,0x3f0e3f6d3f7b3f35
.quad 0xbf35261f3f353f80,0x3f35a731bf35bf80,0x3f7b3ec4bf0ebf80,0xbf55bf6dbe483f35,0xbf6dbf353ec43f80,0xbec43f353f6da742,0x3f0e3f6dbe48bf80,0x3f7b3ec4bf55bf35
.quad 0xa754bf80a6543f80,0xa765bf80a60d3f80,0xbf0e3f6d3e48bf80,0xbf7b3ec43f55bf35,0x3f6dbf35bec43f80,0x3ec43f35bf6da58e,0xbf7b3ec43f0ebf80,0x3f55bf6d3e483f35
.quad 0x3f35a777bf353f80,0xbf3528043f35bf80,0xbe48bec43f55bf80,0xbf0e3f6dbf7b3f35,0xbec43f35bf6d3f80,0x3f6dbf353ec4a78d,0x3f55bf6d3f7bbf80,0x3e48bec43f0ebf35
.quad 0xbf803f80bf803f80,0xbf803f80bf803f80,0x3f55bf6d3f7bbf80,0x3e48bec43f0ebf35,0xbec43f35bf6d3f80,0x3f6dbf353ec4268d,0xbe48bec43f55bf80,0xbf0e3f6dbf7b3f35
.quad 0x3f35268dbf353f80,0xbf35a85d3f35bf80,0xbf7b3ec43f0ebf80,0x3f55bf6d3e483f35,0x3f6dbf35bec43f80,0x3ec43f35bf6d270d,0xbf0e3f6d3e48bf80,0xbf7b3ec43f55bf35
.quad 0x281fbf8028283f80,0x2730bf8026d43f80,0x3f0e3f6dbe48bf80,0x3f7b3ec4bf55bf35,0xbf6dbf353ec43f80,0xbec43f353f6d2828,0x3f7b3ec4bf0ebf80,0xbf55bf6dbe483f35
.quad 0xbf3526d43f353f80,0x3f35289abf35bf80,0x3e48bec4bf55bf80,0x3f0e3f6d3f7b3f35,0x3ec43f353f6d3f80,0xbf6dbf35bec4a7e5,0xbf55bf6dbf7bbf80,0xbe48bec4bf0ebf35
.quad 0x3f803f803f803f80,0x3f803f803f803f80,0x3f0e3ec43e48a554,0x3f7b3f6d3f553f35,0xbec4bf35bf6dbf80,0x3f6d3f353ec4a5f7,0xbf7bbf6dbf0e261f,0x3f553ec4be48bf35
.quad 0xbf35a68d3f353f80,0x3f35a742bf35bf80,0x3e483f6d3f55a742,0x3f0ebec4bf7bbf35,0x3f6d3f35bec4bf80,0x3ec4bf35bf6da60d,0x3f55bec4bf7ba60d,0x3e48bf6dbf0e3f35
.quad 0xa777bf80a58e3f80,0xa784bf80a1373f80,0xbf55bec43f7ba777,0xbe48bf6d3f0e3f35,0xbf6d3f353ec4bf80,0xbec4bf353f6da78d,0xbe483f6dbf55258d,0xbf0ebec43f7bbf35
.quad 0x3f352754bf353f80,0xbf3528893f35bf80,0x3f7bbf6d3f0ea796,0xbf553ec43e48bf35,0x3ec4bf353f6dbf80,0xbf6d3f35bec42816,0xbf0e3ec4be48268d,0xbf7b3f6dbf553f35
.quad 0xbf803f80bf803f80,0xbf803f80bf803f80,0xbf0e3ec4be48a7b1,0xbf7b3f6dbf553f35,0x3ec4bf353f6dbf80,0xbf6d3f35bec426d4,0x3f7bbf6d3f0e281f,0xbf553ec43e48bf35
.quad 0x3f35a7b1bf353f80,0xbf35a7e53f35bf80,0xbe483f6dbf5526d4,0xbf0ebec43f7bbf35,0xbf6d3f353ec4bf80,0xbec4bf353f6d2754,0xbf55bec43f7b2730,0xbe48bf6d3f0e3f35
.quad 0x2839bf80a7e53f80,0x28a3bf80a8803f80,0x3f55bec4bf7ba7e5,0x3e48bf6dbf0e3f35,0x3f6d3f35bec4bf80,0x3ec4bf35bf6da804,0x3e483f6d3f552839,0x3f0ebec4bf7bbf35
.quad 0xbf3528be3f353f80,0x3f3528eabf35bf80,0xbf7bbf6dbf0ea880,0x3f553ec4be48bf35,0xbec4bf35bf6dbf80,0x3f6d3f353ec4a731,0x3f0e3ec43e4828a3,0x3f7b3f6d3f553f35
.quad 0x8000800080008000,0x8000800080008000,0xbf0ebec4be488000,0xbf7bbf6dbf55bf35,0xbf6dbf35bec48000,0xbec4bf35bf6dbf80,0xbf7bbf6dbf0e8000,0x3f553ec4be48bf35
.quad 0xbf35bf80bf358000,0x3f353f803f35a50d,0xbe48bf6dbf558000,0xbf0e3ec43f7b3f35,0x3ec4bf35bf6d8000,0xbf6dbf353ec43f80,0x3f55bec4bf7b8000,0x3e48bf6dbf0e3f35
.quad 0x3f80a50dbf808000,0x3f80a5d4bf80258d,0x3f553ec4bf7b8000,0x3e483f6dbf0ebf35,0x3ec43f35bf6d8000,0xbf6d3f353ec4bf80,0xbe483f6dbf558000,0xbf0ebec43f7bbf35
.quad 0xbf353f80bf358000,0x3f35bf803f35a5d4,0xbf7b3f6dbf0e8000,0x3f55bec4be483f35,0xbf6d3f35bec48000,0xbec43f35bf6d3f80,0xbf0e3ec4be488000,0xbf7b3f6dbf553f35
.quad 0xa5d4258da50d8000,0xa6772654a630260d,0x3f0ebec43e488000,0x3f7bbf6d3f55bf35,0x3f6dbf353ec48000,0x3ec4bf353f6dbf80,0x3f7bbf6d3f0e8000,0xbf553ec43e48bf35
.quad 0x3f35bf803f358000,0xbf353f80bf35a630,0x3e48bf6d3f558000,0x3f0e3ec4bf7b3f35,0xbec4bf353f6d8000,0x3f6dbf35bec43f80,0xbf55bec43f7b8000,0xbe48bf6d3f0e3f35
.quad 0xbf80a5d43f808000,0xbf80a69f3f802654,0xbf553ec43f7b8000,0xbe483f6d3f0ebf35,0xbec43f353f6d8000,0x3f6d3f35bec4bf80,0x3e483f6d3f558000,0x3f0ebec4bf7bbf35
.quad 0x3f353f803f358000,0xbf35bf80bf35a677,0x3f7b3f6d3f0e8000,0xbf55bec43e483f35,0x3f6d3f353ec48000,0x3ec43f353f6d3f80,0x3f0e3ec43e488000,0x3f7b3f6d3f553f35
.quad 0x8000800080008000,0x8000800080008000,0xbf55bf6dbf7bbf80,0xbe48bec4bf0ebf35,0x3f6d3f353ec4a50d,0x3ec43f353f6d3f80,0xbe483ec43f553f80,0xbf0ebf6dbf7bbf35
.quad 0xbf35bf80bf35258d,0x3f353f803f35a5d4,0x3f7b3ec4bf0ebf80,0xbf55bf6dbe483f35,0xbec43f353f6da5d4,0x3f6d3f35bec4bf80,0xbf0ebf6d3e483f80,0xbf7bbec43f553f35
.quad 0x3f80a630bf80260d,0x3f80a677bf802654,0xbf0e3f6d3e48bf80,0xbf7b3ec43f55bf35,0xbec4bf353f6da630,0x3f6dbf35bec43f80,0x3f7bbec4bf0e3f80,0xbf553f6dbe48bf35
.quad 0xbf353f80bf352654,0x3f35bf803f35a69f,0xbe48bec43f55bf80,0xbf0e3f6dbf7b3f35,0x3f6dbf353ec4a677,0x3ec4bf353f6dbf80,0xbf553f6dbf7b3f80,0xbe483ec4bf0e3f35
.quad 0xa7b126b0a69f268d,0xa7c226f7270d26d4,0x3f55bf6d3f7bbf80,0x3e48bec43f0ebf35,0xbf6d3f35bec4a69f,0xbec43f35bf6d3f80,0x3e483ec4bf553f80,0x3f0ebf6d3f7bbf35
.quad 0x3f35bf803f3526b0,0xbf353f80bf35a7c2,0xbf7b3ec43f0ebf80,0x3f55bf6d3e483f35,0x3ec43f35bf6da7b1,0xbf6d3f353ec4bf80,0x3f0ebf6dbe483f80,0x3f7bbec4bf553f35
.quad 0xbf80a7c23f8026d4,0xbf80268d3f80271f,0x3f0e3f6dbe48bf80,0x3f7b3ec4bf55bf35,0x3ec4bf35bf6d270d,0xbf6dbf353ec43f80,0xbf7bbec43f0e3f80,0x3f553f6d3e48bf35
.quad 0x3f353f803f3526f7,0xbf35bf80bf35268d,0x3e48bec4bf55bf80,0x3f0e3f6d3f7b3f35,0xbf6dbf35bec4a7c2,0xbec4bf35bf6dbf80,0x3f553f6d3f7b3f80,0x3e483ec43f0e3f35
.quad 0x8000800080008000,0x8000800080008000,0x3f0e3ec43e48a50d,0x3f7b3f6d3f553f35,0xbf6dbf35bec4258d,0xbec4bf35bf6dbf80,0x3f7b3f6d3f0ea5d4,0xbf55bec43e483f35
.quad 0xbf35bf80bf35260d,0x3f353f803f35a630,0x3e483f6d3f55a630,0x3f0ebec4bf7bbf35,0x3ec4bf35bf6d2654,0xbf6dbf353ec43f80,0xbf553ec43f7ba677,0xbe483f6d3f0ebf35
.quad 0x3f80a69fbf80268d,0x3f80a7b1bf8026b0,0xbf55bec43f7ba69f,0xbe48bf6d3f0e3f35,0x3ec43f35bf6d26b0,0xbf6d3f353ec4bf80,0x3e48bf6d3f55a7b1,0x3f0e3ec4bf7b3f35
.quad 0xbf353f80bf3526d4,0x3f35bf803f35a7c2,0x3f7bbf6d3f0e270d,0xbf553ec43e48bf35,0xbf6d3f35bec426f7,0xbec43f35bf6d3f80,0x3f0ebec43e48a7c2,0x3f7bbf6d3f55bf35
.quad 0xa7d4271f26d4270d,0xa7e52831268d2730,0xbf0e3ec4be4826d4,0xbf7b3f6dbf553f35,0x3f6dbf353ec4271f,0x3ec4bf353f6dbf80,0xbf7b3f6dbf0ea7d4,0x3f55bec4be483f35
.quad 0x3f35bf803f352730,0xbf353f80bf35260e,0xbe483f6dbf55268d,0xbf0ebec43f7bbf35,0xbec4bf353f6d2831,0x3f6dbf35bec43f80,0x3f553ec4bf7ba7e5,0x3e483f6dbf0ebf35
.quad 0xbf80a7f73f802754,0xbf80a8843f802842,0x3f55bec4bf7b260e,0x3e48bf6dbf0e3f35,0xbec43f353f6da78d,0x3f6d3f35bec4bf80,0xbe48bf6dbf55a7f7,0xbf0e3ec43f7b3f35
.quad 0x3f353f803f352777,0xbf35bf80bf35a80d,0xbf7bbf6dbf0e21b7,0x3f553ec4be48bf35,0x3f6d3f353ec42842,0x3ec43f353f6d3f80,0xbf0ebec4be48a804,0xbf7bbf6dbf55bf35
.quad 0x8000800080008000,0x8000800080008000,0x3f553f6d3f7b3f80,0x3e483ec43f0e3f35,0x3f6d3f353ec4a5d4,0x3ec43f353f6d3f80,0x3e48bec4bf55bf80,0x3f0e3f6d3f7b3f35
.quad 0xbf35bf80bf352654,0x3f353f803f35a677,0xbf7bbec43f0e3f80,0x3f553f6d3e48bf35,0xbec43f353f6da69f,0x3f6d3f35bec4bf80,0x3f0e3f6dbe48bf80,0x3f7b3ec4bf55bf35
.quad 0x3f80270dbf8026d4,0x3f80a7c2bf8026f7,0x3f0ebf6dbe483f80,0x3f7bbec4bf553f35,0xbec4bf353f6da7c2,0x3f6dbf35bec43f80,0xbf7b3ec43f0ebf80,0x3f55bf6d3e483f35
.quad 0xbf353f80bf35271f,0x3f35bf803f35268d,0x3e483ec4bf553f80,0x3f0ebf6d3f7bbf35,0x3f6dbf353ec4268d,0x3ec4bf353f6dbf80,0x3f55bf6d3f7bbf80,0x3e48bec43f0ebf35
.quad 0xa7f7a78d260e2754,0xa804284221b72777,0xbf553f6dbf7b3f80,0xbe483ec4bf0e3f35,0xbf6d3f35bec4a7f7,0xbec43f35bf6d3f80,0xbe48bec43f55bf80,0xbf0e3f6dbf7b3f35
.quad 0x3f35bf803f352842,0xbf353f80bf35a80d,0x3f7bbec4bf0e3f80,0xbf553f6dbe48bf35,0x3ec43f35bf6da60d,0xbf6d3f353ec4bf80,0xbf0e3f6d3e48bf80,0xbf7b3ec43f55bf35
.quad 0xbf8027d43f80279f,0xbf80a9093f80a70d,0xbf0ebf6d3e483f80,0xbf7bbec43f553f35,0x3ec4bf35bf6da816,0xbf6dbf353ec43f80,0x3f7b3ec4bf0ebf80,0xbf55bf6dbe483f35
.quad 0x3f353f803f35a70d,0xbf35bf80bf35a896,0xbe483ec43f553f80,0xbf0ebf6dbf7bbf35,0xbf6dbf35bec4a70d,0xbec4bf35bf6dbf80,0xbf55bf6dbf7bbf80,0xbe48bec4bf0ebf35
.quad 0x0,0x0,0x3f0e3ec43e480000,0x3f7b3f6d3f553f35,0x3f6d3f353ec40000,0x3ec43f353f6d3f80,0x3f7b3f6d3f0e0000,0xbf55bec43e483f35
.quad 0x3f353f803f350000,0xbf35bf80bf35250d,0x3e483f6d3f550000,0x3f0ebec4bf7bbf35,0xbec43f353f6d0000,0x3f6d3f35bec4bf80,0xbf553ec43f7b0000,0xbe483f6d3f0ebf35
.quad 0xbf80250d3f800000,0xbf8025d43f80a58d,0xbf55bec43f7b0000,0xbe48bf6d3f0e3f35,0xbec4bf353f6d0000,0x3f6dbf35bec43f80,0x3e48bf6d3f550000,0x3f0e3ec4bf7b3f35
.quad 0x3f35bf803f350000,0xbf353f80bf3525d4,0x3f7bbf6d3f0e0000,0xbf553ec43e48bf35,0x3f6dbf353ec40000,0x3ec4bf353f6dbf80,0x3f0ebec43e480000,0x3f7bbf6d3f55bf35
.quad 0x25d4a58d250d0000,0x2677a6542630a60d,0xbf0e3ec4be480000,0xbf7b3f6dbf553f35,0xbf6d3f35bec40000,0xbec43f35bf6d3f80,0xbf7b3f6dbf0e0000,0x3f55bec4be483f35
.quad 0xbf353f80bf350000,0x3f35bf803f352630,0xbe483f6dbf550000,0xbf0ebec43f7bbf35,0x3ec43f35bf6d0000,0xbf6d3f353ec4bf80,0x3f553ec4bf7b0000,0x3e483f6dbf0ebf35
.quad 0x3f8025d4bf800000,0x3f80269fbf80a654,0x3f55bec4bf7b0000,0x3e48bf6dbf0e3f35,0x3ec4bf35bf6d0000,0xbf6dbf353ec43f80,0xbe48bf6dbf550000,0xbf0e3ec43f7b3f35
.quad 0xbf35bf80bf350000,0x3f353f803f352677,0xbf7bbf6dbf0e0000,0x3f553ec4be48bf35,0xbf6dbf35bec40000,0xbec4bf35bf6dbf80,0xbf0ebec4be480000,0xbf7bbf6dbf55bf35
.quad 0x0,0x0,0x3f553f6d3f7b3f80,0x3e483ec43f0e3f35,0xbf6dbf35bec4250d,0xbec4bf35bf6dbf80,0x3e48bec4bf55bf80,0x3f0e3f6d3f7b3f35
.quad 0x3f353f803f35a58d,0xbf35bf80bf3525d4,0xbf7bbec43f0e3f80,0x3f553f6d3e48bf35,0x3ec4bf35bf6d25d4,0xbf6dbf353ec43f80,0x3f0e3f6dbe48bf80,0x3f7b3ec4bf55bf35
.quad 0xbf8026303f80a60d,0xbf8026773f80a654,0x3f0ebf6dbe483f80,0x3f7bbec4bf553f35,0x3ec43f35bf6d2630,0xbf6d3f353ec4bf80,0xbf7b3ec43f0ebf80,0x3f55bf6d3e483f35
.quad 0x3f35bf803f35a654,0xbf353f80bf35269f,0x3e483ec4bf553f80,0x3f0ebf6d3f7bbf35,0xbf6d3f35bec42677,0xbec43f35bf6d3f80,0x3f55bf6d3f7bbf80,0x3e48bec43f0ebf35
.quad 0x27b1a6b0269fa68d,0x27c2a6f7a70da6d4,0xbf553f6dbf7b3f80,0xbe483ec4bf0e3f35,0x3f6dbf353ec4269f,0x3ec4bf353f6dbf80,0xbe48bec43f55bf80,0xbf0e3f6dbf7b3f35
.quad 0xbf353f80bf35a6b0,0x3f35bf803f3527c2,0x3f7bbec4bf0e3f80,0xbf553f6dbe48bf35,0xbec4bf353f6d27b1,0x3f6dbf35bec43f80,0xbf0e3f6d3e48bf80,0xbf7b3ec43f55bf35
.quad 0x3f8027c2bf80a6d4,0x3f80a68dbf80a71f,0xbf0ebf6d3e483f80,0xbf7bbec43f553f35,0xbec43f353f6da70d,0x3f6d3f35bec4bf80,0x3f7b3ec4bf0ebf80,0xbf55bf6dbe483f35
.quad 0xbf35bf80bf35a6f7,0x3f353f803f35a68d,0xbe483ec43f553f80,0xbf0ebf6dbf7bbf35,0x3f6d3f353ec427c2,0x3ec43f353f6d3f80,0xbf55bf6dbf7bbf80,0xbe48bec4bf0ebf35
.quad 0x0,0x0,0xbf0ebec4be48250d,0xbf7bbf6dbf55bf35,0x3f6d3f353ec4a58d,0x3ec43f353f6d3f80,0xbf7bbf6dbf0e25d4,0x3f553ec4be48bf35
.quad 0x3f353f803f35a60d,0xbf35bf80bf352630,0xbe48bf6dbf552630,0xbf0e3ec43f7b3f35,0xbec43f353f6da654,0x3f6d3f35bec4bf80,0x3f55bec4bf7b2677,0x3e48bf6dbf0e3f35
.quad 0xbf80269f3f80a68d,0xbf8027b13f80a6b0,0x3f553ec4bf7b269f,0x3e483f6dbf0ebf35,0xbec4bf353f6da6b0,0x3f6dbf35bec43f80,0xbe483f6dbf5527b1,0xbf0ebec43f7bbf35
.quad 0x3f35bf803f35a6d4,0xbf353f80bf3527c2,0xbf7b3f6dbf0ea70d,0x3f55bec4be483f35,0x3f6dbf353ec4a6f7,0x3ec4bf353f6dbf80,0xbf0e3ec4be4827c2,0xbf7b3f6dbf553f35
.quad 0x27d4a71fa6d4a70d,0x27e5a831a68da730,0x3f0ebec43e48a6d4,0x3f7bbf6d3f55bf35,0xbf6d3f35bec4a71f,0xbec43f35bf6d3f80,0x3f7bbf6d3f0e27d4,0xbf553ec43e48bf35
.quad 0xbf353f80bf35a730,0x3f35bf803f35a60e,0x3e48bf6d3f55a68d,0x3f0e3ec4bf7b3f35,0x3ec43f35bf6da831,0xbf6d3f353ec4bf80,0xbf55bec43f7b27e5,0xbe48bf6d3f0e3f35
.quad 0x3f8027f7bf80a754,0x3f802884bf80a842,0xbf553ec43f7ba60e,0xbe483f6d3f0ebf35,0x3ec4bf35bf6d278d,0xbf6dbf353ec43f80,0x3e483f6d3f5527f7,0x3f0ebec4bf7bbf35
.quad 0xbf35bf80bf35a777,0x3f353f803f35280d,0x3f7b3f6d3f0ea1b7,0xbf55bec43e483f35,0xbf6dbf35bec4a842,0xbec4bf35bf6dbf80,0x3f0e3ec43e482804,0x3f7b3f6d3f553f35
.quad 0x0,0x0,0xbf55bf6dbf7bbf80,0xbe48bec4bf0ebf35,0xbf6dbf35bec425d4,0xbec4bf35bf6dbf80,0xbe483ec43f553f80,0xbf0ebf6dbf7bbf35
.quad 0x3f353f803f35a654,0xbf35bf80bf352677,0x3f7b3ec4bf0ebf80,0xbf55bf6dbe483f35,0x3ec4bf35bf6d269f,0xbf6dbf353ec43f80,0xbf0ebf6d3e483f80,0xbf7bbec43f553f35
.quad 0xbf80a70d3f80a6d4,0xbf8027c23f80a6f7,0xbf0e3f6d3e48bf80,0xbf7b3ec43f55bf35,0x3ec43f35bf6d27c2,0xbf6d3f353ec4bf80,0x3f7bbec4bf0e3f80,0xbf553f6dbe48bf35
.quad 0x3f35bf803f35a71f,0xbf353f80bf35a68d,0xbe48bec43f55bf80,0xbf0e3f6dbf7b3f35,0xbf6d3f35bec4a68d,0xbec43f35bf6d3f80,0xbf553f6dbf7b3f80,0xbe483ec4bf0e3f35
.quad 0x27f7278da60ea754,0x2804a842a1b7a777,0x3f55bf6d3f7bbf80,0x3e48bec43f0ebf35,0x3f6dbf353ec427f7,0x3ec4bf353f6dbf80,0x3e483ec4bf553f80,0x3f0ebf6d3f7bbf35
.quad 0xbf353f80bf35a842,0x3f35bf803f35280d,0xbf7b3ec43f0ebf80,0x3f55bf6d3e483f35,0xbec4bf353f6d260d,0x3f6dbf35bec43f80,0x3f0ebf6dbe483f80,0x3f7bbec4bf553f35
.quad 0x3f80a7d4bf80a79f,0x3f802909bf80270d,0x3f0e3f6dbe48bf80,0x3f7b3ec4bf55bf35,0xbec43f353f6d2816,0x3f6d3f35bec4bf80,0xbf7bbec43f0e3f80,0x3f553f6d3e48bf35
.quad 0xbf35bf80bf35270d,0x3f353f803f352896,0x3e48bec4bf55bf80,0x3f0e3f6d3f7b3f35,0x3f6d3f353ec4270d,0x3ec43f353f6d3f80,0x3f553f6d3f7b3f80,0x3e483ec43f0e3f35
.quad 0x3f8000003f800000,0x3f8000003f800000,0x3f7ffec43f800000,0x3f7ff4e63f7ffb11,0x3f7ffb113f800000,0x3f7fd3973f7fec43,0x3f7ff4e63f800000,0x3f7f9c183f7fd397
.quad 0x3f7fec433f800000,0x3f7f4e6d3f7fb10f,0x3f7fe1293f800000,0x3f7eea9d3f7f84ab,0x3f7fd3973f800000,0x3f7e70b03f7f4e6d,0x3f7fc38f3f800000,0x3f7de0b13f7f0e58
.quad 0x3f7fb10f3f800000,0x3f7d3aac3f7ec46d,0x3f7f9c183f800000,0x3f7c7eb03f7e70b0,0x3f7f84ab3f800000,0x3f7baccd3f7e1324,0x3f7f6ac73f800000,0x3f7ac5163f7dabcc
.quad 0x3f7f4e6d3f800000,0x3f79c79d3f7d3aac,0x3f7f2f9d3f800000,0x3f78b47b3f7cbfc9,0x3f7f0e583f800000,0x3f778bc53f7c3b28,0x3f7eea9d3f800000,0x3f764d973f7baccd
.quad 0x3f7ec46d3f800000,0x3f74fa0b3f7b14be,0x3f7e9bc93f800000,0x3f73913f3f7a7302,0x3f7e70b03f800000,0x3f7213523f79c79d,0x3f7e43233f800000,0x3f7080663f791298
.quad 0x3f7e13243f800000,0x3f6ed89e3f7853f8,0x3f7de0b13f800000,0x3f6d1c1d3f778bc5,0x3f7dabcc3f800000,0x3f6b4b0c3f76ba07,0x3f7d74743f800000,0x3f6965913f75dec6
.quad 0x3f7d3aac3f800000,0x3f676bd83f74fa0b,0x3f7cfe733f800000,0x3f655e0b3f740bdd,0x3f7cbfc93f800000,0x3f633c5a3f731447,0x3f7c7eb03f800000,0x3f6106f23f721352
.quad 0x3f7c3b283f800000,0x3f5ebe053f710908,0x3f7bf5313f800000,0x3f5c61c73f6ff573,0x3f7baccd3f800000,0x3f59f26a3f6ed89e,0x3f7b61fc3f800000,0x3f5770263f6db293
.quad 0x3f8000003f800000,0x3f8000003f800000,0x3f7fe1293f7fec43,0x3f7fc38f3f7fd397,0x3f7f84ab3f7fb10f,0x3f7f0e583f7f4e6d,0x3f7eea9d3f7f4e6d,0x3f7de0b13f7e70b0
.quad 0x3f7e13243f7ec46d,0x3f7c3b283f7d3aac,0x3f7cfe733f7e1324,0x3f7a1e843f7baccd,0x3f7baccd3f7d3aac,0x3f778bc53f79c79d,0x3f7a1e843f7c3b28,0x3f7484223f778bc5
.quad 0x3f7853f83f7b14be,0x3f7109083f74fa0b,0x3f764d973f79c79d,0x3f6d1c1d3f721352,0x3f740bdd3f7853f8,0x3f68bf3c3f6ed89e,0x3f718f573f76ba07,0x3f63f4733f6b4b0c
.quad 0x3f6ed89e3f74fa0b,0x3f5ebe053f676bd8,0x3f6be8583f731447,0x3f591e6a3f633c5a,0x3f68bf3c3f710908,0x3f5318493f5ebe05,0x3f655e0b3f6ed89e,0x3f4cae793f59f26a
.quad 0x3f61c5983f6c835e,0x3f45e4033f54db31,0x3f5df6be3f6a09a7,0x3f3ebc1b3f4f7a1f,0x3f59f26a3f676bd8,0x3f373a233f49d112,0x3f55b9933f64aa59,0x3f2f61a53f43e200
.quad 0x3f514d3d3f61c598,0x3f2736563f3daef9,0x3f4cae793f5ebe05,0x3f1ebc123f373a23,0x3f47de653f5b941a,0x3f15f6d93f3085bb,0x3f42de293f584853,0x3f0cead03f299415
.quad 0x3f3daef93f54db31,0x3f039c3d3f226799,0x3f3852163f514d3d,0x3ef41f073f1b02c6,0x3f32c8c93f4d9f02,0x3ee0924f3f13682a,0x3f2d14693f49d112,0x3ecc9b8b3f0b9a6b
.quad 0x3f2736563f45e403,0x3eb8442a3f039c3d,0x3f212ff93f41d870,0x3ea395c53ef6e0cb,0x3f1b02c63f3daef9,0x3e8e9a223ee63375,0x3f14b0393f396842,0x3e72b6513ed53641
.quad 0x3f8000003f800000,0x3f8000003f800000,0x3f7f9c183f7fb10f,0x3f7f6ac73f7f84ab,0x3f7e70b03f7ec46d,0x3f7dabcc3f7e1324,0x3f7c7eb03f7d3aac,0x3f7ac5163f7baccd
.quad 0x3f79c79d3f7b14be,0x3f76ba073f7853f8,0x3f764d973f7853f8,0x3f718f573f740bdd,0x3f7213523f74fa0b,0x3f6b4b0c3f6ed89e,0x3f6d1c1d3f710908,0x3f63f4733f68bf3c
.quad 0x3f676bd83f6c835e,0x3f5b941a3f61c598,0x3f6106f23f676bd8,0x3f5233c63f59f26a,0x3f59f26a3f61c598,0x3f47de653f514d3d,0x3f5233c63f5b941a,0x3f3ca0033f47de65
.quad 0x3f49d1123f54db31,0x3f3085bb3f3daef9,0x3f40d0da3f4d9f02,0x3f239da93f32c8c9,0x3f373a233f45e403,0x3f15f6d93f273656,0x3f2d14693f3daef9,0x3f07a1363f1b02c6
.quad 0x3f2267993f3504f3,0x3ef15aea3f0e39da,0x3f173c073f2beb4a,0x3ed25a093f00e7e4,0x3f0b9a6b3f226799,0x3eb263ef3ee63375,0x3eff17b23f187fc0,0x3e919ddd3ec9b953
.quad 0x3ee633753f0e39da,0x3e605c133eac7cd4,0x3ecc9b8b3f039c3d,0x3e1c76de3e8e9a22,0x3eb263ef3ef15aea,0x3dafb6803e605c13,0x3e97a1173edae880,0x3c96c9b63e22abb6
.quad 0x3e78cfcc3ec3ef15,0xbd48fb303dc8bd36,0x3e419b373eac7cd4,0xbdee38763d16c32c,0x3e09cf863e94a031,0xbe3b6ecfbcc90ab0,0x3da3308c3e78cfcc,0xbe7ee6e1bdafb680
.quad 0x3cc90ab03e47c5c2,0xbea09ae5be164083,0xbcfb49ba3e164083,0xbec1071ebe541501,0xbdafb6803dc8bd36,0xbee0924fbe888e93,0xbe1008b73d48fb30,0xbeff17b2bea68f12
.quad 0x3f8000003f800000,0x3f8000003f800000,0x3f7f2f9d3f7f4e6d,0x3f7eea9d3f7f0e58,0x3f7cbfc93f7d3aac,0x3f7baccd3f7c3b28,0x3f78b47b3f79c79d,0x3f764d973f778bc5
.quad 0x3f7314473f74fa0b,0x3f6ed89e3f710908,0x3f6be8583f6ed89e,0x3f655e0b3f68bf3c,0x3f633c5a3f676bd8,0x3f59f26a3f5ebe05,0x3f591e6a3f5ebe05,0x3f4cae793f531849
.quad 0x3f4d9f023f54db31,0x3f3daef93f45e403,0x3f40d0da3f49d112,0x3f2d14693f373a23,0x3f32c8c93f3daef9,0x3f1b02c63f273656,0x3f239da93f3085bb,0x3f07a1363f15f6d9
.quad 0x3f13682a3f226799,0x3ee633753f039c3d,0x3f0242b13f13682a,0x3ebb31a03ee0924f,0x3ee0924f3f039c3d,0x3e8e9a223eb8442a,0x3ebb31a03ee63375,0x3e419b373e8e9a22
.quad 0x3e94a0313ec3ef15,0x3dc8bd363e47c5c2,0x3e5a39973ea09ae5,0x3bc90f883de1bc2e,0x3e09cf863e78cfcc,0xbdafb6803cc90ab0,0x3d6214693e2f10a2,0xbe354098bd7b2b74
.quad 0xbcc90ab03dc8bd36,0xbe888e93be164083,0xbdd53db93cc90ab0,0xbeb554ecbe6c9a7f,0xbe3b6ecfbd48fb30,0xbee0924fbea09ae5,0xbe8586cebdfab273,0xbf04f484bec9b953
.quad 0xbeac7cd4be47c5c2,0xbf187fc0bef15aea,0xbed25a09be888e93,0xbf2ac082bf0b9a6b,0xbef6e0cbbeac7cd4,0xbf3b8f3bbf1d7fd1,0xbf0cead0becf7bca,0xbf4ac77fbf2e3bde
.quad 0xbf1d7fd1bef15aea,0xbf584853bf3daef9,0xbf2d1469bf08f59b,0xbf63f473bf4bbbf8,0xbf3b8f3bbf187fc0,0xbf6db293bf584853,0xbf48d8b3bf273656,0xbf756d97bf633c5a
.quad 0x3f8000003f800000,0x3f8000003f800000,0x3f7e9bc93f7ec46d,0x3f7e43233f7e70b0,0x3f7a73023f7b14be,0x3f7912983f79c79d,0x3f73913f3f74fa0b,0x3f7080663f721352
.quad 0x3f6a09a73f6c835e,0x3f64aa593f676bd8,0x3f5df6be3f61c598,0x3f55b9933f59f26a,0x3f4f7a1f3f54db31,0x3f43e2003f49d112,0x3f3ebc1b3f45e403,0x3f2f61a53f373a23
.quad 0x3f2beb4a3f3504f3,0x3f187fc03f226799,0x3f173c073f226799,0x3eff17b23f0b9a6b,0x3f00e7e43f0e39da,0x3ec9b9533ee63375,0x3ed25a093ef15aea,0x3e919ddd3eb263ef
.quad 0x3ea09ae53ec3ef15,0x3e2f10a23e78cfcc,0x3e5a39973e94a031,0x3d6214693e09cf86,0x3de1bc2e3e47c5c2,0xbd7b2b743cc90ab0,0x3bc90f883dc8bd36,0xbe354098bdafb680
.quad 0xbdc8bd36248d3132,0xbe94a031be47c5c2,0xbe4dee60bdc8bd36,0xbecc9b8bbe9aa086,0xbe9aa086be47c5c2,0xbf00e7e4becf7bca,0xbecc9b8bbe94a031,0xbf19c200bf00e7e4
.quad 0xbefc5d27bec3ef15,0xbf3085bbbf187fc0,0xbf14b039bef15aea,0xbf44e3f5bf2e3bde,0xbf299415bf0e39da,0xbf5695e5bf41d870,0xbf3ca003bf226799,0xbf655e0bbf531849
.quad 0xbf4d9f02bf3504f3,0xbf710908bf61c598,0xbf5c61c7bf45e403,0xbf796e4ebf6db293,0xbf68bf3cbf54db31,0xbf7e70b0bf76ba07,0xbf7294f8bf61c598,0xbf7ffec4bf7cbfc9
.quad 0xbf79c79dbf6c835e,0xbf7e1324bf7fb10f,0xbf7e4323bf74fa0b,0xbf78b47bbf7f84ab,0xbf7ffb11bf7b14be,0xbf6ff573bf7c3b28,0xbf7eea9dbf7ec46d,0xbf63f473bf75dec6
.quad 0x3f8000003f800000,0x3f8000003f800000,0x3f7de0b13f7e1324,0x3f7d74743f7dabcc,0x3f778bc53f7853f8,0x3f75dec63f76ba07,0x3f6d1c1d3f6ed89e,0x3f6965913f6b4b0c
.quad 0x3f5ebe053f61c598,0x3f5848533f5b941a,0x3f4cae793f514d3d,0x3f42de293f47de65,0x3f373a233f3daef9,0x3f2994153f3085bb,0x3f1ebc123f273656,0x3f0cead03f15f6d9
.quad 0x3f039c3d3f0e39da,0x3edae8803ef15aea,0x3ecc9b8b3ee63375,0x3e97a1173eb263ef,0x3e8e9a223eac7cd4,0x3e22abb63e605c13,0x3e1c76de3e605c13,0x3c96c9b63dafb680
.quad 0x3cc90ab03dc8bd36,0xbdfab273bd48fb30,0xbdd53db9bcc90ab0,0xbe8586cebe3b6ecf,0xbe6c9a7fbe164083,0xbec9b953bea09ae5,0xbeb554ecbe888e93,0xbf04f484bee0924f
.quad 0xbef15aeabec3ef15,0xbf226799bf0e39da,0xbf14b039befc5d27,0xbf3ca003bf299415,0xbf2e3bdebf187fc0,0xbf531849bf41d870,0xbf44e3f5bf3085bb,0xbf655e0bbf5695e5
.quad 0xbf584853bf45e403,0xbf731447bf676bd8,0xbf6816a8bf584853,0xbf7bf531bf740bdd,0xbf740bddbf676bd8,0xbf7fd397bf7c3b28,0xbf7bf531bf731447,0xbf7e9bc9bf7fd397
.quad 0xbf7fb10fbf7b14be,0xbf7853f8bf7ec46d,0xbf7f2f9dbf7f4e6d,0xbf6d1c1dbf791298,0xbf7a7302bf7fb10f,0xbf5d2d53bf6ed89e,0xbf718f57bf7c3b28,0xbf48d8b3bf604621
.quad 0xbf64aa59bf74fa0b,0xbf3085bbbf4d9f02,0xbf53fac3bf6a09a7,0xbf14b039bf373a23,0xbf3fc767bf5b941a,0xbeebcbbbbf1d7fd1,0xbf286605bf49d112,0xbea986c4bf00e7e4
.quad 0x3f8000003f800000,0x3f8000003f800000,0x3f7cfe733f7d3aac,0x3f7c7eb03f7cbfc9,0x3f740bdd3f74fa0b,0x3f7213523f731447,0x3f655e0b3f676bd8,0x3f6106f23f633c5a
.quad 0x3f514d3d3f54db31,0x3f49d1123f4d9f02,0x3f3852163f3daef9,0x3f2d14693f32c8c9,0x3f1b02c63f226799,0x3f0b9a6b3f13682a,0x3ef41f073f039c3d,0x3ecc9b8b3ee0924f
.quad 0x3eac7cd43ec3ef15,0x3e78cfcc3e94a031,0x3e419b373e78cfcc,0x3da3308c3e09cf86,0x3d16c32c3dc8bd36,0xbdafb680bcc90ab0,0xbdee3876bd48fb30,0xbe7ee6e1be3b6ecf
.quad 0xbe888e93be47c5c2,0xbecf7bcabeac7cd4,0xbed25a09beac7cd4,0xbf0cead0bef6e0cb,0xbf0b9a6bbef15aea,0xbf2e3bdebf1d7fd1,0xbf2ac082bf187fc0,0xbf4ac77fbf3b8f3b
.quad 0xbf45e403bf3504f3,0xbf61c598bf54db31,0xbf5c61c7bf4d9f02,0xbf7294f8bf68bf3c,0xbf6db293bf61c598,0xbf7cbfc9bf76ba07,0xbf796e4ebf710908,0xbf7ffec4bf7e70b0
.quad 0xbf7f4e6dbf7b14be,0xbf7c3b28bf7fb10f,0xbf7f2f9dbf7fb10f,0xbf718f57bf7a7302,0xbf791298bf7ec46d,0xbf604621bf6ed89e,0xbf6d1c1dbf7853f8,0xbf48d8b3bf5d2d53
.quad 0xbf5b941abf6c835e,0xbf2beb4abf45e403,0xbf44e3f5bf5b941a,0xbf0a48adbf299415,0xbf299415bf45e403,0xbec9b953bf08f59b,0xbf0a48adbf2beb4a,0xbe72b651bec9b953
.quad 0xbecf7bcabf0e39da,0xbd96a905be78cfcc,0xbe8586cebedae880,0x3dbc3ac3bdafb680,0xbde1bc2ebe94a031,0x3e827dc03d96a905,0x3d2fe007be164083,0x3ed25a093e6c9a7f
.quad 0x3f8000003f800000,0x3f8000003f800000,0x3f7bf5313f7c3b28,0x3f7b61fc3f7baccd,0x3f6ff5733f710908,0x3f6db2933f6ed89e,0x3f5c61c73f5ebe05,0x3f5770263f59f26a
.quad 0x3f41d8703f45e403,0x3f3968423f3daef9,0x3f212ff93f273656,0x3f14b0393f1b02c6,0x3ef6e0cb3f039c3d,0x3ed536413ee63375,0x3ea395c53eb8442a,0x3e72b6513e8e9a22
.quad 0x3e1640833e47c5c2,0x3d48fb303dc8bd36,0xbcfb49ba3cc90ab0,0xbe1008b7bdafb680,0xbe541501be164083,0xbea68f12be888e93,0xbec1071ebea09ae5,0xbeff17b2bee0924f
.quad 0xbf08f59bbef15aea,0xbf273656bf187fc0,0xbf2d1469bf1d7fd1,0xbf48d8b3bf3b8f3b,0xbf4bbbf8bf3daef9,0xbf633c5abf584853,0xbf63f473bf584853,0xbf756d97bf6db293
.quad 0xbf74fa0bbf6c835e,0xbf7ec46dbf7b14be,0xbf7e4323bf79c79d,0xbf7eea9dbf7ffb11,0xbf7f84abbf7fb10f,0xbf75dec6bf7c3b28,0xbf78b47bbf7e1324,0xbf63f473bf6ff573
.quad 0xbf6a09a7bf74fa0b,0xbf49d112bf5b941a,0xbf53fac3bf64aa59,0xbf286605bf3fc767,0xbf373a23bf4d9f02,0xbf00e7e4bf1d7fd1,0xbf14b039bf3085bb,0xbea986c4beebcbbb
.quad 0xbedae880bf0e39da,0xbe164083be94a031,0xbe8586cebecf7bca,0x3d2fe007bde1bc2e,0xbdafb680be78cfcc,0x3e6c9a7f3d96a905,0x3dbc3ac3bd96a905,0x3ed25a093e827dc0
.quad 0x3e888e933dc8bd36,0x3f13682a3edae880,0x3eddbe793e888e93,0x3f3852163f15f6d9,0x3f15f6d93edae880,0x3f5695e53f396842,0x3f3852163f13682a,0x3f6d1c1d3f5695e5
.quad 0x8000000080000000,0x8000000080000000,0xbbc90f8880000000,0xbc96c9b6bc490e90,0xbc490e9080000000,0xbd16c32cbcc90ab0,0xbc96c9b680000000,0xbd621469bd16c32c
.quad 0xbcc90ab080000000,0xbd96a905bd48fb30,0xbcfb49ba80000000,0xbdbc3ac3bd7b2b74,0xbd16c32c80000000,0xbde1bc2ebd96a905,0xbd2fe00780000000,0xbe039502bdafb680
.quad 0xbd48fb3080000000,0xbe164083bdc8bd36,0xbd62146980000000,0xbe28defcbde1bc2e,0xbd7b2b7480000000,0xbe3b6ecfbdfab273,0xbd8a200a80000000,0xbe4dee60be09cf86
.quad 0xbd96a90580000000,0xbe605c13be164083,0xbda3308c80000000,0xbe72b651be22abb6,0xbdafb68080000000,0xbe827dc0be2f10a2,0xbdbc3ac380000000,0xbe8b9507be3b6ecf
.quad 0xbdc8bd3680000000,0xbe94a031be47c5c2,0xbdd53db980000000,0xbe9d9e78be541501,0xbde1bc2e80000000,0xbea68f12be605c13,0xbdee387680000000,0xbeaf713abe6c9a7f
.quad 0xbdfab27380000000,0xbeb8442abe78cfcc,0xbe03950280000000,0xbec1071ebe827dc0,0xbe09cf8680000000,0xbec9b953be888e93,0xbe1008b780000000,0xbed25a09be8e9a22
.quad 0xbe16408380000000,0xbedae880be94a031,0xbe1c76de80000000,0xbee363fabe9aa086,0xbe22abb680000000,0xbeebcbbbbea09ae5,0xbe28defc80000000,0xbef41f07bea68f12
.quad 0xbe2f10a280000000,0xbefc5d27beac7cd4,0xbe35409880000000,0xbf0242b1beb263ef,0xbe3b6ecf80000000,0xbf064b82beb8442a,0xbe419b3780000000,0xbf0a48adbebe1d4a
.quad 0x8000000080000000,0x8000000080000000,0xbcfb49babcc90ab0,0xbd2fe007bd16c32c,0xbd7b2b74bd48fb30,0xbdafb680bd96a905,0xbdbc3ac3bd96a905,0xbe039502bde1bc2e
.quad 0xbdfab273bdc8bd36,0xbe2f10a2be164083,0xbe1c76debdfab273,0xbe5a3997be3b6ecf,0xbe3b6ecfbe164083,0xbe827dc0be605c13,0xbe5a3997be2f10a2,0xbe97a117be827dc0
.quad 0xbe78cfccbe47c5c2,0xbeac7cd4be94a031,0xbe8b9507be605c13,0xbec1071ebea68f12,0xbe9aa086be78cfcc,0xbed53641beb8442a,0xbea986c4be888e93,0xbee900b7bec9b953
.quad 0xbeb8442abe94a031,0xbefc5d27bedae880,0xbec6d529bea09ae5,0xbf07a136beebcbbb,0xbed53641beac7cd4,0xbf10d3cdbefc5d27,0xbee363fabeb8442a,0xbf19c200bf064b82
.quad 0xbef15aeabec3ef15,0xbf226799bf0e39da,0xbeff17b2becf7bca,0xbf2ac082bf15f6d9,0xbf064b82bedae880,0xbf32c8c9bf1d7fd1,0xbf0cead0bee63375,0xbf3a7ca4bf24d225
.quad 0xbf13682abef15aea,0xbf41d870bf2beb4a,0xbf19c200befc5d27,0xbf48d8b3bf32c8c9,0xbf1ff6cbbf039c3d,0xbf4f7a1fbf396842,0xbf26050abf08f59b,0xbf55b993bf3fc767
.quad 0xbf2beb4abf0e39da,0xbf5b941abf45e403,0xbf31a81dbf13682a,0xbf6106f2bf4bbbf8,0xbf373a23bf187fc0,0xbf660f88bf514d3d,0xbf3ca003bf1d7fd1,0xbf6aab7bbf5695e5
.quad 0xbf41d870bf226799,0xbf6ed89ebf5b941a,0xbf46e22abf273656,0xbf7294f8bf604621,0xbf4bbbf8bf2beb4a,0xbf75dec6bf64aa59,0xbf5064afbf3085bb,0xbf78b47bbf68bf3c
.quad 0x8000000080000000,0x8000000080000000,0xbd621469bd48fb30,0xbd8a200abd7b2b74,0xbde1bc2ebdc8bd36,0xbe09cf86bdfab273,0xbe28defcbe164083,0xbe4dee60be3b6ecf
.quad 0xbe605c13be47c5c2,0xbe888e93be78cfcc,0xbe8b9507be78cfcc,0xbea986c4be9aa086,0xbea68f12be94a031,0xbec9b953beb8442a,0xbec1071ebeac7cd4,0xbee900b7bed53641
.quad 0xbedae880bec3ef15,0xbf039c3dbef15aea,0xbef41f07bedae880,0xbf121eb0bf064b82,0xbf064b82bef15aea,0xbf1ff6cbbf13682a,0xbf121eb0bf039c3d,0xbf2d1469bf1ff6cb
.quad 0xbf1d7fd1bf0e39da,0xbf396842bf2beb4a,0xbf286605bf187fc0,0xbf44e3f5bf373a23,0xbf32c8c9bf226799,0xbf4f7a1fbf41d870,0xbf3ca003bf2beb4a,0xbf591e6abf4bbbf8
.quad 0xbf45e403bf3504f3,0xbf61c598bf54db31,0xbf4e8d90bf3daef9,0xbf696591bf5d2d53,0xbf5695e5bf45e403,0xbf6ff573bf64aa59,0xbf5df6bebf4d9f02,0xbf756d97bf6b4b0c
.quad 0xbf64aa59bf54db31,0xbf79c79dbf710908,0xbf6aab7bbf5b941a,0xbf7cfe73bf75dec6,0xbf6ff573bf61c598,0xbf7f0e58bf79c79d,0xbf748422bf676bd8,0xbf7ff4e6bf7cbfc9
.quad 0xbf7853f8bf6c835e,0xbf7fb10fbf7ec46d,0xbf7b61fcbf710908,0xbf7e4323bf7fd397,0xbf7dabccbf74fa0b,0xbf7baccdbf7fec43,0xbf7f2f9dbf7853f8,0xbf77f110bf7f0e58
.quad 0xbf7fec43bf7b14be,0xbf731447bf7d3aac,0xbf7fe129bf7d3aac,0xbf6d1c1dbf7a7302,0xbf7f0e58bf7ec46d,0xbf660f88bf76ba07,0xbf7d7474bf7fb10f,0xbf5df6bebf721352
.quad 0x8000000080000000,0x8000000080000000,0xbda3308cbd96a905,0xbdbc3ac3bdafb680,0xbe22abb6be164083,0xbe3b6ecfbe2f10a2,0xbe72b651be605c13,0xbe8b9507be827dc0
.quad 0xbea09ae5be94a031,0xbeb8442abeac7cd4,0xbec6d529beb8442a,0xbee363fabed53641,0xbeebcbbbbedae880,0xbf064b82befc5d27,0xbf07a136befc5d27,0xbf19c200bf10d3cd
.quad 0xbf187fc0bf0e39da,0xbf2beb4abf226799,0xbf286605bf1d7fd1,0xbf3ca003bf32c8c9,0xbf373a23bf2beb4a,0xbf4bbbf8bf41d870,0xbf44e3f5bf396842,0xbf591e6abf4f7a1f
.quad 0xbf514d3dbf45e403,0xbf64aa59bf5b941a,0xbf5c61c7bf514d3d,0xbf6e46bebf660f88,0xbf660f88bf5b941a,0xbf75dec6bf6ed89e,0xbf6e46bebf64aa59,0xbf7b61fcbf75dec6
.quad 0xbf74fa0bbf6c835e,0xbf7ec46dbf7b14be,0xbf7a1e84bf731447,0xbf7ffec4bf7e70b0,0xbf7dabccbf7853f8,0xbf7f0e58bf7fec43,0xbf7f9c18bf7c3b28,0xbf7bf531bf7f84ab
.quad 0xbf7fec43bf7ec46d,0xbf76ba07bf7d3aac,0xbf7e9bc9bf7fec43,0xbf6f6830bf791298,0xbf7baccdbf7fb10f,0xbf660f88bf731447,0xbf772417bf7e1324,0xbf5ac450bf6b4b0c
.quad 0xbf710908bf7b14be,0xbf4d9f02bf61c598,0xbf696591bf76ba07,0xbf3ebc1bbf5695e5,0xbf604621bf710908,0xbf2e3bdebf49d112,0xbf55b993bf6a09a7,0xbf1c420cbf3b8f3b
.quad 0xbf49d112bf61c598,0xbf08f59bbf2beb4a,0xbf3ca003bf584853,0xbee900b7bf1b02c6,0xbf2e3bdebf4d9f02,0xbebe1d4abf08f59b,0xbf1ebc12bf41d870,0xbe919dddbeebcbbb
.quad 0x8000000080000000,0x8000000080000000,0xbdd53db9bdc8bd36,0xbdee3876bde1bc2e,0xbe541501be47c5c2,0xbe6c9a7fbe605c13,0xbe9d9e78be94a031,0xbeaf713abea68f12
.quad 0xbecf7bcabec3ef15,0xbee63375bedae880,0xbeff17b2bef15aea,0xbf0cead0bf064b82,0xbf15f6d9bf0e39da,0xbf24d225bf1d7fd1,0xbf2ac082bf226799,0xbf3a7ca4bf32c8c9
.quad 0xbf3daef9bf3504f3,0xbf4d9f02bf45e403,0xbf4e8d90bf45e403,0xbf5df6bebf5695e5,0xbf5d2d53bf54db31,0xbf6b4b0cbf64aa59,0xbf696591bf61c598,0xbf756d97bf6ff573
.quad 0xbf731447bf6c835e,0xbf7c3b28bf7853f8,0xbf7a1e84bf74fa0b,0xbf7f9c18bf7dabcc,0xbf7e70b0bf7b14be,0xbf7f84abbf7fec43,0xbf7ffec4bf7ec46d,0xbf7bf531bf7f0e58
.quad 0xbf7ec46dbf800000,0xbf74fa0bbf7b14be,0xbf7ac516bf7ec46d,0xbf6aab7bbf740bdd,0xbf740bddbf7b14be,0xbf5d2d53bf6a09a7,0xbf6aab7bbf74fa0b,0xbf4cae79bf5d2d53
.quad 0xbf5ebe05bf6c835e,0xbf396842bf4d9f02,0xbf5064afbf61c598,0xbf239da9bf3b8f3b,0xbf3fc767bf54db31,0xbf0b9a6bbf273656,0xbf2d1469bf45e403,0xbee363fabf10d3cd
.quad 0xbf187fc0bf3504f3,0xbeac7cd4bef15aea,0xbf0242b1bf226799,0xbe667c66bebe1d4a,0xbed53641bf0e39da,0xbde1bc2ebe888e93,0xbea395c5bef15aea,0x3bc90f88be22abb6
.quad 0xbe605c13bec3ef15,0x3dfab273bd48fb30,0xbdee3876be94a031,0x3e72b6513d7b2b74,0xbc490e90be47c5c2,0x3eb263ef3e2f10a2,0x3dbc3ac3bdc8bd36,0x3ee900b73e8e9a22
.quad 0x8000000080000000,0x8000000080000000,0xbe039502bdfab273,0xbe1008b7be09cf86,0xbe827dc0be78cfcc,0xbe8e9a22be888e93,0xbec1071ebeb8442a,0xbed25a09bec9b953
.quad 0xbefc5d27bef15aea,0xbf08f59bbf039c3d,0xbf19c200bf13682a,0xbf26050abf1ff6cb,0xbf32c8c9bf2beb4a,0xbf3fc767bf396842,0xbf48d8b3bf41d870,0xbf55b993bf4f7a1f
.quad 0xbf5b941abf54db31,0xbf676bd8bf61c598,0xbf6aab7bbf64aa59,0xbf748422bf6ff573,0xbf75dec6bf710908,0xbf7cbfc9bf79c79d,0xbf7cfe73bf79c79d,0xbf7ff4e6bf7f0e58
.quad 0xbf7fec43bf7ec46d,0xbf7e1324bf7fb10f,0xbf7e9bc9bf7fec43,0xbf772417bf7baccd,0xbf791298bf7d3aac,0xbf6b4b0cbf731447,0xbf6f6830bf76ba07,0xbf5ac450bf660f88
.quad 0xbf61c598bf6c835e,0xbf45e403bf54db31,0xbf5064afbf5ebe05,0xbf2d1469bf3fc767,0xbf3b8f3bbf4d9f02,0xbf10d3cdbf273656,0xbf239da9bf396842,0xbee363fabf0b9a6b
.quad 0xbf08f59bbf226799,0xbea09ae5bedae880,0xbed8106bbf08f59b,0xbe354098be9aa086,0xbe9aa086bedae880,0xbd16c32cbe2f10a2,0xbe354098bea09ae5,0x3dd53db9bd16c32c
.quad 0xbd48fb30be47c5c2,0x3e78cfcc3dc8bd36,0x3da3308cbd96a905,0x3ec1071e3e6c9a7f,0x3e5415013d48fb30,0x3f00e7e43eb8442a,0x3ea986c43e2f10a2,0x3f1ebc123ef6e0cb
.quad 0x3ee633753e94a031,0x3f3968423f187fc0,0x3f0f87843ecf7bca,0x3f5064af3f32c8c9,0x3f2994153f039c3d,0x3f633c5a3f49d112,0x3f40d0da3f1d7fd1,0x3f718f573f5d2d53
.quad 0x8000000080000000,0x8000000080000000,0xbe1c76debe164083,0xbe28defcbe22abb6,0xbe9aa086be94a031,0xbea68f12bea09ae5,0xbee363fabedae880,0xbef41f07beebcbbb
.quad 0xbf13682abf0e39da,0xbf1d7fd1bf187fc0,0xbf31a81dbf2beb4a,0xbf3ca003bf373a23,0xbf4bbbf8bf45e403,0xbf5695e5bf514d3d,0xbf6106f2bf5b941a,0xbf6aab7bbf660f88
.quad 0xbf710908bf6c835e,0xbf7853f8bf74fa0b,0xbf7b61fcbf7853f8,0xbf7f2f9dbf7dabcc,0xbf7fd397bf7ec46d,0xbf7f0e58bf7fec43,0xbf7e4323bf7fb10f,0xbf77f110bf7baccd
.quad 0xbf76ba07bf7b14be,0xbf6a09a7bf710908,0xbf696591bf710908,0xbf55b993bf604621,0xbf5695e5bf61c598,0xbf3b8f3bbf49d112,0xbf3ebc1bbf4d9f02,0xbf1c420cbf2e3bde
.quad 0xbf226799bf3504f3,0xbef15aeabf0e39da,0xbf0242b1bf187fc0,0xbea395c5bed53641,0xbebe1d4abef15aea,0xbe22abb6be888e93,0xbe667c66beac7cd4,0x3bc90f88bde1bc2e
.quad 0xbd96a905be47c5c2,0x3e2f10a23d48fb30,0x3da3308cbd48fb30,0x3ea986c43e541501,0x3e6c9a7f3dc8bd36,0x3ef6e0cb3eb8442a,0x3ec1071e3e78cfcc,0x3f1ebc123f00e7e4
.quad 0x3f039c3d3ec3ef15,0x3f3daef93f226799,0x3f239da93f039c3d,0x3f5770263f3fc767,0x3f3fc7673f226799,0x3f6b4b0c3f584853,0x3f5770263f3daef9,0x3f78b47b3f6b4b0c
.quad 0x3f6a09a73f54db31,0x3f7f4e6d3f7853f8,0x3f7724173f676bd8,0x3f7eea9d3f7f0e58,0x3f7e70b03f74fa0b,0x3f778bc53f7f4e6d,0x3f7fc38f3f7d3aac,0x3f6965913f791298
.quad 0x8000000080000000,0x8000000080000000,0xbe354098be2f10a2,0xbe419b37be3b6ecf,0xbeb263efbeac7cd4,0xbebe1d4abeb8442a,0xbf0242b1befc5d27,0xbf0a48adbf064b82
.quad 0xbf273656bf226799,0xbf3085bbbf2beb4a,0xbf46e22abf41d870,0xbf5064afbf4bbbf8,0xbf604621bf5b941a,0xbf68bf3cbf64aa59,0xbf7294f8bf6ed89e,0xbf78b47bbf75dec6
.quad 0xbf7d3aacbf7b14be,0xbf7fb10fbf7ec46d,0xbf7fe129bf7fec43,0xbf7d7474bf7f0e58,0xbf7a7302bf7d3aac,0xbf721352bf76ba07,0xbf6d1c1dbf731447,0xbf5df6bebf660f88
.quad 0xbf584853bf61c598,0xbf41d870bf4d9f02,0xbf3ca003bf49d112,0xbf1ebc12bf2e3bde,0xbf1b02c6bf2beb4a,0xbeebcbbbbf08f59b,0xbee900b7bf08f59b,0xbe919dddbebe1d4a
.quad 0xbe94a031bec3ef15,0xbdc8bd36be47c5c2,0xbdee3876be605c13,0x3dbc3ac3bc490e90,0x3d7b2b74bd48fb30,0x3e8e9a223e2f10a2,0x3e72b6513dfab273,0x3ee900b73eb263ef
.quad 0x3ecf7bca3e94a031,0x3f1d7fd13f039c3d,0x3f0f87843ee63375,0x3f40d0da3f299415,0x3f32c8c93f187fc0,0x3f5d2d533f49d112,0x3f5064af3f396842,0x3f718f573f633c5a
.quad 0x3f676bd83f54db31,0x3f7d3aac3f74fa0b,0x3f7724173f6a09a7,0x3f7fc38f3f7e70b0,0x3f7f0e583f7853f8,0x3f7912983f7f4e6d,0x3f7eea9d3f7f4e6d,0x3f6965913f778bc5
.quad 0x3f76ba073f7ec46d,0x3f514d3d3f676bd8,0x3f66becc3f76ba07,0x3f31a81d3f4f7a1f,0x3f4f7a1f3f676bd8,0x3f0b9a6b3f3085bb,0x3f31a81d3f514d3d,0x3ec1071e3f0b9a6b
.quad 0x3612492536124925,0x3612492536124925,0x3612487036124925,0x361242cc36124653,0x3612465336124925,0x36122fc436123ddd,0x361242cc36124925,0x3612100e36122fc4
.quad 0x36123ddd36124925,0x3611e3ac36121c09,0x3612378536124925,0x3611aaa3361202ab,0x36122fc436124925,0x361164f73611e3ac,0x3612269b36124925,0x361112ae3611bf0e
.quad 0x36121c0936124925,0x3610b3d0361194d1,0x3612100e36124925,0x36104865361164f7,0x361202ab36124925,0x360fd07536112f82,0x3611f3e036124925,0x360f4c0c3610f474
.quad 0x3611e3ac36124925,0x360ebb353610b3d0,0x3611d21136124925,0x360e1dfd36106d98,0x3611bf0e36124925,0x360d7471361021ce,0x3611aaa336124925,0x360cbe9f360fd075
.quad 0x361194d136124925,0x360bfc98360f7991,0x36117d9736124925,0x360b2e6d360f1d26,0x361164f736124925,0x360a542f360ebb35,0x36114af036124925,0x36096df1360e53c4
.quad 0x36112f8236124925,0x36087bc8360de6d7,0x361112ae36124925,0x36077dc8360d7471,0x3610f47436124925,0x36067407360cfc96,0x3610d4d536124925,0x36055e9c360c7f4d
.quad 0x3610b3d036124925,0x36043da0360bfc98,0x3610916636124925,0x3603112b360b747e,0x36106d9836124925,0x3601d958360ae704,0x3610486536124925,0x36009641360a542f
.quad 0x361021ce36124925,0x35fe90063609bc05,0x360ff9d336124925,0x35fbdd7536091e8b,0x360fd07536124925,0x35f9150b36087bc8,0x360fa5b536124925,0x35f637063607d3c2
.quad 0x3612492536124925,0x3612492536124925,0x3612378536123ddd,0x3612269b36122fc4,0x361202ab36121c09,0x3611bf0e3611e3ac,0x3611aaa33611e3ac,0x361112ae361164f7
.quad 0x36112f82361194d1,0x361021ce3610b3d0,0x3610916636112f82,0x360eecde360fd075,0x360fd0753610b3d0,0x360d7471360ebb35,0x360eecde361021ce,0x360bb938360d7471
.quad 0x360de6d7360f7991,0x3609bc05360bfc98,0x360cbe9f360ebb35,0x36077dc8360a542f,0x360b747e360de6d7,0x3604ff9036087bc8,0x360a08c4360cfc96,0x3602428b36067407
.quad 0x36087bc8360bfc98,0x35fe900636043da0,0x3606cde9360ae704,0x35f822c33601d958,0x3604ff903609bc05,0x35f1405335fe9006,0x3603112b36087bc8,0x35e9ebf935f9150b
.quad 0x360103323607267f,0x35e2292835f343a6,0x35fdac473605bc5f,0x35d9fb8d35ed1ddb,0x35f9150b36043da0,0x35d1670335e6a5cc,0x35f441cc3602aa7c,0x35c86f9835dfddb7
.quad 0x35ef33b336010332,0x35bf198735d8c7f8,0x35e9ebf935fe9006,0x35b5693935d16703,0x35e46be135faf267,0x35ab634135c9bd68,0x35deb4c135f72e15,0x35a10c5c35c1cdce
.quad 0x35d8c7f835f343a6,0x3596696a35b99af8,0x35d2a6f435ef33b3,0x358b7f7235b127bd,0x35cc532f35eafede,0x3580539b35a8770c,0x35c5ce2f35e6a5cc,0x3569d656359f8be8
.quad 0x35bf198735e22928,0x3552970b3596696a,0x35b836d335dd89a5,0x353af44f358d12bd,0x35b127bd35d8c7f8,0x3522f94b35838b1e,0x35a9edf835d3e4dd,0x350ab1533573abb8
.quad 0x3612492536124925,0x3612492536124925,0x3612100e36121c09,0x3611f3e0361202ab,0x361164f7361194d1,0x3610f47436112f82,0x361048653610b3d0,0x360f4c0c360fd075
.quad 0x360ebb35360f7991,0x360cfc96360de6d7,0x360cbe9f360de6d7,0x360a08c4360b747e,0x360a542f360bfc98,0x3606740736087bc8,0x36077dc83609bc05,0x3602428b3604ff90
.quad 0x36043da03607267f,0x35faf26736010332,0x3600964136043da0,0x35f03b2c35f9150b,0x35f9150b36010332,0x35e46be135ef33b3,0x35f03b2c35faf267,0x35d7924c35e46be1
.quad 0x35e6a5cc35f343a6,0x35c9bd6835d8c7f8,0x35dc5c6635eafede,0x35bafd5335cc532f,0x35d1670335e22928,0x35ab634135bf1987,0x35c5ce2f35d8c7f8,0x359b016235b127bd
.quad 0x35b99af835cee116,0x3589eacf35a28b42,0x35acd6e435c47a9d,0x357066e635935229,0x359f8be835b99af8,0x354bdfec35838b1e,0x3591c46635ae48db,0x35266b4635668aa8
.quad 0x35838b1e35a28b42,0x3500349d354520f2,0x3569d6563596696a,0x34b2d0fd3522f94b,0x354bdfec3589eacf,0x3448d0933500349d,0x352d4a63357a2e49,0x332c543e34b9e8cf
.quad 0x350e2d99355fecab,0xb3e5b15b34656a87,0x34dd43ad354520f2,0xb488204433ac4cc4,0x349d7f753529dba6,0xb4d6357fb365c312,0x343a80a0350e2d99,0xb511a880b448d093
.quad 0x3365c31234e44fb9,0xb5378c73b4abb772,0xb38f97d834abb772,0xb55c9a6bb4f26126,0xb448d09334656a87,0xb580539bb51c10a8,0xb4a49c3e33e5b15b,0xb591c466b53e5a5e
.quad 0x3612492536124925,0x3612492536124925,0x3611d2113611e3ac,0x3611aaa33611bf0e,0x36106d983610b3d0,0x360fd075361021ce,0x360e1dfd360ebb35,0x360cbe9f360d7471
.quad 0x360ae704360bfc98,0x36087bc83609bc05,0x3606cde936087bc8,0x3603112b3604ff90,0x3601d95836043da0,0x35f9150b35fe9006,0x35f822c335fe9006,0x35e9ebf935f14053
.quad 0x35eafede35f343a6,0x35d8c7f835e22928,0x35dc5c6635e6a5cc,0x35c5ce2f35d16703,0x35cc532f35d8c7f8,0x35b127bd35bf1987,0x35bafd5335c9bd68,0x359b016235ab6341
.quad 0x35a8770c35b99af8,0x35838b1e3596696a,0x3594de8135a8770c,0x3555ef933580539b,0x3580539b3596696a,0x3522f94b3552970b,0x3555ef9335838b1e,0x34dd43ad3522f94b
.quad 0x3529dba6355fecab,0x34656a8734e44fb9,0x34f9666435378c73,0x3265c89b3480fdd1,0x349d7f75350e2d99,0xb448d0933365c312,0x3401303c34c81302,0xb4cf2540b40f868b
.quad 0xb365c31234656a87,0xb51c10a8b4abb772,0xb473b4413365c312,0xb54f3c7bb50733b6,0xb4d6357fb3e5b15b,0xb580539bb5378c73,0xb5189a11b48f4166,0xb597f2e0b5668aa8
.quad 0xb54520f2b4e44fb9,0xb5ae48dbb589eacf,0xb57066e6b51c10a8,0xb5c32527b59f8be8,0xb58d12bdb54520f2,0xb5d65a8db5b3ffcb,0xb5a10c5cb56d1fc2,0xb5e7bf6db5c71fd9
.quad 0xb5b3ffcbb589eacf,0xb5f72e15b5d8c7f8,0xb5c5ce2fb59c8668,0xb602428bb5e8d6d2,0xb5d65a8db5ae48db,0xb607d3c2b5f72e15,0xb5e589f2b5bf1987,0xb60c3ea0b601d958
.quad 0x3612492536124925,0x3612492536124925,0x36117d97361194d1,0x36114af0361164f7,0x360f1d26360f7991,0x360e53c4360ebb35,0x360b2e6d360bfc98,0x36096df1360a542f
.quad 0x3605bc5f3607267f,0x3602aa7c36043da0,0x35fdac4736010332,0x35f441cc35f9150b,0x35ed1ddb35f343a6,0x35dfddb735e6a5cc,0x35d9fb8d35e22928,0x35c86f9835d16703
.quad 0x35c47a9d35cee116,0x35ae48db35b99af8,0x35acd6e435b99af8,0x3591c466359f8be8,0x3593522935a28b42,0x35668aa835838b1e,0x357066e63589eacf,0x35266b46354bdfec
.quad 0x35378c73355fecab,0x34c81302350e2d99,0x34f966643529dba6,0x3401303c349d7f75,0x3480fdd134e44fb9,0xb40f868b3365c312,0x3265c89b34656a87,0xb4cf2540b448d093
.quad 0xb4656a871b215ccb,0xb529dba6b4e44fb9,0xb4eb5992b4656a87,0xb569d656b530b775,0xb530b775b4e44fb9,0xb5935229b56d1fc2,0xb569d656b529dba6,0xb5afb925b5935229
.quad 0xb590353bb55fecab,0xb5c9bd68b5ae48db,0xb5a9edf8b589eacf,0xb5e10486b5c71fd9,0xb5c1cdceb5a28b42,0xb5f53d98b5dd89a5,0xb5d7924cb5b99af8,0xb603112bb5f14053
.quad 0xb5eafedeb5cee116,0xb609bc05b6010332,0xb5fbdd75b5e22928,0xb60e882db607d3c2,0xb604ff90b5f343a6,0xb61164f7b60cfc96,0xb60a9e45b6010332,0xb6124870b6106d98
.quad 0xb60ebb35b607267f,0xb6112f82b6121c09,0xb6114af0b60bfc98,0xb60e1dfdb61202ab,0xb6124653b60f7991,0xb6091e8bb61021ce,0xb611aaa3b61194d1,0xb602428bb60c7f4d
.quad 0x3612492536124925,0x3612492536124925,0x361112ae36112f82,0x3610d4d53610f474,0x360d7471360de6d7,0x360c7f4d360cfc96,0x36077dc836087bc8,0x36055e9c36067407
.quad 0x35fe900636010332,0x35f72e1535faf267,0x35e9ebf935ef33b3,0x35deb4c135e46be1,0x35d1670335d8c7f8,0x35c1cdce35c9bd68,0x35b5693935bf1987,0x35a10c5c35ab6341
.quad 0x3596696a35a28b42,0x357a2e493589eacf,0x3569d65635838b1e,0x352d4a63354bdfec,0x3522f94b354520f2,0x34b9e8cf3500349d,0x34b2d0fd3500349d,0x332c543e3448d093
.quad 0x3365c31234656a87,0xb48f4166b3e5b15b,0xb473b441b365c312,0xb5189a11b4d6357f,0xb50733b6b4abb772,0xb5668aa8b5378c73,0xb54f3c7bb51c10a8,0xb597f2e0b580539b
.quad 0xb589eacfb55fecab,0xb5b99af8b5a28b42,0xb5a9edf8b590353b,0xb5d7924cb5c1cdce,0xb5c71fd9b5ae48db,0xb5f14053b5dd89a5,0xb5e10486b5c9bd68,0xb603112bb5f53d98
.quad 0xb5f72e15b5e22928,0xb60ae704b6043da0,0xb6049f3bb5f72e15,0xb60ff9d3b60b747e,0xb60b747eb6043da0,0xb6122fc4b61021ce,0xb60ff9d3b60ae704,0xb6117d97b6122fc4
.quad 0xb6121c09b60f7991,0xb60de6d7b61194d1,0xb611d211b611e3ac,0xb6077dc8b60e53c4,0xb60f1d26b6121c09,0xb5fcc616b6087bc8,0xb60a08c4b61021ce,0xb5e589f2b6002813
.quad 0xb602aa7cb60bfc98,0xb5c9bd68b5eafede,0xb5f24328b605bc5f,0xb5a9edf8b5d16703,0xb5db2d08b5faf267,0xb586bd8fb5b3ffcb,0xb5c07498b5e6a5cc,0xb541be97b5935229
.quad 0x3612492536124925,0x3612492536124925,0x361091663610b3d0,0x3610486536106d98,0x360b747e360bfc98,0x360a542f360ae704,0x3603112b36043da0,0x360096413601d958
.quad 0x35ef33b335f343a6,0x35e6a5cc35eafede,0x35d2a6f435d8c7f8,0x35c5ce2f35cc532f,0x35b127bd35b99af8,0x359f8be835a8770c,0x358b7f723596696a,0x3569d6563580539b
.quad 0x354520f2355fecab,0x350e2d993529dba6,0x34dd43ad350e2d99,0x343a80a0349d7f75,0x33ac4cc434656a87,0xb448d093b365c312,0xb4882044b3e5b15b,0xb511a880b4d6357f
.quad 0xb51c10a8b4e44fb9,0xb56d1fc2b54520f2,0xb57066e6b54520f2,0xb5a10c5cb58d12bd,0xb59f8be8b589eacf,0xb5c71fd9b5b3ffcb,0xb5c32527b5ae48db,0xb5e7bf6db5d65a8d
.quad 0xb5e22928b5cee116,0xb6010332b5f343a6,0xb5fbdd75b5eafede,0xb60a9e45b604ff90,0xb607d3c2b6010332,0xb6106d98b60cfc96,0xb60e882db609bc05,0xb6124870b61164f7
.quad 0xb611e3acb60f7991,0xb61021ceb6121c09,0xb611d211b6121c09,0xb60a08c4b60f1d26,0xb60e53c4b61194d1,0xb6002813b6087bc8,0xb6077dc8b60de6d7,0xb5e589f2b5fcc616
.quad 0xb5faf267b607267f,0xb5c47a9db5e22928,0xb5e10486b5faf267,0xb59e09ebb5c1cdce,0xb5c1cdceb5e22928,0xb5668aa8b59c8668,0xb59e09ebb5c47a9d,0xb50ab153b5668aa8
.quad 0xb56d1fc2b5a28b42,0xb42c2ee1b50e2d99,0xb5189a11b57a2e49,0x34571e96b448d093,0xb480fdd1b529dba6,0x35152201342c2ee1,0x33c90008b4abb772,0x357066e6350733b6
.quad 0x3612492536124925,0x3612492536124925,0x360ff9d3361021ce,0x360fa5b5360fd075,0x36091e8b3609bc05,0x3607d3c236087bc8,0x35fbdd7535fe9006,0x35f6370635f9150b
.quad 0x35dd89a535e22928,0x35d3e4dd35d8c7f8,0x35b836d335bf1987,0x35a9edf835b127bd,0x358d12bd3596696a,0x3573abb835838b1e,0x353af44f3552970b,0x350ab1533522f94b
.quad 0x34abb77234e44fb9,0x33e5b15b34656a87,0xb38f97d83365c312,0xb4a49c3eb448d093,0xb4f26126b4abb772,0xb53e5a5eb51c10a8,0xb55c9a6bb5378c73,0xb591c466b580539b
.quad 0xb59c8668b589eacf,0xb5bf1987b5ae48db,0xb5c5ce2fb5b3ffcb,0xb5e589f2b5d65a8d,0xb5e8d6d2b5d8c7f8,0xb601d958b5f72e15,0xb602428bb5f72e15,0xb60c3ea0b607d3c2
.quad 0xb60bfc98b607267f,0xb61194d1b60f7991,0xb6114af0b60ebb35,0xb611aaa3b6124653,0xb61202abb6121c09,0xb60c7f4db61021ce,0xb60e1dfdb6112f82,0xb602428bb6091e8b
.quad 0xb605bc5fb60bfc98,0xb5e6a5ccb5faf267,0xb5f24328b602aa7c,0xb5c07498b5db2d08,0xb5d16703b5eafede,0xb5935229b5b3ffcb,0xb5a9edf8b5c9bd68,0xb541be97b586bd8f
.quad 0xb57a2e49b5a28b42,0xb4abb772b529dba6,0xb5189a11b56d1fc2,0x33c90008b480fdd1,0xb448d093b50e2d99,0x350733b6342c2ee1,0x34571e96b42c2ee1,0x357066e635152201
.quad 0x351c10a834656a87,0x35a8770c357a2e49,0x357d6bf8351c10a8,0x35d2a6f435ab6341,0x35ab6341357a2e49,0x35f53d9835d3e4dd,0x35d2a6f435a8770c,0x36077dc835f53d98
.quad 0x0,0x0,0x3265c89b00000000,0x332c543e32e5c780,0x32e5c78000000000,0x33ac4cc43365c312,0x332c543e00000000,0x3401303c33ac4cc4
.quad 0x3365c31200000000,0x342c2ee133e5b15b,0x338f97d800000000,0x34571e96340f868b,0x33ac4cc400000000,0x3480fdd1342c2ee1,0x33c9000800000000,0x349661273448d093
.quad 0x33e5b15b00000000,0x34abb77234656a87,0x3401303c00000000,0x34c0fed73480fdd1,0x340f868b00000000,0x34d6357f348f4166,0x341ddb7900000000,0x34eb5992349d7f75
.quad 0x342c2ee100000000,0x3500349d34abb772,0x343a80a000000000,0x350ab15334b9e8cf,0x3448d09300000000,0x3515220134c81302,0x34571e9600000000,0x351f85bf34d6357f
.quad 0x34656a8700000000,0x3529dba634e44fb9,0x3473b44100000000,0x353422d234f26126,0x3480fdd100000000,0x353e5a5e3500349d,0x3488204400000000,0x35488167350733b6
.quad 0x348f416600000000,0x3552970b350e2d99,0x3496612700000000,0x355c9a6b35152201,0x349d7f7500000000,0x35668aa8351c10a8,0x34a49c3e00000000,0x357066e63522f94b
.quad 0x34abb77200000000,0x357a2e493529dba6,0x34b2d0fd00000000,0x3581effd3530b775,0x34b9e8cf00000000,0x3586bd8f35378c73,0x34c0fed700000000,0x358b7f72353e5a5e
.quad 0x34c8130200000000,0x3590353b354520f2,0x34cf254000000000,0x3594de81354bdfec,0x34d6357f00000000,0x35997ade3552970b,0x34dd43ad00000000,0x359e09eb3559460b
.quad 0x0,0x0,0x338f97d83365c312,0x33c9000833ac4cc4,0x340f868b33e5b15b,0x3448d093342c2ee1,0x34571e96342c2ee1,0x349661273480fdd1
.quad 0x348f416634656a87,0x34c8130234abb772,0x34b2d0fd348f4166,0x34f9666434d6357f,0x34d6357f34abb772,0x351522013500349d,0x34f9666434c81302,0x352d4a6335152201
.quad 0x350e2d9934e44fb9,0x354520f23529dba6,0x351f85bf3500349d,0x355c9a6b353e5a5e,0x3530b775350e2d99,0x3573abb83552970b,0x3541be97351c10a8,0x358524fb35668aa8
.quad 0x3552970b3529dba6,0x3590353b357a2e49,0x35633cc235378c73,0x359b01623586bd8f,0x3573abb8354520f2,0x35a584583590353b,0x3581effd3552970b,0x35afb92535997ade
.quad 0x3589eacf355fecab,0x35b99af835a28b42,0x3591c466356d1fc2,0x35c3252735ab6341,0x35997ade357a2e49,0x35cc532f35b3ffcb,0x35a10c5c35838b1e,0x35d520bc35bc5de1
.quad 0x35a8770c3589eacf,0x35dd89a535c47a9d,0x35afb9253590353b,0x35e589f235cc532f,0x35b6d0e83596696a,0x35ed1ddb35d3e4dd,0x35bdbc9e359c8668,0x35f441cc35db2d08
.quad 0x35c47a9d35a28b42,0x35faf26735e22928,0x35cb094635a8770c,0x3600964135e8d6d2,0x35d1670335ae48db,0x3603769735ef33b3,0x35d7924c35b3ffcb,0x360618d835f53d98
.quad 0x35dd89a535b99af8,0x36087bc835faf267,0x35e34b9d35bf1987,0x360a9e4536002813,0x35e8d6d235c47a9d,0x360c7f4d3602aa7c,0x35ee29ed35c9bd68,0x360e1dfd3604ff90
.quad 0x0,0x0,0x3401303c33e5b15b,0x341ddb79340f868b,0x3480fdd134656a87,0x349d7f75348f4166,0x34c0fed734abb772,0x34eb599234d6357f
.quad 0x3500349d34e44fb9,0x351c10a8350e2d99,0x351f85bf350e2d99,0x3541be973530b775,0x353e5a5e3529dba6,0x35668aa83552970b,0x355c9a6b354520f2,0x358524fb3573abb8
.quad 0x357a2e49355fecab,0x3596696a3589eacf,0x358b7f72357a2e49,0x35a6fe8035997ade,0x35997ade3589eacf,0x35b6d0e835a8770c,0x35a6fe803596696a,0x35c5ce2f35b6d0e8
.quad 0x35b3ffcb35a28b42,0x35d3e4dd35c47a9d,0x35c0749835ae48db,0x35e1048635d16703,0x35cc532f35b99af8,0x35ed1ddb35dd89a5,0x35d7924c35c47a9d,0x35f822c335e8d6d2
.quad 0x35e2292835cee116,0x3601033235f343a6,0x35ec0f8035d8c7f8,0x36055e9c35fcc616,0x35f53d9835e22928,0x36091e8b3602aa7c,0x35fdac4735eafede,0x360c3ea036067407
.quad 0x3602aa7c35f343a6,0x360ebb353609bc05,0x360618d835faf267,0x36109166360c7f4d,0x36091e8b36010332,0x3611bf0e360ebb35,0x360bb93836043da0,0x361242cc36106d98
.quad 0x360de6d73607267f,0x36121c09361194d1,0x360fa5b53609bc05,0x36114af036122fc4,0x3610f474360bfc98,0x360fd07536123ddd,0x3611d211360de6d7,0x360dae533611bf0e
.quad 0x36123ddd360f7991,0x360ae7043610b3d0,0x361237853610b3d0,0x36077dc8360f1d26,0x3611bf0e361194d1,0x36037697360cfc96,0x3610d4d536121c09,0x35fdac47360a542f
.quad 0x0,0x0,0x343a80a0342c2ee1,0x34571e963448d093,0x34b9e8cf34abb772,0x34d6357f34c81302,0x350ab1533500349d,0x351f85bf35152201
.quad 0x35378c733529dba6,0x3552970b354520f2,0x35633cc23552970b,0x3581effd3573abb8,0x3586bd8f357a2e49,0x35997ade3590353b,0x359b01623590353b,0x35afb92535a58458
.quad 0x35ae48db35a28b42,0x35c47a9d35b99af8,0x35c0749835b3ffcb,0x35d7924c35cc532f,0x35d1670335c47a9d,0x35e8d6d235dd89a5,0x35e1048635d3e4dd,0x35f822c335ed1ddb
.quad 0x35ef33b335e22928,0x3602aa7c35faf267,0x35fbdd7535ef33b3,0x3608286d36037697,0x3603769735faf267,0x360c7f4d36087bc8,0x3608286d3602aa7c,0x360fa5b5360c7f4d
.quad 0x360bfc983607267f,0x361194d1360f7991,0x360eecde360ae704,0x36124870361164f7,0x3610f474360de6d7,0x3611bf0e36123ddd,0x3612100e361021ce,0x360ff9d3361202ab
.quad 0x36123ddd361194d1,0x360cfc963610b3d0,0x36117d9736123ddd,0x3608cdd2360e53c4,0x360fd07536121c09,0x36037697360ae704,0x360d393236112f82,0x35fa04ee36067407
.quad 0x3609bc05360f7991,0x35eafede36010332,0x36055e9c360cfc96,0x35d9fb8d35f53d98,0x360028133609bc05,0x35c71fd935e6a5cc,0x35f441cc3605bc5f,0x35b294a035d65a8d
.quad 0x35e6a5cc36010332,0x359c866835c47a9d,0x35d7924c35f72e15,0x358524fb35b127bd,0x35c71fd935eafede,0x3559460b359c8668,0x35b5693935dd89a5,0x35266b463586bd8f
.quad 0x0,0x0,0x3473b44134656a87,0x348820443480fdd1,0x34f2612634e44fb9,0x350733b63500349d,0x353422d23529dba6,0x35488167353e5a5e
.quad 0x356d1fc2355fecab,0x35838b1e357a2e49,0x3591c4663589eacf,0x35a10c5c35997ade,0x35ab634135a28b42,0x35bc5de135b3ffcb,0x35c3252735b99af8,0x35d520bc35cc532f
.quad 0x35d8c7f835cee116,0x35eafede35e22928,0x35ec0f8035e22928,0x35fdac4735f53d98,0x35fcc61635f343a6,0x360674073602aa7c,0x36055e9c36010332,0x360c3ea036091e8b
.quad 0x360ae7043607267f,0x361021ce360de6d7,0x360eecde360bfc98,0x3612100e3610f474,0x361164f7360f7991,0x361202ab36123ddd,0x36124870361194d1,0x360ff9d33611bf0e
.quad 0x361194d136124925,0x360bfc98360f7991,0x360f4c0c361194d1,0x360618d8360b747e,0x360b747e360f7991,0x35fcc6163605bc5f,0x360618d8360bfc98,0x35e9ebf935fcc616
.quad 0x35fe90063607267f,0x35d3e4dd35eafede,0x35ee29ed36010332,0x35bafd5335d65a8d,0x35db2d0835f343a6,0x359f8be835bf1987,0x35c5ce2f35e22928,0x3581effd35a58458
.quad 0x35ae48db35cee116,0x354520f23589eacf,0x3594de8135b99af8,0x3503b4cc3559460b,0x3573abb835a28b42,0x3480fdd1351c10a8,0x353af44f3589eacf,0xb265c89b34b9e8cf
.quad 0x3500349d355fecab,0xb48f416633e5b15b,0x348820443529dba6,0xb50ab153b40f868b,0x32e5c78034e44fb9,0xb54bdfecb4c81302,0xb4571e9634656a87,0xb58524fbb522f94b
.quad 0x0,0x0,0x34966127348f4166,0x34a49c3e349d7f75,0x35152201350e2d99,0x3522f94b351c10a8,0x355c9a6b3552970b,0x357066e635668aa8
.quad 0x3590353b3589eacf,0x359c86683596696a,0x35afb92535a8770c,0x35bdbc9e35b6d0e8,0x35cc532f35c47a9d,0x35db2d0835d3e4dd,0x35e589f235dd89a5,0x35f441cc35ed1ddb
.quad 0x35faf26735f343a6,0x36043da036010332,0x360618d83602aa7c,0x360bb93836091e8b,0x360c7f4d3609bc05,0x36106d98360ebb35,0x36109166360ebb35,0x361242cc3611bf0e
.quad 0x36123ddd361194d1,0x36112f8236121c09,0x36117d9736123ddd,0x360d3932360fd075,0x360e53c43610b3d0,0x36067407360ae704,0x3608cdd2360cfc96,0x35fa04ee36037697
.quad 0x360103323607267f,0x35e2292835f343a6,0x35ee29ed35fe9006,0x35c5ce2f35db2d08,0x35d65a8d35eafede,0x35a5845835bf1987,0x35bafd5335d3e4dd,0x3581effd359f8be8
.quad 0x359c866835b99af8,0x35378c73357a2e49,0x3576ee32359c8668,0x34cf25403530b775,0x3530b775357a2e49,0x33ac4cc434c81302,0x34cf254035378c73,0xb473b44133ac4cc4
.quad 0x33e5b15b34e44fb9,0xb50e2d99b4656a87,0xb43a80a0342c2ee1,0xb55c9a6bb50733b6,0xb4f26126b3e5b15b,0xb5935229b552970b,0xb541be97b4c81302,0xb5b56939b58d12bd
.quad 0xb5838b1eb529dba6,0xb5d3e4ddb5ae48db,0xb5a40897b56d1fc2,0xb5ee29edb5cc532f,0xb5c1cdceb596696a,0xb601d958b5e6a5cc,0xb5dc5c66b5b3ffcb,0xb60a08c4b5fcc616
.quad 0x0,0x0,0x34b2d0fd34abb772,0x34c0fed734b9e8cf,0x3530b7753529dba6,0x353e5a5e35378c73,0x3581effd357a2e49,0x358b7f723586bd8f
.quad 0x35a8770c35a28b42,0x35b3ffcb35ae48db,0x35cb094635c47a9d,0x35d7924c35d16703,0x35e8d6d235e22928,0x35f53d9835ef33b3,0x3600964135faf267,0x360618d836037697
.quad 0x3609bc053607267f,0x360de6d7360bfc98,0x360fa5b5360de6d7,0x3611d2113610f474,0x36122fc4361194d1,0x3611bf0e36123ddd,0x36114af036121c09,0x360dae53360fd075
.quad 0x360cfc96360f7991,0x3605bc5f3609bc05,0x36055e9c3609bc05,0x35f441cc36002813,0x35f53d9836010332,0x35d65a8d35e6a5cc,0x35d9fb8d35eafede,0x35b294a035c71fd9
.quad 0x35b99af835cee116,0x3589eacf35a28b42,0x3594de8135ae48db,0x353af44f3573abb8,0x3559460b3589eacf,0x34b9e8cf351c10a8,0x3503b4cc354520f2,0xb265c89b3480fdd1
.quad 0x342c2ee134e44fb9,0xb4c81302b3e5b15b,0xb43a80a033e5b15b,0xb541be97b4f26126,0xb50733b6b4656a87,0xb58d12bdb552970b,0xb55c9a6bb50e2d99,0xb5b56939b5935229
.quad 0xb596696ab55fecab,0xb5d8c7f8b5b99af8,0xb5bafd53b596696a,0xb5f63706b5db2d08,0xb5db2d08b5b99af8,0xb6067407b5f72e15,0xb5f63706b5d8c7f8,0xb60e1dfdb6067407
.quad 0xb605bc5fb5f343a6,0xb611e3acb60de6d7,0xb60d3932b6043da0,0xb611aaa3b611bf0e,0xb61164f7b60bfc98,0xb60d7471b611e3ac,0xb612269bb610b3d0,0xb6055e9cb60e53c4
.quad 0x0,0x0,0x34cf254034c81302,0x34dd43ad34d6357f,0x354bdfec354520f2,0x3559460b3552970b,0x3594de813590353b,0x359e09eb35997ade
.quad 0x35bf198735b99af8,0x35c9bd6835c47a9d,0x35e34b9d35dd89a5,0x35ee29ed35e8d6d2,0x3600281335faf267,0x3604ff903602aa7c,0x360a9e4536087bc8,0x360e1dfd360c7f4d
.quad 0x3610b3d0360f7991,0x36121c09361194d1,0x3612378536123ddd,0x3610d4d53611bf0e,0x360f1d263610b3d0,0x360a542f360cfc96,0x36077dc8360ae704,0x35fdac4736037697
.quad 0x35f72e1536010332,0x35dd89a535eafede,0x35d7924c35e6a5cc,0x35b5693935c71fd9,0x35b127bd35c47a9d,0x3586bd8f359c8668,0x358524fb359c8668,0x35266b463559460b
.quad 0x3529dba6355fecab,0x34656a8734e44fb9,0x348820443500349d,0xb4571e9632e5c780,0xb40f868b33e5b15b,0xb522f94bb4c81302,0xb50ab153b48f4166,0xb58524fbb54bdfec
.quad 0xb56d1fc2b529dba6,0xb5b3ffcbb596696a,0xb5a40897b5838b1e,0xb5dc5c66b5c1cdce,0xb5cc532fb5ae48db,0xb5fcc616b5e6a5cc,0xb5ee29edb5d3e4dd,0xb60a08c4b601d958
.quad 0xb6043da0b5f343a6,0xb610b3d0b60bfc98,0xb60d3932b605bc5f,0xb612269bb61164f7,0xb611bf0eb60de6d7,0xb60e53c4b611e3ac,0xb611aaa3b611e3ac,0xb6055e9cb60d7471
.quad 0xb60cfc96b61194d1,0xb5ef33b3b6043da0,0xb603dabeb60cfc96,0xb5cb0946b5ed1ddb,0xb5ed1ddbb6043da0,0xb59f8be8b5c9bd68,0xb5cb0946b5ef33b3,0xb55c9a6bb59f8be8
.quad 0x3f803f803f803f80,0x3f803f803f803f80,0x3f553f6d3f7b3f80,0xbf0ebec4be48248d,0x3ec43f353f6d3f80,0xbec4bf35bf6dbf80,0xbe483ec43f553f80,0x3f7b3f6d3f0ea554
.quad 0xbf35248d3f353f80,0xbf3525b03f353f80,0xbf7bbec43f0e3f80,0xbe48bf6dbf5525b0,0xbf6dbf353ec43f80,0x3f6d3f35bec4bf80,0xbf0ebf6d3e483f80,0xbf553ec43f7ba5f7
.quad 0xa554bf80248d3f80,0xa731bf80261f3f80,0x3f0ebf6dbe483f80,0x3f553ec4bf7b261f,0x3f6dbf35bec43f80,0xbf6d3f353ec4bf80,0x3f7bbec4bf0e3f80,0x3e48bf6d3f55a731
.quad 0x3f35a554bf353f80,0x3f35a742bf353f80,0x3e483ec4bf553f80,0xbf7b3f6dbf0ea68d,0xbec43f35bf6d3f80,0x3ec4bf353f6dbf80,0xbf553f6dbf7b3f80,0x3f0ebec43e48a742
.quad 0xbf803f80bf803f80,0xbf803f80bf803f80,0xbf553f6dbf7b3f80,0x3f0ebec43e48a654,0xbec43f35bf6d3f80,0x3ec4bf353f6dbf80,0x3e483ec4bf553f80,0xbf7b3f6dbf0ea754
.quad 0x3f3525b0bf353f80,0x3f35a58ebf353f80,0x3f7bbec4bf0e3f80,0x3e48bf6d3f55a60d,0x3f6dbf35bec43f80,0xbf6d3f353ec4bf80,0x3f0ebf6dbe483f80,0x3f553ec4bf7ba765
.quad 0x261fbf80a5543f80,0x258dbf80a7773f80,0xbf0ebf6d3e483f80,0xbf553ec43f7ba58e,0xbf6dbf353ec43f80,0x3f6d3f35bec4bf80,0xbf7bbec43f0e3f80,0xbe48bf6dbf55a777
.quad 0xbf35a5f73f353f80,0xbf35a78d3f353f80,0xbe483ec43f553f80,0x3f7b3f6d3f0ea137,0x3ec43f353f6d3f80,0xbec4bf35bf6dbf80,0x3f553f6d3f7b3f80,0xbf0ebec4be48a784
.quad 0x3f803f803f803f80,0x3f803f803f803f80,0x3e483ec43f0e3f35,0xbf7bbf6dbf55bf35,0xbf6dbf35bec4248d,0x3f6d3f353ec4a554,0xbf0ebf6dbf7bbf35,0xbf55bec43e483f35
.quad 0x3f35a554bf35bf80,0x3f35a5f7bf35bf80,0x3f553f6d3e48bf35,0xbf0e3ec43f7b3f35,0xbec43f353f6da554,0x3ec4bf35bf6d261f,0xbf7bbec43f553f35,0xbe483f6d3f0ebf35
.quad 0xa5f7bf8025b03f80,0xa742bf80a68d3f80,0x3f7bbec4bf553f35,0x3e483f6dbf0ebf35,0x3ec43f35bf6d25b0,0xbec4bf353f6da742,0xbf553f6dbe48bf35,0x3f0e3ec4bf7b3f35
.quad 0xbf35261f3f35bf80,0xbf35a60d3f35bf80,0x3f0ebf6d3f7bbf35,0x3f55bec4be483f35,0x3f6dbf353ec4a5f7,0xbf6d3f35bec4a60d,0xbe483ec4bf0e3f35,0x3f7bbf6d3f55bf35
.quad 0xbf803f80bf803f80,0xbf803f80bf803f80,0xbe483ec4bf0e3f35,0x3f7bbf6d3f55bf35,0x3f6dbf353ec4261f,0xbf6d3f35bec4a777,0x3f0ebf6d3f7bbf35,0x3f55bec4be483f35
.quad 0xbf35a7423f35bf80,0xbf35a78d3f35bf80,0xbf553f6dbe48bf35,0x3f0e3ec4bf7b3f35,0x3ec43f35bf6da731,0xbec4bf353f6d2804,0x3f7bbec4bf553f35,0x3e483f6dbf0ebf35
.quad 0xa60dbf80a7423f80,0x268dbf80a7963f80,0xbf7bbec43f553f35,0xbe483f6d3f0ebf35,0xbec43f353f6da68d,0x3ec4bf35bf6d2754,0x3f553f6d3e48bf35,0xbf0e3ec43f7b3f35
.quad 0x3f35a60dbf35bf80,0x3f352816bf35bf80,0xbf0ebf6dbf7bbf35,0xbf55bec43e483f35,0xbf6dbf35bec4a742,0x3f6d3f353ec42889,0x3e483ec43f0e3f35,0xbf7bbf6dbf55bf35
.quad 0x3f803f803f803f80,0x3f803f803f803f80,0xbf55bf6dbf7bbf80,0x3f0e3ec43e48a554,0x3ec43f353f6d3f80,0xbec4bf35bf6dbf80,0x3e48bec4bf55bf80,0xbf7bbf6dbf0e261f
.quad 0xbf35261f3f353f80,0xbf35a68d3f353f80,0x3f7b3ec4bf0ebf80,0x3e483f6d3f55a742,0xbf6dbf353ec43f80,0x3f6d3f35bec4bf80,0x3f0e3f6dbe48bf80,0x3f55bec4bf7ba60d
.quad 0xa754bf80a6543f80,0xa777bf80a58e3f80,0xbf0e3f6d3e48bf80,0xbf55bec43f7ba777,0x3f6dbf35bec43f80,0xbf6d3f353ec4bf80,0xbf7b3ec43f0ebf80,0xbe483f6dbf552804
.quad 0x3f35a777bf353f80,0x3f35a796bf353f80,0xbe48bec43f55bf80,0x3f7bbf6d3f0e2754,0xbec43f35bf6d3f80,0x3ec4bf353f6dbf80,0x3f55bf6d3f7bbf80,0xbf0e3ec4be482889
.quad 0xbf803f80bf803f80,0xbf803f80bf803f80,0x3f55bf6d3f7bbf80,0xbf0e3ec4be482828,0xbec43f35bf6d3f80,0x3ec4bf353f6dbf80,0xbe48bec43f55bf80,0x3f7bbf6d3f0e281f
.quad 0x3f35268dbf353f80,0x3f352828bf353f80,0xbf7b3ec43f0ebf80,0xbe483f6dbf5526d4,0x3f6dbf35bec43f80,0xbf6d3f353ec4bf80,0xbf0e3f6d3e48bf80,0xbf55bec43f7b2730
.quad 0x281fbf80a7b13f80,0x2839bf80a7e53f80,0x3f0e3f6dbe48bf80,0x3f55bec4bf7ba7e5,0xbf6dbf353ec43f80,0x3f6d3f35bec4bf80,0x3f7b3ec4bf0ebf80,0x3e483f6d3f552839
.quad 0xbf3526d43f353f80,0xbf35a8043f353f80,0x3e48bec4bf55bf80,0xbf7bbf6dbf0ea880,0x3ec43f353f6d3f80,0xbec4bf35bf6dbf80,0xbf55bf6dbf7bbf80,0x3f0e3ec43e4828a3
.quad 0x3f803f803f803f80,0x3f803f803f803f80,0xbe48bec4bf0ebf35,0x3f7b3f6d3f553f35,0xbf6dbf35bec425b0,0x3f6d3f353ec4a5f7,0x3f0e3f6d3f7b3f35,0x3f553ec4be48bf35
.quad 0x3f35a731bf35bf80,0x3f35a742bf35bf80,0xbf55bf6dbe483f35,0x3f0ebec4bf7bbf35,0xbec43f353f6da742,0x3ec4bf35bf6da60d,0x3f7b3ec4bf55bf35,0x3e48bf6dbf0e3f35
.quad 0xa765bf80a60d3f80,0xa784bf80a1373f80,0xbf7b3ec43f55bf35,0xbe48bf6d3f0e3f35,0x3ec43f35bf6da58e,0xbec4bf353f6da78d,0x3f55bf6d3e483f35,0xbf0ebec43f7bbf35
.quad 0xbf35258d3f35bf80,0xbf35268d3f35bf80,0xbf0e3f6dbf7b3f35,0xbf553ec43e48bf35,0x3f6dbf353ec4a78d,0xbf6d3f35bec42816,0x3e48bec43f0ebf35,0xbf7b3f6dbf553f35
.quad 0xbf803f80bf803f80,0xbf803f80bf803f80,0x3e48bec43f0ebf35,0xbf7b3f6dbf553f35,0x3f6dbf353ec4268d,0xbf6d3f35bec426d4,0xbf0e3f6dbf7b3f35,0xbf553ec43e48bf35
.quad 0xbf35270d3f35bf80,0xbf35a7e53f35bf80,0x3f55bf6d3e483f35,0xbf0ebec43f7bbf35,0x3ec43f35bf6da85d,0xbec4bf353f6d289a,0xbf7b3ec43f55bf35,0xbe48bf6d3f0e3f35
.quad 0x2730bf8026d43f80,0x28a3bf80a8803f80,0x3f7b3ec4bf55bf35,0x3e48bf6dbf0e3f35,0xbec43f353f6da7b1,0x3ec4bf35bf6d28be,0xbf55bf6dbe483f35,0x3f0ebec4bf7bbf35
.quad 0x3f352754bf35bf80,0x3f35a731bf35bf80,0x3f0e3f6d3f7b3f35,0x3f553ec4be48bf35,0xbf6dbf35bec4a7e5,0x3f6d3f353ec428ea,0xbe48bec4bf0ebf35,0x3f7b3f6d3f553f35
.quad 0x0,0x0,0x3f0e3ec43e480000,0x3f553f6d3f7b3f80,0x3f6d3f353ec40000,0xbf6dbf35bec4250d,0x3f7b3f6d3f0e0000,0x3e48bec4bf55bf80
.quad 0x3f353f803f350000,0x3f353f803f35a58d,0x3e483f6d3f550000,0xbf7bbec43f0e3f80,0xbec43f353f6d0000,0x3ec4bf35bf6d25d4,0xbf553ec43f7b0000,0x3f0e3f6dbe48bf80
.quad 0xbf80250d3f800000,0xbf8026303f80a60d,0xbf55bec43f7b0000,0x3f0ebf6dbe483f80,0xbec4bf353f6d0000,0x3ec43f35bf6d2630,0x3e48bf6d3f550000,0xbf7b3ec43f0ebf80
.quad 0x3f35bf803f350000,0x3f35bf803f35a654,0x3f7bbf6d3f0e0000,0x3e483ec4bf553f80,0x3f6dbf353ec40000,0xbf6d3f35bec42677,0x3f0ebec43e480000,0x3f55bf6d3f7bbf80
.quad 0x25d4a58d250d0000,0x27b1a6b0269fa68d,0xbf0e3ec4be480000,0xbf553f6dbf7b3f80,0xbf6d3f35bec40000,0x3f6dbf353ec4269f,0xbf7b3f6dbf0e0000,0xbe48bec43f55bf80
.quad 0xbf353f80bf350000,0xbf353f80bf35a6b0,0xbe483f6dbf550000,0x3f7bbec4bf0e3f80,0x3ec43f35bf6d0000,0xbec4bf353f6d27b1,0x3f553ec4bf7b0000,0xbf0e3f6d3e48bf80
.quad 0x3f8025d4bf800000,0x3f8027c2bf80a6d4,0x3f55bec4bf7b0000,0xbf0ebf6d3e483f80,0x3ec4bf35bf6d0000,0xbec43f353f6da70d,0xbe48bf6dbf550000,0x3f7b3ec4bf0ebf80
.quad 0xbf35bf80bf350000,0xbf35bf80bf35a6f7,0xbf7bbf6dbf0e0000,0xbe483ec43f553f80,0xbf6dbf35bec40000,0x3f6d3f353ec427c2,0xbf0ebec4be480000,0xbf55bf6dbf7bbf80
.quad 0x0,0x0,0x3f7b3f6d3f553f35,0x3e483ec43f0e3f35,0x3ec43f353f6d3f80,0xbec4bf35bf6dbf80,0xbf55bec43e483f35,0x3f0e3f6d3f7b3f35
.quad 0xbf35bf80bf35250d,0xbf35bf80bf3525d4,0x3f0ebec4bf7bbf35,0x3f553f6d3e48bf35,0x3f6d3f35bec4bf80,0xbf6dbf353ec43f80,0xbe483f6d3f0ebf35,0x3f7b3ec4bf55bf35
.quad 0xbf8025d43f80a58d,0xbf8026773f80a654,0xbe48bf6d3f0e3f35,0x3f7bbec4bf553f35,0x3f6dbf35bec43f80,0xbf6d3f353ec4bf80,0x3f0e3ec4bf7b3f35,0x3f55bf6d3e483f35
.quad 0xbf353f80bf3525d4,0xbf353f80bf35269f,0xbf553ec43e48bf35,0x3f0ebf6d3f7bbf35,0x3ec4bf353f6dbf80,0xbec43f35bf6d3f80,0x3f7bbf6d3f55bf35,0x3e48bec43f0ebf35
.quad 0x2677a6542630a60d,0x27c2a6f7a70da6d4,0xbf7b3f6dbf553f35,0xbe483ec4bf0e3f35,0xbec43f35bf6d3f80,0x3ec4bf353f6dbf80,0x3f55bec4be483f35,0xbf0e3f6dbf7b3f35
.quad 0x3f35bf803f352630,0x3f35bf803f3527c2,0xbf0ebec43f7bbf35,0xbf553f6dbe48bf35,0xbf6d3f353ec4bf80,0x3f6dbf35bec43f80,0x3e483f6dbf0ebf35,0xbf7b3ec43f55bf35
.quad 0x3f80269fbf80a654,0x3f80a68dbf80a71f,0x3e48bf6dbf0e3f35,0xbf7bbec43f553f35,0xbf6dbf353ec43f80,0x3f6d3f35bec4bf80,0xbf0e3ec43f7b3f35,0xbf55bf6dbe483f35
.quad 0x3f353f803f352677,0x3f353f803f35a68d,0x3f553ec4be48bf35,0xbf0ebf6dbf7bbf35,0xbec4bf35bf6dbf80,0x3ec43f353f6d3f80,0xbf7bbf6dbf55bf35,0xbe48bec4bf0ebf35
.quad 0x0,0x0,0xbf0ebec4be48250d,0xbf55bf6dbf7bbf80,0x3f6d3f353ec4a58d,0xbf6dbf35bec425d4,0xbf7bbf6dbf0e25d4,0xbe483ec43f553f80
.quad 0x3f353f803f35a60d,0x3f353f803f35a654,0xbe48bf6dbf552630,0x3f7b3ec4bf0ebf80,0xbec43f353f6da654,0x3ec4bf35bf6d269f,0x3f55bec4bf7b2677,0xbf0ebf6d3e483f80
.quad 0xbf80269f3f80a68d,0xbf80a70d3f80a6d4,0x3f553ec4bf7b269f,0xbf0e3f6d3e48bf80,0xbec4bf353f6da6b0,0x3ec43f35bf6d27c2,0xbe483f6dbf5527b1,0x3f7bbec4bf0e3f80
.quad 0x3f35bf803f35a6d4,0x3f35bf803f35a71f,0xbf7b3f6dbf0ea70d,0xbe48bec43f55bf80,0x3f6dbf353ec4a6f7,0xbf6d3f35bec4a68d,0xbf0e3ec4be4827c2,0xbf553f6dbf7b3f80
.quad 0x27d4a71fa6d4a70d,0x27f7278da60ea754,0x3f0ebec43e48a6d4,0x3f55bf6d3f7bbf80,0xbf6d3f35bec4a71f,0x3f6dbf353ec427f7,0x3f7bbf6d3f0e27d4,0x3e483ec4bf553f80
.quad 0xbf353f80bf35a730,0xbf353f80bf35a842,0x3e48bf6d3f55a68d,0xbf7b3ec43f0ebf80,0x3ec43f35bf6da831,0xbec4bf353f6d2884,0xbf55bec43f7b27e5,0x3f0ebf6dbe483f80
.quad 0x3f8027f7bf80a754,0x3f802816bf80a79f,0xbf553ec43f7ba60e,0x3f0e3f6dbe48bf80,0x3ec4bf35bf6d278d,0xbec43f353f6da7d4,0x3e483f6d3f5527f7,0xbf7bbec43f0e3f80
.quad 0xbf35bf80bf35a777,0xbf35bf80bf35270d,0x3f7b3f6d3f0ea1b7,0x3e48bec4bf55bf80,0xbf6dbf35bec4a842,0x3f6d3f353ec42909,0x3f0e3ec43e482804,0x3f553f6d3f7b3f80
.quad 0x0,0x0,0xbf7bbf6dbf55bf35,0xbe48bec4bf0ebf35,0x3ec43f353f6d3f80,0xbec4bf35bf6dbf80,0x3f553ec4be48bf35,0xbf0ebf6dbf7bbf35
.quad 0xbf35bf80bf352630,0xbf35bf80bf352677,0xbf0e3ec43f7b3f35,0xbf55bf6dbe483f35,0x3f6d3f35bec4bf80,0xbf6dbf353ec43f80,0x3e48bf6dbf0e3f35,0xbf7bbec43f553f35
.quad 0xbf8027b13f80a6b0,0xbf8027c23f80a6f7,0x3e483f6dbf0ebf35,0xbf7b3ec43f55bf35,0x3f6dbf35bec43f80,0xbf6d3f353ec4bf80,0xbf0ebec43f7bbf35,0xbf553f6dbe48bf35
.quad 0xbf353f80bf3527c2,0xbf353f80bf35a68d,0x3f55bec4be483f35,0xbf0e3f6dbf7b3f35,0x3ec4bf353f6dbf80,0xbec43f35bf6d3f80,0xbf7b3f6dbf553f35,0xbe483ec4bf0e3f35
.quad 0x27e5a831a68da730,0x2804a842a1b7a777,0x3f7bbf6d3f55bf35,0x3e48bec43f0ebf35,0xbec43f35bf6d3f80,0x3ec4bf353f6dbf80,0xbf553ec43e48bf35,0x3f0ebf6d3f7bbf35
.quad 0x3f35bf803f35a60e,0x3f35bf803f35280d,0x3f0e3ec4bf7b3f35,0x3f55bf6d3e483f35,0xbf6d3f353ec4bf80,0x3f6dbf35bec43f80,0xbe48bf6d3f0e3f35,0x3f7bbec4bf553f35
.quad 0x3f80260dbf80a842,0x3f80270dbf80270d,0xbe483f6d3f0ebf35,0x3f7b3ec4bf55bf35,0xbf6dbf353ec43f80,0x3f6d3f35bec4bf80,0x3f0ebec4bf7bbf35,0x3f553f6d3e48bf35
.quad 0x3f353f803f35280d,0x3f353f803f352896,0xbf55bec43e483f35,0x3f0e3f6d3f7b3f35,0xbec4bf35bf6dbf80,0x3ec43f353f6d3f80,0x3f7b3f6d3f553f35,0x3e483ec43f0e3f35
.quad 0x8000800080008000,0x8000800080008000,0xbf0ebec4be488000,0xbf55bf6dbf7bbf80,0xbf6dbf35bec48000,0x3f6d3f353ec4a50d,0xbf7bbf6dbf0e8000,0xbe483ec43f553f80
.quad 0xbf35bf80bf358000,0xbf35bf80bf35258d,0xbe48bf6dbf558000,0x3f7b3ec4bf0ebf80,0x3ec4bf35bf6d8000,0xbec43f353f6da5d4,0x3f55bec4bf7b8000,0xbf0ebf6d3e483f80
.quad 0x3f80a50dbf808000,0x3f80a630bf80260d,0x3f553ec4bf7b8000,0xbf0e3f6d3e48bf80,0x3ec43f35bf6d8000,0xbec4bf353f6da630,0xbe483f6dbf558000,0x3f7bbec4bf0e3f80
.quad 0xbf353f80bf358000,0xbf353f80bf352654,0xbf7b3f6dbf0e8000,0xbe48bec43f55bf80,0xbf6d3f35bec48000,0x3f6dbf353ec4a677,0xbf0e3ec4be488000,0xbf553f6dbf7b3f80
.quad 0xa5d4258da50d8000,0xa7b126b0a69f268d,0x3f0ebec43e488000,0x3f55bf6d3f7bbf80,0x3f6dbf353ec48000,0xbf6d3f35bec4a69f,0x3f7bbf6d3f0e8000,0x3e483ec4bf553f80
.quad 0x3f35bf803f358000,0x3f35bf803f3526b0,0x3e48bf6d3f558000,0xbf7b3ec43f0ebf80,0xbec4bf353f6d8000,0x3ec43f35bf6da7b1,0xbf55bec43f7b8000,0x3f0ebf6dbe483f80
.quad 0xbf80a5d43f808000,0xbf80a7c23f8026d4,0xbf553ec43f7b8000,0x3f0e3f6dbe48bf80,0xbec43f353f6d8000,0x3ec4bf35bf6d270d,0x3e483f6d3f558000,0xbf7bbec43f0e3f80
.quad 0x3f353f803f358000,0x3f353f803f3526f7,0x3f7b3f6d3f0e8000,0x3e48bec4bf55bf80,0x3f6d3f353ec48000,0xbf6dbf35bec4a7c2,0x3f0e3ec43e488000,0x3f553f6d3f7b3f80
.quad 0x8000800080008000,0x8000800080008000,0xbf7bbf6dbf55bf35,0xbe48bec4bf0ebf35,0xbec4bf35bf6dbf80,0x3ec43f353f6d3f80,0x3f553ec4be48bf35,0xbf0ebf6dbf7bbf35
.quad 0x3f353f803f35a50d,0x3f353f803f35a5d4,0xbf0e3ec43f7b3f35,0xbf55bf6dbe483f35,0xbf6dbf353ec43f80,0x3f6d3f35bec4bf80,0x3e48bf6dbf0e3f35,0xbf7bbec43f553f35
.quad 0x3f80a5d4bf80258d,0x3f80a677bf802654,0x3e483f6dbf0ebf35,0xbf7b3ec43f55bf35,0xbf6d3f353ec4bf80,0x3f6dbf35bec43f80,0xbf0ebec43f7bbf35,0xbf553f6dbe48bf35
.quad 0x3f35bf803f35a5d4,0x3f35bf803f35a69f,0x3f55bec4be483f35,0xbf0e3f6dbf7b3f35,0xbec43f35bf6d3f80,0x3ec4bf353f6dbf80,0xbf7b3f6dbf553f35,0xbe483ec4bf0e3f35
.quad 0xa6772654a630260d,0xa7c226f7270d26d4,0x3f7bbf6d3f55bf35,0x3e48bec43f0ebf35,0x3ec4bf353f6dbf80,0xbec43f35bf6d3f80,0xbf553ec43e48bf35,0x3f0ebf6d3f7bbf35
.quad 0xbf353f80bf35a630,0xbf353f80bf35a7c2,0x3f0e3ec4bf7b3f35,0x3f55bf6d3e483f35,0x3f6dbf35bec43f80,0xbf6d3f353ec4bf80,0xbe48bf6d3f0e3f35,0x3f7bbec4bf553f35
.quad 0xbf80a69f3f802654,0xbf80268d3f80271f,0xbe483f6d3f0ebf35,0x3f7b3ec4bf55bf35,0x3f6d3f35bec4bf80,0xbf6dbf353ec43f80,0x3f0ebec4bf7bbf35,0x3f553f6d3e48bf35
.quad 0xbf35bf80bf35a677,0xbf35bf80bf35268d,0xbf55bec43e483f35,0x3f0e3f6d3f7b3f35,0x3ec43f353f6d3f80,0xbec4bf35bf6dbf80,0x3f7b3f6d3f553f35,0x3e483ec43f0e3f35
.quad 0x8000800080008000,0x8000800080008000,0x3f0e3ec43e48a50d,0x3f553f6d3f7b3f80,0xbf6dbf35bec4258d,0x3f6d3f353ec4a5d4,0x3f7b3f6d3f0ea5d4,0x3e48bec4bf55bf80
.quad 0xbf35bf80bf35260d,0xbf35bf80bf352654,0x3e483f6d3f55a630,0xbf7bbec43f0e3f80,0x3ec4bf35bf6d2654,0xbec43f353f6da69f,0xbf553ec43f7ba677,0x3f0e3f6dbe48bf80
.quad 0x3f80a69fbf80268d,0x3f80270dbf8026d4,0xbf55bec43f7ba69f,0x3f0ebf6dbe483f80,0x3ec43f35bf6d26b0,0xbec4bf353f6da7c2,0x3e48bf6d3f55a7b1,0xbf7b3ec43f0ebf80
.quad 0xbf353f80bf3526d4,0xbf353f80bf35271f,0x3f7bbf6d3f0e270d,0x3e483ec4bf553f80,0xbf6d3f35bec426f7,0x3f6dbf353ec4268d,0x3f0ebec43e48a7c2,0x3f55bf6d3f7bbf80
.quad 0xa7d4271f26d4270d,0xa7f7a78d260e2754,0xbf0e3ec4be4826d4,0xbf553f6dbf7b3f80,0x3f6dbf353ec4271f,0xbf6d3f35bec4a7f7,0xbf7b3f6dbf0ea7d4,0xbe48bec43f55bf80
.quad 0x3f35bf803f352730,0x3f35bf803f352842,0xbe483f6dbf55268d,0x3f7bbec4bf0e3f80,0xbec4bf353f6d2831,0x3ec43f35bf6da884,0x3f553ec4bf7ba7e5,0xbf0e3f6d3e48bf80
.quad 0xbf80a7f73f802754,0xbf80a8163f80279f,0x3f55bec4bf7b260e,0xbf0ebf6d3e483f80,0xbec43f353f6da78d,0x3ec4bf35bf6d27d4,0xbe48bf6dbf55a7f7,0x3f7b3ec4bf0ebf80
.quad 0x3f353f803f352777,0x3f353f803f35a70d,0xbf7bbf6dbf0e21b7,0xbe483ec43f553f80,0x3f6d3f353ec42842,0xbf6dbf35bec4a909,0xbf0ebec4be48a804,0xbf55bf6dbf7bbf80
.quad 0x8000800080008000,0x8000800080008000,0x3f7b3f6d3f553f35,0x3e483ec43f0e3f35,0xbec4bf35bf6dbf80,0x3ec43f353f6d3f80,0xbf55bec43e483f35,0x3f0e3f6d3f7b3f35
.quad 0x3f353f803f35a630,0x3f353f803f35a677,0x3f0ebec4bf7bbf35,0x3f553f6d3e48bf35,0xbf6dbf353ec43f80,0x3f6d3f35bec4bf80,0xbe483f6d3f0ebf35,0x3f7b3ec4bf55bf35
.quad 0x3f80a7b1bf8026b0,0x3f80a7c2bf8026f7,0xbe48bf6d3f0e3f35,0x3f7bbec4bf553f35,0xbf6d3f353ec4bf80,0x3f6dbf35bec43f80,0x3f0e3ec4bf7b3f35,0x3f55bf6d3e483f35
.quad 0x3f35bf803f35a7c2,0x3f35bf803f35268d,0xbf553ec43e48bf35,0x3f0ebf6d3f7bbf35,0xbec43f35bf6d3f80,0x3ec4bf353f6dbf80,0x3f7bbf6d3f55bf35,0x3e48bec43f0ebf35
.quad 0xa7e52831268d2730,0xa804284221b72777,0xbf7b3f6dbf553f35,0xbe483ec4bf0e3f35,0x3ec4bf353f6dbf80,0xbec43f35bf6d3f80,0x3f55bec4be483f35,0xbf0e3f6dbf7b3f35
.quad 0xbf353f80bf35260e,0xbf353f80bf35a80d,0xbf0ebec43f7bbf35,0xbf553f6dbe48bf35,0x3f6dbf35bec43f80,0xbf6d3f353ec4bf80,0x3e483f6dbf0ebf35,0xbf7b3ec43f55bf35
.quad 0xbf80a60d3f802842,0xbf80a70d3f80a70d,0x3e48bf6dbf0e3f35,0xbf7bbec43f553f35,0x3f6d3f35bec4bf80,0xbf6dbf353ec43f80,0xbf0e3ec43f7b3f35,0xbf55bf6dbe483f35
.quad 0xbf35bf80bf35a80d,0xbf35bf80bf35a896,0x3f553ec4be48bf35,0xbf0ebf6dbf7bbf35,0x3ec43f353f6d3f80,0xbec4bf35bf6dbf80,0xbf7bbf6dbf55bf35,0xbe48bec4bf0ebf35
.quad 0x3f753f7b3f7f3f80,0x3f463f553f623f6d,0x3f223f553f753f80,0xbef1be483dc93ec4,0x3dc93f0e3f623f80,0xbf75bf7bbf46bec4,0xbef13e483f463f80,0x3dc9bf0ebf75bf6d
.quad 0xbf62be483f223f80,0x3f7f3f0ebe95bf6d,0xbf7fbf0e3ef13f80,0x3e953f7b3f22bec4,0xbf46bf553e953f80,0xbf623e483f7f3ec4,0xbe95bf7b3dc93f80,0xbf22bf553ef13f6d
.quad 0x3e95bf7bbdc93f80,0x3f22bf55bef13f6d,0x3f46bf55be953f80,0x3f623e48bf7f3ec4,0x3f7fbf0ebef13f80,0xbe953f7bbf22bec4,0x3f62be48bf223f80,0xbf7f3f0e3e95bf6d
.quad 0x3ef13e48bf463f80,0xbdc9bf0e3f75bf6d,0xbdc93f0ebf623f80,0x3f75bf7b3f46bec4,0xbf223f55bf753f80,0x3ef1be48bdc93ec4,0xbf753f7bbf7f3f80,0xbf463f55bf623f6d
.quad 0xbf753f7bbf7f3f80,0xbf463f55bf623f6d,0xbf223f55bf753f80,0x3ef1be48bdc93ec4,0xbdc93f0ebf623f80,0x3f75bf7b3f46bec4,0x3ef13e48bf463f80,0xbdc9bf0e3f75bf6d
.quad 0x3f62be48bf223f80,0xbf7f3f0e3e95bf6d,0x3f7fbf0ebef13f80,0xbe953f7bbf22bec4,0x3f46bf55be953f80,0x3f623e48bf7f3ec4,0x3e95bf7bbdc93f80,0x3f22bf55bef13f6d
.quad 0xbe95bf7b3dc93f80,0xbf22bf553ef13f6d,0xbf46bf553e953f80,0xbf623e483f7f3ec4,0xbf7fbf0e3ef13f80,0x3e953f7b3f22bec4,0xbf62be483f223f80,0x3f7f3f0ebe95bf6d
.quad 0xbef13e483f463f80,0x3dc9bf0ebf75bf6d,0x3dc93f0e3f623f80,0xbf75bf7bbf46bec4,0x3f223f553f753f80,0xbef1be483dc93ec4,0x3f753f7b3f7f3f80,0x3f463f553f623f6d
.quad 0x3ef13f0e3f223f35,0x3dc93e483e953ec4,0xbf7fbf7bbf62bf35,0xbe95bf0ebf46bf6d,0x3f223e48be95bf35,0x3ef13f553f7f3f6d,0x3e953f553f7f3f35,0xbf22bf7bbf62bec4
.quad 0xbf75bf55bdc93f35,0x3f463f7b3ef1bec4,0x3f46be48bf75bf35,0xbf62bf553dc93f6d,0x3dc93f7b3ef1bf35,0x3f753f0ebf22bf6d,0xbf62bf0e3f463f35,0xbf7fbe483f753ec4
.quad 0x3f62bf0ebf463f35,0x3f7fbe48bf753ec4,0xbdc93f7bbef1bf35,0xbf753f0e3f22bf6d,0xbf46be483f75bf35,0x3f62bf55bdc93f6d,0x3f75bf553dc93f35,0xbf463f7bbef1bec4
.quad 0xbe953f55bf7f3f35,0x3f22bf7b3f62bec4,0xbf223e483e95bf35,0xbef13f55bf7f3f6d,0x3f7fbf7b3f62bf35,0x3e95bf0e3f46bf6d,0xbef13f0ebf223f35,0xbdc93e48be953ec4
.quad 0xbef13f0ebf223f35,0xbdc93e48be953ec4,0x3f7fbf7b3f62bf35,0x3e95bf0e3f46bf6d,0xbf223e483e95bf35,0xbef13f55bf7f3f6d,0xbe953f55bf7f3f35,0x3f22bf7b3f62bec4
.quad 0x3f75bf553dc93f35,0xbf463f7bbef1bec4,0xbf46be483f75bf35,0x3f62bf55bdc93f6d,0xbdc93f7bbef1bf35,0xbf753f0e3f22bf6d,0x3f62bf0ebf463f35,0x3f7fbe48bf753ec4
.quad 0xbf62bf0e3f463f35,0xbf7fbe483f753ec4,0x3dc93f7b3ef1bf35,0x3f753f0ebf22bf6d,0x3f46be48bf75bf35,0xbf62bf553dc93f6d,0xbf75bf55bdc93f35,0x3f463f7b3ef1bec4
.quad 0x3e953f553f7f3f35,0xbf22bf7bbf62bec4,0x3f223e48be95bf35,0x3ef13f553f7f3f6d,0xbf7fbf7bbf62bf35,0xbe95bf0ebf46bf6d,0x3ef13f0e3f223f35,0x3dc93e483e953ec4
.quad 0xbe95be48bdc9248d,0xbf22bf0ebef1bec4,0x3f463f0e3e95a554,0x3f623f7b3f7f3f6d,0xbf7fbf55bef125b0,0x3e95be48bf22bf6d,0x3f623f7b3f22a5f7,0xbf7fbf55be953ec4
.quad 0xbef1bf7bbf46261f,0x3dc93f553f753ec4,0xbdc93f553f62a731,0x3f753e48bf46bf6d,0x3f22bf0ebf75a68d,0xbef1bf7bbdc93f6d,0xbf753e483f7fa742,0xbf463f0e3f62bec4
.quad 0x3f753e48bf7fa654,0x3f463f0ebf62bec4,0xbf22bf0e3f75a754,0x3ef1bf7b3dc93f6d,0x3dc93f55bf62a60d,0xbf753e483f46bf6d,0x3ef1bf7b3f46a765,0xbdc93f55bf753ec4
.quad 0xbf623f7bbf22a58e,0x3f7fbf553e953ec4,0x3f7fbf553ef1a777,0xbe95be483f22bf6d,0xbf463f0ebe95a137,0xbf623f7bbf7f3f6d,0x3e95be483dc9a784,0x3f22bf0e3ef1bec4
.quad 0x3e95be483dc9258d,0x3f22bf0e3ef1bec4,0xbf463f0ebe95a78d,0xbf623f7bbf7f3f6d,0x3f7fbf553ef1260d,0xbe95be483f22bf6d,0xbf623f7bbf22a796,0x3f7fbf553e953ec4
.quad 0x3ef1bf7b3f46280d,0xbdc93f55bf753ec4,0x3dc93f55bf62a79f,0xbf753e483f46bf6d,0xbf22bf0e3f75268d,0x3ef1bf7b3dc93f6d,0x3f753e48bf7f2731,0x3f463f0ebf62bec4
.quad 0xbf753e483f7f2816,0xbf463f0e3f62bec4,0x3f22bf0ebf75a7b1,0xbef1bf7bbdc93f6d,0xbdc93f553f6226d4,0x3f753e48bf46bf6d,0xbef1bf7bbf46270d,0x3dc93f553f753ec4
.quad 0x3f623f7b3f22281f,0xbf7fbf55be953ec4,0xbf7fbf55bef1a7c2,0x3e95be48bf22bf6d,0x3f463f0e3e95270d,0x3f623f7b3f7f3f6d,0xbe95be48bdc926d4,0xbf22bf0ebef1bec4
.quad 0xbf62bf55bf46bf35,0xbf7fbf7bbf75bf6d,0xbdc93e483ef13f35,0xbf75bf55bf22bec4,0x3f463f7b3f753f35,0xbf62bf0ebdc93ec4,0x3f753f0ebdc9bf35,0xbf46be483ef13f6d
.quad 0x3e95bf0ebf7fbf35,0xbf223e483f623f6d,0xbf22bf7bbe953f35,0xbef13f0e3f7f3ec4,0xbf7fbe483f623f35,0xbe953f553f46bec4,0xbef13f553f22bf35,0xbdc93f7b3e95bf6d
.quad 0x3ef13f55bf22bf35,0x3dc93f7bbe95bf6d,0x3f7fbe48bf623f35,0x3e953f55bf46bec4,0x3f22bf7b3e953f35,0x3ef13f0ebf7f3ec4,0xbe95bf0e3f7fbf35,0x3f223e48bf623f6d
.quad 0xbf753f0e3dc9bf35,0x3f46be48bef13f6d,0xbf463f7bbf753f35,0x3f62bf0e3dc93ec4,0x3dc93e48bef13f35,0x3f75bf553f22bec4,0x3f62bf553f46bf35,0x3f7fbf7b3f75bf6d
.quad 0x3f62bf553f46bf35,0x3f7fbf7b3f75bf6d,0x3dc93e48bef13f35,0x3f75bf553f22bec4,0xbf463f7bbf753f35,0x3f62bf0e3dc93ec4,0xbf753f0e3dc9bf35,0x3f46be48bef13f6d
.quad 0xbe95bf0e3f7fbf35,0x3f223e48bf623f6d,0x3f22bf7b3e953f35,0x3ef13f0ebf7f3ec4,0x3f7fbe48bf623f35,0x3e953f55bf46bec4,0x3ef13f55bf22bf35,0x3dc93f7bbe95bf6d
.quad 0xbef13f553f22bf35,0xbdc93f7b3e95bf6d,0xbf7fbe483f623f35,0xbe953f553f46bec4,0xbf22bf7bbe953f35,0xbef13f0e3f7f3ec4,0x3e95bf0ebf7fbf35,0xbf223e483f623f6d
.quad 0x3f753f0ebdc9bf35,0xbf46be483ef13f6d,0x3f463f7b3f753f35,0xbf62bf0ebdc93ec4,0xbdc93e483ef13f35,0xbf75bf55bf22bec4,0xbf62bf55bf46bf35,0xbf7fbf7bbf75bf6d
.quad 0xbe95be48bdc98000,0xbf22bf0ebef1bec4,0xbf46bf0ebe958000,0xbf62bf7bbf7fbf6d,0xbf7fbf55bef18000,0x3e95be48bf22bf6d,0xbf62bf7bbf228000,0x3f7f3f553e95bec4
.quad 0xbef1bf7bbf468000,0x3dc93f553f753ec4,0x3dc9bf55bf628000,0xbf75be483f463f6d,0x3f22bf0ebf758000,0xbef1bf7bbdc93f6d,0x3f75be48bf7f8000,0x3f46bf0ebf623ec4
.quad 0x3f753e48bf7f8000,0x3f463f0ebf62bec4,0x3f223f0ebf758000,0xbef13f7bbdc9bf6d,0x3dc93f55bf628000,0xbf753e483f46bf6d,0xbef13f7bbf468000,0x3dc9bf553f75bec4
.quad 0xbf623f7bbf228000,0x3f7fbf553e953ec4,0xbf7f3f55bef18000,0x3e953e48bf223f6d,0xbf463f0ebe958000,0xbf623f7bbf7f3f6d,0xbe953e48bdc98000,0xbf223f0ebef13ec4
.quad 0x3e95be483dc98000,0x3f22bf0e3ef1bec4,0x3f46bf0e3e958000,0x3f62bf7b3f7fbf6d,0x3f7fbf553ef18000,0xbe95be483f22bf6d,0x3f62bf7b3f228000,0xbf7f3f55be95bec4
.quad 0x3ef1bf7b3f468000,0xbdc93f55bf753ec4,0xbdc9bf553f628000,0x3f75be48bf463f6d,0xbf22bf0e3f758000,0x3ef1bf7b3dc93f6d,0xbf75be483f7f8000,0xbf46bf0e3f623ec4
.quad 0xbf753e483f7f8000,0xbf463f0e3f62bec4,0xbf223f0e3f758000,0x3ef13f7b3dc9bf6d,0xbdc93f553f628000,0x3f753e48bf46bf6d,0x3ef13f7b3f468000,0xbdc9bf55bf75bec4
.quad 0x3f623f7b3f228000,0xbf7fbf55be953ec4,0x3f7f3f553ef18000,0xbe953e483f223f6d,0x3f463f0e3e958000,0x3f623f7b3f7f3f6d,0x3e953e483dc98000,0x3f223f0e3ef13ec4
.quad 0xbf62bf55bf46bf35,0xbf7fbf7bbf75bf6d,0x3dc9be48bef1bf35,0x3f753f553f223ec4,0x3f463f7b3f753f35,0xbf62bf0ebdc93ec4,0xbf75bf0e3dc93f35,0x3f463e48bef1bf6d
.quad 0x3e95bf0ebf7fbf35,0xbf223e483f623f6d,0x3f223f7b3e95bf35,0x3ef1bf0ebf7fbec4,0xbf7fbe483f623f35,0xbe953f553f46bec4,0x3ef1bf55bf223f35,0x3dc9bf7bbe953f6d
.quad 0x3ef13f55bf22bf35,0x3dc93f7bbe95bf6d,0xbf7f3e483f62bf35,0xbe95bf553f463ec4,0x3f22bf7b3e953f35,0x3ef13f0ebf7f3ec4,0x3e953f0ebf7f3f35,0xbf22be483f62bf6d
.quad 0xbf753f0e3dc9bf35,0x3f46be48bef13f6d,0x3f46bf7b3f75bf35,0xbf623f0ebdc9bec4,0x3dc93e48bef13f35,0x3f75bf553f22bec4,0xbf623f55bf463f35,0xbf7f3f7bbf753f6d
.quad 0x3f62bf553f46bf35,0x3f7fbf7b3f75bf6d,0xbdc9be483ef1bf35,0xbf753f55bf223ec4,0xbf463f7bbf753f35,0x3f62bf0e3dc93ec4,0x3f75bf0ebdc93f35,0xbf463e483ef1bf6d
.quad 0xbe95bf0e3f7fbf35,0x3f223e48bf623f6d,0xbf223f7bbe95bf35,0xbef1bf0e3f7fbec4,0x3f7fbe48bf623f35,0x3e953f55bf46bec4,0xbef1bf553f223f35,0xbdc9bf7b3e953f6d
.quad 0xbef13f553f22bf35,0xbdc93f7b3e95bf6d,0x3f7f3e48bf62bf35,0x3e95bf55bf463ec4,0xbf22bf7bbe953f35,0xbef13f0e3f7f3ec4,0xbe953f0e3f7f3f35,0x3f22be48bf62bf6d
.quad 0x3f753f0ebdc9bf35,0xbf46be483ef13f6d,0xbf46bf7bbf75bf35,0x3f623f0e3dc9bec4,0xbdc93e483ef13f35,0xbf75bf55bf22bec4,0x3f623f553f463f35,0x3f7f3f7b3f753f6d
.quad 0xbf75bf7bbf7fbf80,0xbf46bf55bf62bf6d,0x3f223f553f753f80,0xbef1be483dc93ec4,0xbdc9bf0ebf62bf80,0x3f753f7b3f463ec4,0xbef13e483f463f80,0x3dc9bf0ebf75bf6d
.quad 0x3f623e48bf22bf80,0xbf7fbf0e3e953f6d,0xbf7fbf0e3ef13f80,0x3e953f7b3f22bec4,0x3f463f55be95bf80,0x3f62be48bf7fbec4,0xbe95bf7b3dc93f80,0xbf22bf553ef13f6d
.quad 0xbe953f7b3dc9bf80,0xbf223f553ef1bf6d,0x3f46bf55be953f80,0x3f623e48bf7f3ec4,0xbf7f3f0e3ef1bf80,0x3e95bf7b3f223ec4,0x3f62be48bf223f80,0xbf7f3f0e3e95bf6d
.quad 0xbef1be483f46bf80,0x3dc93f0ebf753f6d,0xbdc93f0ebf623f80,0x3f75bf7b3f46bec4,0x3f22bf553f75bf80,0xbef13e483dc9bec4,0xbf753f7bbf7f3f80,0xbf463f55bf623f6d
.quad 0x3f75bf7b3f7fbf80,0x3f46bf553f62bf6d,0xbf223f55bf753f80,0x3ef1be48bdc93ec4,0x3dc9bf0e3f62bf80,0xbf753f7bbf463ec4,0x3ef13e48bf463f80,0xbdc9bf0e3f75bf6d
.quad 0xbf623e483f22bf80,0x3f7fbf0ebe953f6d,0x3f7fbf0ebef13f80,0xbe953f7bbf22bec4,0xbf463f553e95bf80,0xbf62be483f7fbec4,0x3e95bf7bbdc93f80,0x3f22bf55bef13f6d
.quad 0x3e953f7bbdc9bf80,0x3f223f55bef1bf6d,0xbf46bf553e953f80,0xbf623e483f7f3ec4,0x3f7f3f0ebef1bf80,0xbe95bf7bbf223ec4,0xbf62be483f223f80,0x3f7f3f0ebe95bf6d
.quad 0x3ef1be48bf46bf80,0xbdc93f0e3f753f6d,0x3dc93f0e3f623f80,0xbf75bf7bbf46bec4,0xbf22bf55bf75bf80,0x3ef13e48bdc9bec4,0x3f753f7b3f7f3f80,0x3f463f553f623f6d
.quad 0xbef1bf0ebf22bf35,0xbdc9be48be95bec4,0xbf7fbf7bbf62bf35,0xbe95bf0ebf46bf6d,0xbf22be483e953f35,0xbef1bf55bf7fbf6d,0x3e953f553f7f3f35,0xbf22bf7bbf62bec4
.quad 0x3f753f553dc9bf35,0xbf46bf7bbef13ec4,0x3f46be48bf75bf35,0xbf62bf553dc93f6d,0xbdc9bf7bbef13f35,0xbf75bf0e3f223f6d,0xbf62bf0e3f463f35,0xbf7fbe483f753ec4
.quad 0xbf623f0e3f46bf35,0xbf7f3e483f75bec4,0xbdc93f7bbef1bf35,0xbf753f0e3f22bf6d,0x3f463e48bf753f35,0xbf623f553dc9bf6d,0x3f75bf553dc93f35,0xbf463f7bbef1bec4
.quad 0x3e95bf553f7fbf35,0xbf223f7bbf623ec4,0xbf223e483e95bf35,0xbef13f55bf7f3f6d,0xbf7f3f7bbf623f35,0xbe953f0ebf463f6d,0xbef13f0ebf223f35,0xbdc93e48be953ec4
.quad 0x3ef1bf0e3f22bf35,0x3dc9be483e95bec4,0x3f7fbf7b3f62bf35,0x3e95bf0e3f46bf6d,0x3f22be48be953f35,0x3ef1bf553f7fbf6d,0xbe953f55bf7f3f35,0x3f22bf7b3f62bec4
.quad 0xbf753f55bdc9bf35,0x3f46bf7b3ef13ec4,0xbf46be483f75bf35,0x3f62bf55bdc93f6d,0x3dc9bf7b3ef13f35,0x3f75bf0ebf223f6d,0x3f62bf0ebf463f35,0x3f7fbe48bf753ec4
.quad 0x3f623f0ebf46bf35,0x3f7f3e48bf75bec4,0x3dc93f7b3ef1bf35,0x3f753f0ebf22bf6d,0xbf463e483f753f35,0x3f623f55bdc9bf6d,0xbf75bf55bdc93f35,0x3f463f7b3ef1bec4
.quad 0xbe95bf55bf7fbf35,0x3f223f7b3f623ec4,0x3f223e48be95bf35,0x3ef13f553f7f3f6d,0x3f7f3f7b3f623f35,0x3e953f0e3f463f6d,0x3ef13f0e3f223f35,0x3dc93e483e953ec4
.quad 0x3e953e483dc90000,0x3f223f0e3ef13ec4,0x3f463f0e3e950000,0x3f623f7b3f7f3f6d,0x3f7f3f553ef10000,0xbe953e483f223f6d,0x3f623f7b3f220000,0xbf7fbf55be953ec4
.quad 0x3ef13f7b3f460000,0xbdc9bf55bf75bec4,0xbdc93f553f620000,0x3f753e48bf46bf6d,0xbf223f0e3f750000,0x3ef13f7b3dc9bf6d,0xbf753e483f7f0000,0xbf463f0e3f62bec4
.quad 0xbf75be483f7f0000,0xbf46bf0e3f623ec4,0xbf22bf0e3f750000,0x3ef1bf7b3dc93f6d,0xbdc9bf553f620000,0x3f75be48bf463f6d,0x3ef1bf7b3f460000,0xbdc93f55bf753ec4
.quad 0x3f62bf7b3f220000,0xbf7f3f55be95bec4,0x3f7fbf553ef10000,0xbe95be483f22bf6d,0x3f46bf0e3e950000,0x3f62bf7b3f7fbf6d,0x3e95be483dc90000,0x3f22bf0e3ef1bec4
.quad 0xbe953e48bdc90000,0xbf223f0ebef13ec4,0xbf463f0ebe950000,0xbf623f7bbf7f3f6d,0xbf7f3f55bef10000,0x3e953e48bf223f6d,0xbf623f7bbf220000,0x3f7fbf553e953ec4
.quad 0xbef13f7bbf460000,0x3dc9bf553f75bec4,0x3dc93f55bf620000,0xbf753e483f46bf6d,0x3f223f0ebf750000,0xbef13f7bbdc9bf6d,0x3f753e48bf7f0000,0x3f463f0ebf62bec4
.quad 0x3f75be48bf7f0000,0x3f46bf0ebf623ec4,0x3f22bf0ebf750000,0xbef1bf7bbdc93f6d,0x3dc9bf55bf620000,0xbf75be483f463f6d,0xbef1bf7bbf460000,0x3dc93f553f753ec4
.quad 0xbf62bf7bbf220000,0x3f7f3f553e95bec4,0xbf7fbf55bef10000,0x3e95be48bf22bf6d,0xbf46bf0ebe950000,0xbf62bf7bbf7fbf6d,0xbe95be48bdc90000,0xbf22bf0ebef1bec4
.quad 0x3f623f553f463f35,0x3f7f3f7b3f753f6d,0xbdc93e483ef13f35,0xbf75bf55bf22bec4,0xbf46bf7bbf75bf35,0x3f623f0e3dc9bec4,0x3f753f0ebdc9bf35,0xbf46be483ef13f6d
.quad 0xbe953f0e3f7f3f35,0x3f22be48bf62bf6d,0xbf22bf7bbe953f35,0xbef13f0e3f7f3ec4,0x3f7f3e48bf62bf35,0x3e95bf55bf463ec4,0xbef13f553f22bf35,0xbdc93f7b3e95bf6d
.quad 0xbef1bf553f223f35,0xbdc9bf7b3e953f6d,0x3f7fbe48bf623f35,0x3e953f55bf46bec4,0xbf223f7bbe95bf35,0xbef1bf0e3f7fbec4,0xbe95bf0e3f7fbf35,0x3f223e48bf623f6d
.quad 0x3f75bf0ebdc93f35,0xbf463e483ef1bf6d,0xbf463f7bbf753f35,0x3f62bf0e3dc93ec4,0xbdc9be483ef1bf35,0xbf753f55bf223ec4,0x3f62bf553f46bf35,0x3f7fbf7b3f75bf6d
.quad 0xbf623f55bf463f35,0xbf7f3f7bbf753f6d,0x3dc93e48bef13f35,0x3f75bf553f22bec4,0x3f46bf7b3f75bf35,0xbf623f0ebdc9bec4,0xbf753f0e3dc9bf35,0x3f46be48bef13f6d
.quad 0x3e953f0ebf7f3f35,0xbf22be483f62bf6d,0x3f22bf7b3e953f35,0x3ef13f0ebf7f3ec4,0xbf7f3e483f62bf35,0xbe95bf553f463ec4,0x3ef13f55bf22bf35,0x3dc93f7bbe95bf6d
.quad 0x3ef1bf55bf223f35,0x3dc9bf7bbe953f6d,0xbf7fbe483f623f35,0xbe953f553f46bec4,0x3f223f7b3e95bf35,0x3ef1bf0ebf7fbec4,0x3e95bf0ebf7fbf35,0xbf223e483f623f6d
.quad 0xbf75bf0e3dc93f35,0x3f463e48bef1bf6d,0x3f463f7b3f753f35,0xbf62bf0ebdc93ec4,0x3dc9be48bef1bf35,0x3f753f553f223ec4,0xbf62bf55bf46bf35,0xbf7fbf7bbf75bf6d
.quad 0x3f753f7b3f7f3f80,0x3f463f553f623f6d,0xbf22bf55bf75bf80,0x3ef13e48bdc9bec4,0x3dc93f0e3f623f80,0xbf75bf7bbf46bec4,0x3ef1be48bf46bf80,0xbdc93f0e3f753f6d
.quad 0xbf62be483f223f80,0x3f7f3f0ebe95bf6d,0x3f7f3f0ebef1bf80,0xbe95bf7bbf223ec4,0xbf46bf553e953f80,0xbf623e483f7f3ec4,0x3e953f7bbdc9bf80,0x3f223f55bef1bf6d
.quad 0x3e95bf7bbdc93f80,0x3f22bf55bef13f6d,0xbf463f553e95bf80,0xbf62be483f7fbec4,0x3f7fbf0ebef13f80,0xbe953f7bbf22bec4,0xbf623e483f22bf80,0x3f7fbf0ebe953f6d
.quad 0x3ef13e48bf463f80,0xbdc9bf0e3f75bf6d,0x3dc9bf0e3f62bf80,0xbf753f7bbf463ec4,0xbf223f55bf753f80,0x3ef1be48bdc93ec4,0x3f75bf7b3f7fbf80,0x3f46bf553f62bf6d
.quad 0xbf753f7bbf7f3f80,0xbf463f55bf623f6d,0x3f22bf553f75bf80,0xbef13e483dc9bec4,0xbdc93f0ebf623f80,0x3f75bf7b3f46bec4,0xbef1be483f46bf80,0x3dc93f0ebf753f6d
.quad 0x3f62be48bf223f80,0xbf7f3f0e3e95bf6d,0xbf7f3f0e3ef1bf80,0x3e95bf7b3f223ec4,0x3f46bf55be953f80,0x3f623e48bf7f3ec4,0xbe953f7b3dc9bf80,0xbf223f553ef1bf6d
.quad 0xbe95bf7b3dc93f80,0xbf22bf553ef13f6d,0x3f463f55be95bf80,0x3f62be48bf7fbec4,0xbf7fbf0e3ef13f80,0x3e953f7b3f22bec4,0x3f623e48bf22bf80,0xbf7fbf0e3e953f6d
.quad 0xbef13e483f463f80,0x3dc9bf0ebf75bf6d,0xbdc9bf0ebf62bf80,0x3f753f7b3f463ec4,0x3f223f553f753f80,0xbef1be483dc93ec4,0xbf75bf7bbf7fbf80,0xbf46bf55bf62bf6d
.quad 0x3ef13f0e3f223f35,0x3dc93e483e953ec4,0x3f7f3f7b3f623f35,0x3e953f0e3f463f6d,0x3f223e48be95bf35,0x3ef13f553f7f3f6d,0xbe95bf55bf7fbf35,0x3f223f7b3f623ec4
.quad 0xbf75bf55bdc93f35,0x3f463f7b3ef1bec4,0xbf463e483f753f35,0x3f623f55bdc9bf6d,0x3dc93f7b3ef1bf35,0x3f753f0ebf22bf6d,0x3f623f0ebf46bf35,0x3f7f3e48bf75bec4
.quad 0x3f62bf0ebf463f35,0x3f7fbe48bf753ec4,0x3dc9bf7b3ef13f35,0x3f75bf0ebf223f6d,0xbf46be483f75bf35,0x3f62bf55bdc93f6d,0xbf753f55bdc9bf35,0x3f46bf7b3ef13ec4
.quad 0xbe953f55bf7f3f35,0x3f22bf7b3f62bec4,0x3f22be48be953f35,0x3ef1bf553f7fbf6d,0x3f7fbf7b3f62bf35,0x3e95bf0e3f46bf6d,0x3ef1bf0e3f22bf35,0x3dc9be483e95bec4
.quad 0xbef13f0ebf223f35,0xbdc93e48be953ec4,0xbf7f3f7bbf623f35,0xbe953f0ebf463f6d,0xbf223e483e95bf35,0xbef13f55bf7f3f6d,0x3e95bf553f7fbf35,0xbf223f7bbf623ec4
.quad 0x3f75bf553dc93f35,0xbf463f7bbef1bec4,0x3f463e48bf753f35,0xbf623f553dc9bf6d,0xbdc93f7bbef1bf35,0xbf753f0e3f22bf6d,0xbf623f0e3f46bf35,0xbf7f3e483f75bec4
.quad 0xbf62bf0e3f463f35,0xbf7fbe483f753ec4,0xbdc9bf7bbef13f35,0xbf75bf0e3f223f6d,0x3f46be48bf75bf35,0xbf62bf553dc93f6d,0x3f753f553dc9bf35,0xbf46bf7bbef13ec4
.quad 0x3e953f553f7f3f35,0xbf22bf7bbf62bec4,0xbf22be483e953f35,0xbef1bf55bf7fbf6d,0xbf7fbf7bbf62bf35,0xbe95bf0ebf46bf6d,0xbef1bf0ebf22bf35,0xbdc9be48be95bec4
.quad 0x3f7fffb13f800000,0x3f7ffd393f7ffec4,0x3f7ffd393f800000,0x3f7fe7053f7ff4e6,0x3f7ff84a3f800000,0x3f7fba9e3f7fe129,0x3f7ff0e33f800000,0x3f7f78083f7fc38f
.quad 0x3f7fe7053f800000,0x3f7f1f493f7f9c18,0x3f7fdaaf3f800000,0x3f7eb0693f7f6ac7,0x3f7fcbe23f800000,0x3f7e2b723f7f2f9d,0x3f7fba9e3f800000,0x3f7d906e3f7eea9d
.quad 0x3f7fa6e33f800000,0x3f7cdf6c3f7e9bc9,0x3f7f90b13f800000,0x3f7c187a3f7e4323,0x3f7f78083f800000,0x3f7b3bab3f7de0b1,0x3f7f5ce93f800000,0x3f7a49103f7d7474
.quad 0x3f7f3f543f800000,0x3f7940c03f7cfe73,0x3f7f1f493f800000,0x3f7822d13f7c7eb0,0x3f7efcc93f800000,0x3f76ef5b3f7bf531,0x3f7ed7d43f800000,0x3f75a67b3f7b61fc
.quad 0x3f7eb0693f800000,0x3f74484b3f7ac516,0x3f7e868b3f800000,0x3f72d4eb3f7a1e84,0x3f7e5a383f800000,0x3f714c7a3f796e4e,0x3f7e2b723f800000,0x3f6faf1b3f78b47b
.quad 0x3f7dfa383f800000,0x3f6dfcf23f77f110,0x3f7dc68c3f800000,0x3f6c36243f772417,0x3f7d906e3f800000,0x3f6a5ad93f764d97,0x3f7d57de3f800000,0x3f686b393f756d97
.quad 0x3f7d1cdd3f800000,0x3f6667713f748422,0x3f7cdf6c3f800000,0x3f644fac3f73913f,0x3f7c9f8a3f800000,0x3f62241a3f7294f8,0x3f7c5d3a3f800000,0x3f5fe4e93f718f57
.quad 0x3f7c187a3f800000,0x3f5d924d3f708066,0x3f7bd14d3f800000,0x3f5b2c793f6f6830,0x3f7b87b23f800000,0x3f58b3a13f6e46be,0x3f7b3bab3f800000,0x3f5627fe3f6d1c1d
.quad 0x3f7ff84a3f7ffb11,0x3f7ff0e33f7ff4e6,0x3f7fba9e3f7fd397,0x3f7f78083f7f9c18,0x3f7f3f543f7f84ab,0x3f7e868b3f7eea9d,0x3f7e868b3f7f0e58,0x3f7d1cdd3f7de0b1
.quad 0x3f7d906e3f7e70b0,0x3f7b3bab3f7c7eb0,0x3f7c5d3a3f7dabcc,0x3f78e3d63f7ac516,0x3f7aed373f7cbfc9,0x3f76167a3f78b47b,0x3f7940c03f7baccd,0x3f72d4eb3f764d97
.quad 0x3f77583a3f7a7302,0x3f6f20b03f73913f,0x3f75341d3f791298,0x3f6afb8c3f708066,0x3f72d4eb3f778bc5,0x3f6667713f6d1c1d,0x3f703b373f75dec6,0x3f61668a3f696591
.quad 0x3f6d67a13f740bdd,0x3f5bfb343f655e0b,0x3f6a5ad93f721352,0x3f5627fe3f6106f2,0x3f6715993f6ff573,0x3f4fefa83f5c61c7,0x3f6398ac3f6db293,0x3f4955213f577026
.quad 0x3f5fe4e93f6b4b0c,0x3f425b893f5233c6,0x3f5bfb343f68bf3c,0x3f3b06293f4cae79,0x3f57dc7f3f660f88,0x3f33587a3f46e22a,0x3f5389c73f633c5a,0x3f2b561b3f40d0da
.quad 0x3f4f04173f604621,0x3f2302d33f3a7ca4,0x3f4a4c873f5d2d53,0x3f1a62933f33e7bc,0x3f4564393f59f26a,0x3f11796b3f2d1469,0x3f404c5c3f5695e5,0x3f084b923f26050a
.quad 0x3f3b06293f531849,0x3efdbabb3f1ebc12,0x3f3592e73f4f7a1f,0x3eea66813f173c07,0x3f2ff3e63f4bbbf8,0x3ed6a3993f0f8784,0x3f2a2a803f47de65,0x3ec27b553f07a136
.quad 0x3f24381a3f43e200,0x3eadf73c3eff17b2,0x3f1e1e223f3fc767,0x3e9920fe3eee9479,0x3f17de123f3b8f3b,0x3e8402703eddbe79,0x3f11796b3f373a23,0x3e5d4b1a3ecc9b8b
.quad 0x3f7fe7053f7fec43,0x3f7fdaaf3f7fe129,0x3f7f1f493f7f4e6d,0x3f7eb0693f7eea9d,0x3f7d906e3f7e1324,0x3f7c5d3a3f7cfe73,0x3f7b3bab3f7c3b28,0x3f78e3d63f7a1e84
.quad 0x3f7822d13f79c79d,0x3f74484b3f764d97,0x3f74484b3f76ba07,0x3f6e8ff83f718f57,0x3f6faf1b3f731447,0x3f67c1873f6be858,0x3f6a5ad93f6ed89e,0x3f5fe4e93f655e0b
.quad 0x3f644fac3f6a09a7,0x3f5703483f5df6be,0x3f5d924d3f64aa59,0x3f4d26fd3f55b993,0x3f5627fe3f5ebe05,0x3f425b893f4cae79,0x3f4e16893f584853,0x3f36ad7f3f42de29
.quad 0x3f4564393f514d3d,0x3f2a2a803f385216,0x3f3c17d93f49d112,0x3f1ce11f3f2d1469,0x3f3238aa3f41d870,0x3f0ee0db3f212ff9,0x3f27ce613f396842,0x3f003a063f14b039
.quad 0x3f1ce11f3f3085bb,0x3ee1fb6a3f07a136,0x3f11796b3f273656,0x3ec27b553ef41f07,0x3f05a02c3f1d7fd1,0x3ea218873ed8106b,0x3ef2bd433f13682a,0x3e80f8c03ebb31a0
.quad 0x3ed97cb93f08f59b,0x3e3e853e3e9d9e78,0x3ebf926f3efc5d27,0x3df475c03e7ee6e1,0x3ea5129f3ee63375,0x3d55880e3e419b37,0x3e8a11f73ecf7bca,0xbc7b514b3e039502
.quad 0x3e5d4b1a3eb8442a,0xbda973ba3d8a200a,0x3e25c58c3ea09ae5,0xbe195be03bc90f88,0x3ddb7d373e888e93,0xbe5d4b1abd621469,0x3d55880e3e605c13,0xbe901c2cbdee3876
.quad 0xbb490fc63e2f10a2,0xbeb0eacbbe354098,0xbd6ea0383dfab273,0xbed0eb2abe72b651,0xbde7fa9a3d96a905,0xbeeff7fbbe97a117,0xbe2bf8043cc90ab0,0xbf06f686beb554ec
.quad 0x3f7fcbe23f7fd397,0x3f7fba9e3f7fc38f,0x3f7e2b723f7e70b0,0x3f7d906e3f7de0b1,0x3f7aed373f7baccd,0x3f7940c03f7a1e84,0x3f76167a3f778bc5,0x3f72d4eb3f748422
.quad 0x3f6faf1b3f721352,0x3f6a5ad93f6d1c1d,0x3f67c1873f6b4b0c,0x3f5fe4e93f63f473,0x3f5e5aa63f633c5a,0x3f5389c73f591e6a,0x3f5389c73f59f26a,0x3f4564393f4cae79
.quad 0x3f4760853f4f7a1f,0x3f3592e73f3ebc1b,0x3f39f2ac3f43e200,0x3f24381a3f2f61a5,0x3f2b561b3f373a23,0x3f11796b3f1ebc12,0x3f1ba2993f299415,0x3efafef73f0cead0
.quad 0x3f0af1b73f1b02c6,0x3ed0eb2a3ef41f07,0x3ef2bd433f0b9a6b,0x3ea5129f3ecc9b8b,0x3ece0bea3ef6e0cb,0x3e6fa8b23ea395c5,0x3ea80b1f3ed53641,0x3e1324ca3e72b651
.quad 0x3e80f8c03eb263ef,0x3d55880e3e1c76de,0x3e3228d43e8e9a22,0xbd2351cb3d8a200a,0x3dc27c393e541501,0xbe06b26ebc96c9b6,0x3c7b514b3e09cf86,0xbe636c83bdd53db9
.quad 0xbd83db0a3d7b2b74,0xbe9f1cdfbe419b37,0xbe1324cabc490e90,0xbecb2aaebe8b9507,0xbe636c83bdafb680,0xbef58035beb554ec,0xbe9920febe22abb6,0xbf0ee0dbbeddbe79
.quad 0xbebf926fbe6c9a7f,0xbf21cbfbbf0242b1,0xbee4cbfebe9aa086,0xbf33587abf14b039,0xbf044889bebe1d4a,0xbf436051bf26050a,0xbf1553b7bee0924f,0xbf51c0c2bf36206c
.quad 0xbf256bcbbf00e7e4,0xbf5e5aa6bf44e3f5,0xbf34768fbf10d3cd,0xbf6912aebf5233c6,0xbf425b89bf1ff6cb,0xbf71d19fbf5df6be,0xbf4f0417bf2e3bde,0xbf788486bf6816a8
.quad 0x3f7fa6e33f7fb10f,0x3f7f90b13f7f9c18,0x3f7cdf6c3f7d3aac,0x3f7c187a3f7c7eb0,0x3f77583a3f7853f8,0x3f75341d3f764d97,0x3f6f20b03f710908,0x3f6afb8c3f6d1c1d
.quad 0x3f644fac3f676bd8,0x3f5d924d3f6106f2,0x3f5703483f5b941a,0x3f4d26fd3f5233c6,0x3f4760853f4d9f02,0x3f39f2ac3f40d0da,0x3f3592e73f3daef9,0x3f24381a3f2d1469
.quad 0x3f21cbfb3f2beb4a,0x3f0c42c93f173c07,0x3f0c42c93f187fc0,0x3ee4cbfe3eff17b2,0x3eea66813f039c3d,0x3eadf73c3ecc9b8b,0x3eb9bb1e3edae880,0x3e698bba3e97a117
.quad 0x3e870ada3eac7cd4,0x3de7fa9a3e419b37,0x3e25c58c3e78cfcc,0xbb490fc63da3308c,0x3d6ea0383e164083,0xbdf475c0bcfb49ba,0xbd3c6dd53d48fb30,0xbe6fa8b2be1008b7
.quad 0xbe195be0bd48fb30,0xbeb0eacbbe7ee6e1,0xbe80f8c0be164083,0xbee79a5dbeb554ec,0xbeb3dca5be78cfcc,0xbf0d9281bee900b7,0xbee4cbfebeac7cd4,0xbf256bcbbf0cead0
.quad 0xbf099f4ebedae880,0xbf3b0629bf239da9,0xbf1f599fbf039c3d,0xbf4e1689bf385216,0xbf33587abf187fc0,0xbf5e5aa6bf4ac77f,0xbf456439bf2beb4a,0xbf6b99fbbf5ac450
.quad 0xbf554aa4bf3daef9,0xbf75a67bbf6816a8,0xbf62df7bbf4d9f02,0xbf7c5d3abf7294f8,0xbf6dfcf2bf5b941a,0xbf7fa6e3bf7a1e84,0xbf76841bbf676bd8,0xbf7f7808bf7e9bc9
.quad 0xbf7c5d3abf710908,0xbf7bd14dbf7ffec4,0xbf7f7808bf7853f8,0xbf74bf62bf7e4323,0xbf7fcbe2bf7d3aac,0xbf6a5ad9bf796e4e,0xbf7d57debf7fb10f,0xbf5cc7d1bf718f57
.quad 0x3f7f78083f7f84ab,0x3f7f5ce93f7f6ac7,0x3f7b3bab3f7baccd,0x3f7a49103f7ac516,0x3f72d4eb3f740bdd,0x3f703b373f718f57,0x3f6667713f68bf3c,0x3f61668a3f63f473
.quad 0x3f5627fe3f59f26a,0x3f4e16893f5233c6,0x3f425b893f47de65,0x3f36ad7f3f3ca003,0x3f2b561b3f32c8c9,0x3f1ba2993f239da9,0x3f11796b3f1b02c6,0x3efafef73f07a136
.quad 0x3eea66813f00e7e4,0x3eb9bb1e3ed25a09,0x3eadf73c3ec9b953,0x3e698bba3e919ddd,0x3e5d4b1a3e8e9a22,0x3db5f8da3e1c76de,0x3db5f8da3e22abb6,0xbd55880e3c96c9b6
.quad 0xbd2351cb3d16c32c,0xbe44b0b9bdee3876,0xbe2bf804bdafb680,0xbea80b1fbe7ee6e1,0xbe9620d2be541501,0xbeea6681bec1071e,0xbed3c867bea68f12,0xbf140c5fbeff17b2
.quad 0xbf06f686bee0924f,0xbf2ff3e6bf1c420c,0xbf21cbfbbf0b9a6b,0xbf485bcabf36206c,0xbf39f2acbf24d225,0xbf5cc7d1bf4cae79,0xbf4f0417bf3b8f3b,0xbf6cd007bf5f8327
.quad 0xbf60a6cfbf4f7a1f,0xbf7822d1bf6e46be,0xbf6e8ff8bf604621,0xbf7e868bbf78b47b,0xbf788486bf6db293,0xbf7fdaafbf7e9bc9,0xbf7e5a38bf778bc5,0xbf7c187abf7fe129
.quad 0xbf7ff84abf7dabcc,0xbf73530ebf7c7eb0,0xbf7d57debf7ffb11,0xbf65b710bf748422,0xbf76841bbf7e70b0,0xbf5389c7bf6816a8,0xbf6b99fbbf791298,0xbf3d27b8bf577026
.quad 0xbf5cc7d1bf6ff573,0xbf2302d3bf42de29,0xbf4a4c87bf633c5a,0xbf05a02cbf2ac082,0xbf34768fbf531849,0xbecb2aaebf0f8784,0xbf1ba299bf3fc767,0xbe870adabee363fa
.quad 0x3f7f3f543f7f4e6d,0x3f7f1f493f7f2f9d,0x3f7940c03f79c79d,0x3f7822d13f78b47b,0x3f6d67a13f6ed89e,0x3f6a5ad93f6be858,0x3f5bfb343f5ebe05,0x3f5627fe3f591e6a
.quad 0x3f4564393f49d112,0x3f3c17d93f40d0da,0x3f2a2a803f3085bb,0x3f1ce11f3f239da9,0x3f0af1b73f13682a,0x3ef2bd433f0242b1,0x3ed0eb2a3ee63375,0x3ea5129f3ebb31a0
.quad 0x3e870ada3ea09ae5,0x3e25c58c3e5a3997,0x3de7fa9a3e2f10a2,0xbb490fc63d621469,0xbd2351cb3cc90ab0,0xbe2bf804bdd53db9,0xbe44b0b9bdfab273,0xbea80b1fbe8586ce
.quad 0xbeadf73cbe888e93,0xbef58035bed25a09,0xbef58035becf7bca,0xbf1e1e22bf0cead0,0xbf1ba299bf08f59b,0xbf3d27b8bf2d1469,0xbf38dd65bf273656,0xbf570348bf48d8b3
.quad 0xbf51c0c2bf41d870,0xbf6afb8cbf5f8327,0xbf65b710bf584853,0xbf788486bf708066,0xbf74484bbf6a09a7,0xbf7f3f54bf7b61fc,0xbf7d1cddbf76ba07,0xbf7efcc9bf7fe129
.quad 0xbf7fffb1bf7e1324,0xbf77beb7bf7de0b1,0xbf7cdf6cbf7fec43,0xbf69b7e4bf756d97,0xbf73ced9bf7c3b28,0xbf554aa4bf66becc,0xbf650479bf731447,0xbf3b0629bf5233c6
.quad 0xbf50d937bf64aa59,0xbf1ba299bf385216,0xbf37c655bf514d3d,0xbeeff7fbbf19c200,0xbf1a6293bf396842,0xbea21887beee9479,0xbef2bd43bf1d7fd1,0xbe1f917bbea395c5
.quad 0xbeab0201befc5d27,0x3c16cb58be28defc,0xbe3e853ebeb8442a,0x3e3228d4bbc90f88,0xbd0a342fbe605c13,0x3eab02013e1c76de,0x3df475c0bd96a905,0x3ef840c83e9d9e78
.quad 0x3f7efcc93f7f0e58,0x3f7ed7d43f7eea9d,0x3f76ef5b3f778bc5,0x3f75a67b3f764d97,0x3f6715993f68bf3c,0x3f6398ac3f655e0b,0x3f4fefa83f531849,0x3f4955213f4cae79
.quad 0x3f3238aa3f373a23,0x3f27ce613f2d1469,0x3f0ee0db3f15f6d9,0x3f003a063f07a136,0x3ece0bea3ee0924f,0x3ea80b1f3ebb31a0,0x3e6fa8b23e8e9a22,0x3e1324ca3e419b37
.quad 0x3d6ea0383de1bc2e,0xbd3c6dd53bc90f88,0xbdf475c0bd7b2b74,0xbe6fa8b2be354098,0xbe9620d2be6c9a7f,0xbed3c867beb554ec,0xbeea6681bec9b953,0xbf140c5fbf04f484
.quad 0xbf1ba299bf0b9a6b,0xbf38dd65bf2ac082,0xbf3d27b8bf2e3bde,0xbf570348bf4ac77f,0xbf58b3a1bf4bbbf8,0xbf6d67a1bf63f473,0xbf6d67a1bf633c5a,0xbf7b3babbf756d97
.quad 0xbf7a9c59bf740bdd,0xbf7fffb1bf7e9bc9,0xbf7fe705bf7dabcc,0xbf7b87b2bf7f2f9d,0xbf7d1cddbf7fd397,0xbf6dfcf2bf772417,0xbf725470bf7a7302,0xbf57dc7fbf66becc
.quad 0xbf5fe4e9bf6db293,0xbf39f2acbf4e8d90,0xbf466354bf59f26a,0xbf1553b7bf2f61a5,0xbf269de3bf3fc767,0xbed6a399bf0a48ad,0xbf019573bf1ff6cb,0xbe75c35abec1071e
.quad 0xbeb0eacbbef6e0cb,0xbd55880ebe4dee60,0xbe3228d4bea68f12,0x3e0cec4abc96c9b6,0x3b490fc6be22abb6,0x3ea5129f3e28defc,0x3e3857ec3c490e90,0x3efdbabb3eaf713a
.quad 0x3eb3dca53e3b6ecf,0x3f269de33f0242b1,0x3f02ef9f3eb263ef,0x3f485bca3f286605,0x3f27ce613f00e7e4,0x3f62df7b3f48d8b3,0x3f4760853f24d225,0x3f75341d3f628210
.quad 0xbb490fc680000000,0xbc16cb58bbc90f88,0xbc16cb5880000000,0xbce22a7abc96c9b6,0xbc7b514b80000000,0xbd3c6dd5bcfb49ba,0xbcafea6980000000,0xbd83db0abd2fe007
.quad 0xbce22a7a80000000,0xbda973babd621469,0xbd0a342f80000000,0xbdcefdb7bd8a200a,0xbd2351cb80000000,0xbdf475c0bda3308c,0xbd3c6dd580000000,0xbe0cec4abdbc3ac3
.quad 0xbd55880e80000000,0xbe1f917bbdd53db9,0xbd6ea03880000000,0xbe3228d4bdee3876,0xbd83db0a80000000,0xbe44b0b9be039502,0xbd9064b480000000,0xbe57278fbe1008b7
.quad 0xbd9cecf980000000,0xbe698bbabe1c76de,0xbda973ba80000000,0xbe7bdba4be28defc,0xbdb5f8da80000000,0xbe870adabe354098,0xbdc27c3980000000,0xbe901c2cbe419b37
.quad 0xbdcefdb780000000,0xbe9920febe4dee60,0xbddb7d3780000000,0xbea21887be5a3997,0xbde7fa9a80000000,0xbeab0201be667c66,0xbdf475c080000000,0xbeb3dca5be72b651
.quad 0xbe00774580000000,0xbebca7afbe7ee6e1,0xbe06b26e80000000,0xbec5625cbe8586ce,0xbe0cec4a80000000,0xbece0beabe8b9507,0xbe1324ca80000000,0xbed6a399be919ddd
.quad 0xbe195be080000000,0xbedf28a9be97a117,0xbe1f917b80000000,0xbee79a5dbe9d9e78,0xbe25c58c80000000,0xbeeff7fbbea395c5,0xbe2bf80480000000,0xbef840c8bea986c4
.quad 0xbe3228d480000000,0xbf003a06beaf713a,0xbe3857ec80000000,0xbf044889beb554ec,0xbe3e853e80000000,0xbf084b92bebb31a0,0xbe44b0b980000000,0xbf0c42c9bec1071e
.quad 0xbc7b514bbc490e90,0xbcafea69bc96c9b6,0xbd3c6dd5bd16c32c,0xbd83db0abd621469,0xbd9cecf9bd7b2b74,0xbddb7d37bdbc3ac3,0xbddb7d37bdafb680,0xbe195be0be039502
.quad 0xbe0cec4abde1bc2e,0xbe44b0b9be28defc,0xbe2bf804be09cf86,0xbe6fa8b2be4dee60,0xbe4ada4fbe22abb6,0xbe8d17c0be72b651,0xbe698bbabe3b6ecf,0xbea21887be8b9507
.quad 0xbe840270be541501,0xbeb6ccc3be9d9e78,0xbe931f35be6c9a7f,0xbecb2aaebeaf713a,0xbea21887be827dc0,0xbedf28a9bec1071e,0xbeb0eacbbe8e9a22,0xbef2bd43bed25a09
.quad 0xbebf926fbe9aa086,0xbf02ef9fbee363fa,0xbece0beabea68f12,0xbf0c42c9bef41f07,0xbedc53c1beb263ef,0xbf1553b7bf0242b1,0xbeea6681bebe1d4a,0xbf1e1e22bf0a48ad
.quad 0xbef840c8bec9b953,0xbf269de3bf121eb0,0xbf02ef9fbed53641,0xbf2ecef7bf19c200,0xbf099f4ebee0924f,0xbf36ad7fbf212ff9,0xbf102dd5beebcbbb,0xbf3e35c5bf286605
.quad 0xbf16999fbef6e0cb,0xbf456439bf2f61a5,0xbf1ce11fbf00e7e4,0xbf4c3578bf36206c,0xbf2302d3bf064b82,0xbf52a649bf3ca003,0xbf28fd41bf0b9a6b,0xbf58b3a1bf42de29
.quad 0xbf2ecef7bf10d3cd,0xbf5e5aa6bf48d8b3,0xbf34768fbf15f6d9,0xbf6398acbf4e8d90,0xbf39f2acbf1b02c6,0xbf686b39bf53fac3,0xbf3f41fcbf1ff6cb,0xbf6cd007bf591e6a
.quad 0xbf446337bf24d225,0xbf70c501bf5df6be,0xbf495521bf299415,0xbf74484bbf628210,0xbf4e1689bf2e3bde,0xbf77583abf66becc,0xbf52a649bf32c8c9,0xbf79f35ebf6aab7b
.quad 0xbce22a7abcc90ab0,0xbd0a342fbcfb49ba,0xbda973babd96a905,0xbdcefdb7bdbc3ac3,0xbe0cec4abdfab273,0xbe2bf804be1c76de,0xbe44b0b9be2f10a2,0xbe6fa8b2be5a3997
.quad 0xbe7bdba4be605c13,0xbe9920febe8b9507,0xbe9920febe888e93,0xbeb9bb1ebea986c4,0xbeb3dca5bea09ae5,0xbed97cb9bec6d529,0xbece0beabeb8442a,0xbef840c8bee363fa
.quad 0xbee79a5dbecf7bca,0xbf0af1b7beff17b2,0xbf003a06bee63375,0xbf19210fbf0cead0,0xbf0c42c9befc5d27,0xbf269de3bf19c200,0xbf17de12bf08f59b,0xbf33587abf26050a
.quad 0xbf2302d3bf13682a,0xbf3f41fcbf31a81d,0xbf2da859bf1d7fd1,0xbf4a4c87bf3ca003,0xbf37c655bf273656,0xbf546b3bbf46e22a,0xbf4154e1bf3085bb,0xbf5d924dbf5064af
.quad 0xbf4a4c87bf396842,0xbf65b710bf591e6a,0xbf52a649bf41d870,0xbf6cd007bf6106f2,0xbf5a5ba0bf49d112,0xbf72d4ebbf6816a8,0xbf61668abf514d3d,0xbf77beb7bf6e46be
.quad 0xbf67c187bf584853,0xbf7b87b2bf73913f,0xbf6d67a1bf5ebe05,0xbf7e2b72bf77f110,0xbf725470bf64aa59,0xbf7fa6e3bf7b61fc,0xbf76841bbf6a09a7,0xbf7ff84abf7de0b1
.quad 0xbf79f35ebf6ed89e,0xbf7f1f49bf7f6ac7,0xbf7c9f8abf731447,0xbf7d1cddbf7ffec4,0xbf7e868bbf76ba07,0xbf79f35ebf7f9c18,0xbf7fa6e3bf79c79d,0xbf75a67bbf7e4323
.quad 0xbf7fffb1bf7c3b28,0xbf703b37bf7bf531,0xbf7f90b1bf7e1324,0xbf69b7e4bf78b47b,0xbf7e5a38bf7f4e6d,0xbf62241abf748422,0xbf7c5d3abf7fec43,0xbf5988adbf6f6830
.quad 0xbd2351cbbd16c32c,0xbd3c6dd5bd2fe007,0xbdf475c0bde1bc2e,0xbe0cec4abe039502,0xbe4ada4fbe3b6ecf,0xbe698bbabe5a3997,0xbe8d17c0be827dc0,0xbea21887be97a117
.quad 0xbeb3dca5bea68f12,0xbece0beabec1071e,0xbed97cb9bec9b953,0xbef840c8bee900b7,0xbefdbabbbeebcbbb,0xbf102dd5bf07a136,0xbf102dd5bf064b82,0xbf2302d3bf19c200
.quad 0xbf209393bf15f6d9,0xbf34768fbf2ac082,0xbf2ff3e6bf24d225,0xbf446337bf3a7ca4,0xbf3e35c5bf32c8c9,0xbf52a649bf48d8b3,0xbf4b41fabf3fc767,0xbf5f20dbbf55b993
.quad 0xbf570348bf4bbbf8,0xbf69b7e4bf6106f2,0xbf61668abf5695e5,0xbf725470bf6aab7b,0xbf6a5ad9bf604621,0xbf78e3d6bf7294f8,0xbf71d19fbf68bf3c,0xbf7d57debf78b47b
.quad 0xbf77beb7bf6ff573,0xbf7fa6e3bf7cfe73,0xbf7c187abf75dec6,0xbf7fcbe2bf7f6ac7,0xbf7ed7d4bf7a7302,0xbf7dc68cbf7ff4e6,0xbf7ff84abf7dabcc,0xbf799b43bf7e9bc9
.quad 0xbf7f7808bf7f84ab,0xbf73530ebf7b61fc,0xbf7d57debf7ffb11,0xbf6afb8cbf764d97,0xbf799b43bf7f0e58,0xbf60a6cfbf6f6830,0xbf74484bbf7cbfc9,0xbf546b3bbf66becc
.quad 0xbf6d67a1bf791298,0xbf466354bf5c61c7,0xbf650479bf740bdd,0xbf36ad7fbf5064af,0xbf5b2c79bf6db293,0xbf256bcbbf42de29,0xbf4fefa8bf660f88,0xbf12c39abf33e7bc
.quad 0xbf436051bf5d2d53,0xbefdbabbbf239da9,0xbf3592e7bf531849,0xbed3c867bf121eb0,0xbf269de3bf47de65,0xbea80b1fbeff17b2,0xbf16999fbf3b8f3b,0xbe75c35abed8106b
.quad 0xbd55880ebd48fb30,0xbd6ea038bd621469,0xbe1f917bbe164083,0xbe3228d4be28defc,0xbe840270be78cfcc,0xbe931f35be8b9507,0xbeb6ccc3beac7cd4,0xbecb2aaebec1071e
.quad 0xbee79a5dbedae880,0xbf003a06bef41f07,0xbf0af1b7bf039c3d,0xbf19210fbf121eb0,0xbf209393bf187fc0,0xbf2ff3e6bf286605,0xbf34768fbf2beb4a,0xbf446337bf3ca003
.quad 0xbf466354bf3daef9,0xbf5627febf4e8d90,0xbf5627febf4d9f02,0xbf650479bf5df6be,0xbf6398acbf5b941a,0xbf70c501bf6aab7b,0xbf6e8ff8bf676bd8,0xbf7940c0bf748422
.quad 0xbf76ef5bbf710908,0xbf7e5a38bf7b61fc,0xbf7c9f8abf7853f8,0xbf7fffb1bf7f2f9d,0xbf7f90b1bf7d3aac,0xbf7e2b72bf7fe129,0xbf7fba9ebf7fb10f,0xbf78e3d6bf7d7474
.quad 0xbf7d1cddbf7fb10f,0xbf703b37bf77f110,0xbf77beb7bf7d3aac,0xbf644facbf6f6830,0xbf6faf1bbf7853f8,0xbf554aa4bf63f473,0xbf650479bf710908,0xbf436051bf55b993
.quad 0xbf57dc7fbf676bd8,0xbf2ecef7bf44e3f5,0xbf485bcabf5b941a,0xbf17de12bf31a81d,0xbf36ad7fbf4d9f02,0xbefdbabbbf1c420c,0xbf2302d3bf3daef9,0xbec8477cbf04f484
.quad 0xbf0d9281bf2beb4a,0xbe901c2cbed8106b,0xbeed3063bf187fc0,0xbe2bf804bea395c5,0xbebca7afbf039c3d,0xbd55880ebe5a3997,0xbe8a11f7bedae880,0x3d83db0abdd53db9
.quad 0xbe2bf804beac7cd4,0x3e3857ec3bc90f88,0xbd83db0abe78cfcc,0x3e9620d23dee3876,0x3d2351cbbe164083,0x3ece0bea3e667c66,0x3e1324cabd48fb30,0x3f0195733ea986c4
.quad 0xbd83db0abd7b2b74,0xbd9064b4bd8a200a,0xbe44b0b9be3b6ecf,0xbe57278fbe4dee60,0xbea21887be9aa086,0xbeb0eacbbea986c4,0xbedf28a9bed53641,0xbef2bd43bee900b7
.quad 0xbf0c42c9bf064b82,0xbf17de12bf121eb0,0xbf269de3bf1ff6cb,0xbf33587abf2d1469,0xbf3e35c5bf373a23,0xbf4b41fabf44e3f5,0xbf52a649bf4bbbf8,0xbf5f20dbbf591e6a
.quad 0xbf6398acbf5d2d53,0xbf6e8ff8bf696591,0xbf70c501bf6b4b0c,0xbf7940c0bf756d97,0xbf79f35ebf75dec6,0xbf7efcc9bf7cfe73,0xbf7efcc9bf7cbfc9,0xbf7fa6e3bf7ff4e6
.quad 0xbf7fcbe2bf7fd397,0xbf7b3babbf7e4323,0xbf7c5d3abf7f0e58,0xbf71d19fbf77f110,0xbf74bf62bf7a7302,0xbf6398acbf6d1c1d,0xbf6912aebf721352,0xbf50d937bf5df6be
.quad 0xbf5988adbf660f88,0xbf39f2acbf4ac77f,0xbf466354bf5695e5,0xbf1f599fbf33e7bc,0xbf2ff3e6bf43e200,0xbf019573bf19c200,0xbf16999fbf2e3bde,0xbec27b55bef9a02d
.quad 0xbef58035bf15f6d9,0xbe7bdba4bebb31a0,0xbeb9bb1ebef6e0cb,0xbddb7d37be72b651,0xbe75c35abebe1d4a,0x3d0a342fbdd53db9,0xbde7fa9abe827dc0,0x3e3228d43cfb49ba
.quad 0x3c7b514bbe09cf86,0x3e9f1cdf3e28defc,0x3e1324cabc490e90,0x3ee1fb6a3e97a117,0x3e8a11f73de1bc2e,0x3f102dd53ed8106b,0x3ec8477c3e6c9a7f,0x3f2c800f3f0a48ad
.quad 0x3f0195733eb263ef,0x3f4564393f26050a,0x3f1ce11f3eebcbbb,0x3f5a5ba03f3ebc1b,0x3f3592e73f10d3cd,0x3f6afb8c3f53fac3,0x3f4b41fa3f299415,0x3f76ef5b3f655e0b
.quad 0xbd9cecf9bd96a905,0xbda973babda3308c,0xbe698bbabe605c13,0xbe7bdba4be72b651,0xbebf926fbeb8442a,0xbece0beabec6d529,0xbf02ef9fbefc5d27,0xbf0c42c9bf07a136
.quad 0xbf2302d3bf1d7fd1,0xbf2da859bf286605,0xbf3f41fcbf396842,0xbf4a4c87bf44e3f5,0xbf570348bf514d3d,0xbf61668abf5c61c7,0xbf69b7e4bf64aa59,0xbf725470bf6e46be
.quad 0xbf76ef5bbf731447,0xbf7c9f8abf7a1e84,0xbf7e5a38bf7c3b28,0xbf7fffb1bf7f9c18,0xbf7fcbe2bf7fec43,0xbf7c5d3abf7e9bc9,0xbf7b3babbf7e1324,0xbf71d19fbf772417
.quad 0xbf70c501bf76ba07,0xbf60a6cfbf696591,0xbf60a6cfbf6a09a7,0xbf495521bf55b993,0xbf4b41fabf584853,0xbf2c800fbf3ca003,0xbf311722bf41d870,0xbf0af1b7bf1ebc12
.quad 0xbf12c39abf273656,0xbecb2aaebef9a02d,0xbee1fb6abf08f59b,0xbe75c35abeaf713a,0xbe9920febecf7bca,0xbd9cecf9be419b37,0xbe195be0be888e93,0x3db5f8dabcfb49ba
.quad 0x3b490fc6bdfab273,0x3e80f8c03e039502,0x3e1f917b3cc90ab0,0x3ed0eb2a3e919ddd,0x3e9c1faf3e2f10a2,0x3f0d92813eddbe79,0x3ee4cbfe3ea09ae5,0x3f2ecef73f121eb0
.quad 0x3f140c5f3ee63375,0x3f4b41fa3f31a81d,0x3f3238aa3f13682a,0x3f62241a3f4cae79,0x3f4c35783f3085bb,0x3f72d4eb3f628210,0x3f61668a3f49d112,0x3f7cdf6c3f7294f8
.quad 0x3f714c7a3f5ebe05,0x3f7ffd393f7c7eb0,0x3f7b87b23f6ed89e,0x3f7c187a3f7ffec4,0x3f7fdaaf3f79c79d,0x3f714c7a3f7cfe73,0x3f7e2b723f7f4e6d,0x3f5fe4e93f73913f
.quad 0xbdb5f8dabdafb680,0xbdc27c39bdbc3ac3,0xbe870adabe827dc0,0xbe901c2cbe8b9507,0xbedc53c1bed53641,0xbeea6681bee363fa,0xbf1553b7bf10d3cd,0xbf1e1e22bf19c200
.quad 0xbf37c655bf32c8c9,0xbf4154e1bf3ca003,0xbf546b3bbf4f7a1f,0xbf5d924dbf591e6a,0xbf6a5ad9bf660f88,0xbf71d19fbf6e46be,0xbf78e3d6bf75dec6,0xbf7d57debf7b61fc
.quad 0xbf7f90b1bf7e70b0,0xbf7fba9ebf7ffec4,0xbf7e2b72bf7f84ab,0xbf78e3d6bf7bf531,0xbf74bf62bf791298,0xbf6912aebf6f6830,0xbf6398acbf6b4b0c,0xbf50d937bf5ac450
.quad 0xbf4b41fabf5695e5,0xbf311722bf3ebc1b,0xbf2c800fbf3b8f3b,0xbf0af1b7bf1c420c,0xbf084b92bf1b02c6,0xbebf926fbee900b7,0xbebf926fbeebcbbb,0xbe44b0b9be919ddd
.quad 0xbe5101f1be9aa086,0xbb490fc6bdd53db9,0xbce22a7abe09cf86,0x3e3e853e3da3308c,0x3e195be03d16c32c,0x3ebca7af3e8586ce,0x3ea5129f3e541501,0x3f099f4e3eddbe79
.quad 0x3ef840c83ebe1d4a,0x3f2ff3e63f173c07,0x3f21cbfb3f064b82,0x3f4fefa83f3a7ca4,0x3f425b893f299415,0x3f686b393f577026,0x3f5cc7d13f47de65,0x3f7884863f6d1c1d
.quad 0x3f703b373f604621,0x3f7fa6e33f7ac516,0x3f7c187a3f721352,0x3f7d906e3f7ff4e6,0x3f7fffb13f7cbfc9,0x3f7254703f7c7eb0,0x3f7bd14d3f7ffb11,0x3f5e5aa63f708066
.quad 0x3f6faf1b3f7baccd,0x3f425b893f5c61c7,0x3f5bfb343f6ff573,0x3f1f599f3f40d0da,0x3f4154e13f5d2d53,0x3eed30633f1ebc12,0x3f2093933f43e200,0x3e931f353eee9479
.quad 0x3612492536124925,0x3612492536124925,0x3612478f361248f7,0x36124082361244bd,0x361242cc36124870,0x3612269b36123785,0x36123ade3612478f,0x3611fb723612217f
.quad 0x36122fc436124653,0x3611bf0e361202ab,0x3612217f361244bd,0x361171743611db0c,0x3612100e361242cc,0x361112ae3611aaa3,0x3611fb7236124082,0x3610a2c836117174
.quad 0x3611e3ac36123ddd,0x361021ce36112f82,0x3611c8bc36123ade,0x360f8fcf3610e4d1,0x3611aaa336123785,0x360eecde36109166,0x36118961361233d2,0x360e390d36103546
.quad 0x361164f736122fc4,0x360d7471360fd075,0x36113d6636122b5d,0x360c9f21360f62fb,0x361112ae3612269b,0x360bb938360eecde,0x3610e4d13612217f,0x360ac2cf360e6e25
.quad 0x3610b3d036121c09,0x3609bc05360de6d7,0x36107fab36121638,0x3608a4f7360d56fd,0x361048653612100e,0x36077dc8360cbe9f,0x36100dfd3612098a,0x36064699360c1dc7
.quad 0x360fd075361202ab,0x3604ff90360b747e,0x360f8fcf3611fb72,0x3603a8d3360ac2cf,0x360f4c0c3611f3e0,0x3602428b360a08c4,0x360f052e3611ebf3,0x3600cce136094668
.quad 0x360ebb353611e3ac,0x35fe900636087bc8,0x360e6e253611db0c,0x35fb683c3607a8ef,0x360e1dfd3611d211,0x35f822c33606cde9,0x360dcac03611c8bc,0x35f4bffe3605eac5
.quad 0x360d74713611bf0e,0x35f140533604ff90,0x360d1b103611b505,0x35eda42d36040c58,0x360cbe9f3611aaa3,0x35e9ebf93603112b,0x360c5f2136119fe7,0x35e6182636020e19
.quad 0x3612492536124925,0x3612492536124925,0x361233d236123ade,0x3612217f36122b5d,0x3611f3e03612100e,0x3611aaa33611d211,0x361189613611c8bc,0x3610e4d136113d66
.quad 0x3610f474361164f7,0x360fd07536106d98,0x361035463610e4d1,0x360e6e25360f62fb,0x360f4c0c36104865,0x360cbe9f360e1dfd,0x360e390d360f8fcf,0x360ac2cf360c9f21
.quad 0x360cfc96360ebb35,0x36087bc8360ae704,0x360b9706360dcac0,0x3605eac53608f659,0x360a08c4360cbe9f,0x3603112b3606cde9,0x36085244360b9706,0x35ffe10a36046e96
.quad 0x36067407360a542f,0x35f9150b3601d958,0x36046e963608f659,0x35f1c20835fe1e75,0x3602428b36077dc8,0x35e9ebf935f822c3,0x35ffe10a3605eac5,0x35e1971d35f1c208
.quad 0x35faf26736043da0,0x35d8c7f835eafede,0x35f5ba9b360276ac,0x35cf835235e3dc06,0x35f03b2c36009641,0x35c5ce2f35dc5c66,0x35ea75b435fd397d,0x35bbadd435d4830e
.quad 0x35e46be135f9150b,0x35b127bd35cc532f,0x35de1f7735f4bffe,0x35a6419f35c3d01e,0x35d7924c35f03b2c,0x359b016235bafd53,0x35d0c64935eb8777,0x358f6d2035b1de66
.quad 0x35c9bd6835e6a5cc,0x35838b1e35a8770c,0x35c279b635e1971d,0x356ec39e359ecb1a,0x35bafd5335dc5c66,0x3555ef933594de81,0x35b34a6d35d6f6af,0x353ca791358ab54b
.quad 0x35ab634135d16703,0x3522f94b3580539b,0x35a34a1f35cbae79,0x3508f2af356b7b55,0x359b016235c5ce2f,0x34dd43ad3555ef93,0x35928b7535bfc74a,0x34a82a0c35400cb6
.quad 0x3612492536124925,0x3612492536124925,0x3612098a36121638,0x3611ebf33611fb72,0x36114af036117d97,0x3610d4d5361112ae,0x36100dfd36107fab,0x360f052e360f8fcf
.quad 0x360e53c4360f1d26,0x360c7f4d360d7471,0x360c1dc7360d56fd,0x36094668360ac2cf,0x36096df1360b2e6d,0x36055e9c36077dc8,0x360646993608a4f7,0x3600cce13603a8d3
.quad 0x3602aa7c3605bc5f,0x35f72e1535fe9006,0x35fd397d360276ac,0x35eb877735f4bffe,0x35f441cc35fdac47,0x35deb4c135e9ebf9,0x35ea75b435f5ba9b,0x35d0c64935de1f77
.quad 0x35dfddb735ed1ddb,0x35c1cdce35d16703,0x35d4830e35e3dc06,0x35b1de6635c3d01e,0x35c86f9835d9fb8d,0x35a10c5c35b56939,0x35bbadd435cf8352,0x358f6d2035a6419f
.quad 0x35ae48db35c47a9d,0x357a2e493596696a,0x35a04c5335b8e91f,0x355443903585f16e,0x3591c46635acd6e4,0x352d4a633569d656,0x3582bdb635a04c53,0x3505746b3546d16a
.quad 0x35668aa835935229,0x34b9e8cf3522f94b,0x3546d16a3585f16e,0x344ff7d534fce81d,0x35266b46357066e6,0x332c543e34b2d0fd,0x3505746b35544390,0xb3f40934344ff7d5
.quad 0x34c8130235378c73,0xb48f41663365c312,0x34848f33351a558c,0xb4e0c9f8b3baa69f,0x3401303c34f96664,0xb5189a11b473b441,0xb1e5c8e234bd740e,0xb5400cb6b4c48929
.quad 0xb40f868b3480fdd1,0xb5668aa8b50733b6,0xb48bb10034085b8e,0xb585f16eb52b933a,0xb4cf25403265c89b,0xb597f2e0b54f3c7b,0xb508f2afb3d758f4,0xb5a932b6b572099a
.quad 0x3612492536124925,0x3612492536124925,0x3611c8bc3611db0c,0x36119fe73611b505,0x3610486536109166,0x360fa5b5360ff9d3,0x360dcac0360e6e25,0x360c5f21360d1b10
.quad 0x360a542f360b747e,0x3607d3c236091e8b,0x3605eac53607a8ef,0x36020e1936040c58,0x360096413603112b,0x35f6370635fbdd75,0x35f4bffe35fb683c,0x35e6182635eda42d
.quad 0x35e6a5cc35ef33b3,0x35d3e4dd35dd89a5,0x35d6f6af35e1971d,0x35bfc74a35cbae79,0x35c5ce2f35d2a6f4,0x35a9edf835b836d3,0x35b34a6d35c279b6,0x35928b7535a34a1f
.quad 0x359f8be835b127bd,0x3573abb8358d12bd,0x358ab54b359ecb1a,0x35400cb6356b7b55,0x3569d656358b7f72,0x350ab153353af44f,0x353ca791356ec39e,0x34a82a0c3508f2af
.quad 0x350e2d99354520f2,0x33e5b15b34abb772,0x34bd740e351a558c,0xb3d758f434085b8e,0x343a80a034dd43ad,0xb4a49c3eb38f97d8,0xb1e5c8e234848f33,0xb508f2afb48bb100
.quad 0xb448d09333ac4cc4,0xb53e5a5eb4f26126,0xb4c48929b3baa69f,0xb572099ab52b933a,0xb511a880b4882044,0xb591c466b55c9a6b,0xb5400cb6b4e0c9f8,0xb5a932b6b585f16e
.quad 0xb56d1fc2b51c10a8,0xb5bf1987b59c8668,0xb58c4943b546d16a,0xb5d3462ab5b1de66,0xb5a10c5cb57066e6,0xb5e589f2b5c5ce2f,0xb5b4b4b9b58c4943,0xb5f5ba9bb5d82d65
.quad 0xb5c71fd9b59f8be8,0xb601d958b5e8d6d2,0xb5d82d65b5b1de66,0xb607a8efb5f7a8b8,0xb5e7bf6db5c32527,0xb60c3ea0b602428b,0xb5f5ba9bb5d3462a,0xb60f8fcfb607a8ef
.quad 0x3612492536124925,0x3612492536124925,0x3611717436118961,0x36113d6636115820,0x360eecde360f4c0c,0x360e1dfd360e882d,0x360ac2cf360b9706,0x3608f6593609e28f
.quad 0x3604ff9036067407,0x3601d95836037697,0x35fb683c35ffe10a,0x35f1c20835f6b2da,0x35e9ebf935f03b2c,0x35dc5c6635e34b9d,0x35d5bde635de1f77,0x35c3d01e35ccf767
.quad 0x35bf198735c9bd68,0x35a8770c35b3ffcb,0x35a6419f35b34a6d,0x358ab54b3598b70e,0x358b7f72359b0162,0x3555ef933576ee32,0x355e43cf358121f4,0x3513656e3539409a
.quad 0x3522f94b354bdfec,0x349d7f7534f26126,0x34cb9c603513656e,0x330f9c2b345e44d3,0x341ddb7934b2d0fd,0xb473b441b32c543e,0xb3baa69f33f40934,0xb501f4ddb499f07e
.quad 0xb4abb772b3e5b15b,0xb54520f2b50e2d99,0xb513656eb4af446d,0xb582bdb6b54d8e73,0xb54f3c7bb511a880,0xb5a10c5cb58524fb,0xb5845835b54a30e8,0xb5bd0d7ab5a1cc01
.quad 0xb59f8be8b580539b,0xb5d65a8db5bc5de1,0xb5b8e91fb59a3e50,0xb5ec96f6b5d4830e,0xb5d0250db5b294a0,0xb5ff7151b5e9ebf9,0xb5e4fb30b5c916be,0xb607524db5fc5213
.quad 0xb5f72e15b5dd89a5,0xb60cfc96b605bc5f,0xb6034409b5efb7ba,0xb610a2c8b60b9706,0xb6096df1b5ff7151,0xb6123785b60fa5b5,0xb60e0296b6064699,0xb611b505b611db0c
.quad 0xb610f474b60b747e,0xb60f1d26b6122fc4,0xb6123adeb60f34c5,0xb60a7965b610a2c8,0xb611d211b6117d97,0xb603dabeb60d3932,0xb60fbb41b61248f7,0xb5f6b2dab607fe41
.quad 0x3612492536124925,0x3612492536124925,0x361103be36112145,0x3610c47f3610e4d1,0x360d3932360dae53,0x360c3ea0360cbe9f,0x3606fa5e3607fe41,0x3604cf8f3605eac5
.quad 0x35fcc61636002813,0x35f53d9835f9150b,0x35e732e435ec96f6,0x35dbc4fb35e1971d,0x35cd9b2035d520bc,0x35bdbc9e35c5ce2f,0x35b070a835ba4c5f,0x359bc41535a6419f
.quad 0x3590353b359c8668,0x356d1fc235838b1e,0x355af07e35788e8a,0x351dcb64353ca791,0x3511a880353422d2,0x3496612734dd43ad,0x348bb10034d9bcd9,0xb30f9c2b33f40934
.quad 0xb2e5c780340f868b,0xb4b9e8cfb448d093,0xb4a82a0cb416b131,0xb52f0122b501f4dd,0xb51f85bfb4dd43ad,0xb57d6bf8b54f3c7b,0xb56830c7b535d7db,0xb5a34a1fb58c4943
.quad 0xb596696ab57a2e49,0xb5c47a9db5ae48db,0xb5b61d48b59d485a,0xb5e1971db5ccf767,0xb5d2a6f4b5bafd53,0xb5fa04eeb5e7bf6d,0xb5eb8777b5d5bde6,0xb606a121b5fe1e75
.quad 0xb6002813b5ed1ddb,0xb60d7471b607d3c2,0xb6085244b6005f52,0xb6115820b60e0296,0xb60e1dfdb608286d,0xb6123785b6117d97,0xb6117174b60dcac0,0xb6100dfdb61233d2
.quad 0xb6123dddb6112f82,0xb60ae704b61021ce,0xb6107fabb61248f7,0xb602ddfcb60b51a1,0xb60c3ea0b61112ae,0xb5f03b2cb603dabe,0xb6058da7b60d918d,0xb5d5bde6b5f3c304
.quad 0xb5f9150bb607d3c2,0xb5b6d0e8b5db2d08,0xb5e2baa9b5ffe10a,0xb5941883b5be6b4d,0xb5c86f98b5ec0f80,0xb55c9a6bb59e09eb,0xb5aaa8d1b5d4830e,0xb50c6fa1b5754d41
.quad 0x3612492536124925,0x3612492536124925,0x36107fab3610a2c8,0x3610354636105b2b,0x360b2e6d360bb938,0x360a08c4360a9e45,0x360276ac3603a8d3,0x35ffe10a36013933
.quad 0x35ed1ddb35f14053,0x35e46be135e8d6d2,0x35cf835235d5bde6,0x35c279b635c916be,0x35acd6e435b56939,0x359b016235a40897,0x3585f16e3590fcfd,0x355e43cf35754d41
.quad 0x35378c733552970b,0x3500349d351c10a8,0x34bd740e34fce81d,0x33f40934347ad83f,0x3265c89b341ddb79,0xb4882044b401303c,0xb4af446db441a8d5,0xb524b27cb4fce81d
.quad 0xb530b775b50733b6,0xb580539bb559460b,0xb582bdb6b55af07e,0xb5aaa8d1b5972e53,0xb5a9edf8b594de81,0xb5d0250db5bdbc9e,0xb5ccf767b5b8e91f,0xb5efb7bab5df4981
.quad 0xb5eafedeb5d8c7f8,0xb6043da0b5faf267,0xb601a446b5f3c304,0xb60cddc6b607fe41,0xb60a9e45b6049f3b,0xb6117d97b60eecde,0xb6103546b60c5f21,0xb611fb72b6121638
.quad 0xb6124653b610f474,0xb60e53c4b61164f7,0xb610c47fb61244bd,0xb606a121b60cddc6,0xb60bb938b6104865,0xb5f63706b6049f3b,0xb6034409b60b0ae4,0xb5d82d65b5f1c208
.quad 0xb5ef33b3b602aa7c,0xb5b3ffcbb5d3e4dd,0xb5d2073cb5eeaf1a,0xb58ab54bb5b070a8,0xb5afb925b5d2a6f4,0xb53af44fb58854d7,0xb5891ffdb5b1de66,0xb4b65d1fb539409a
.quad 0xb53e5a5eb58d12bd,0x32e5c780b4b9e8cf,0xb4cb9c60b54a30e8,0x34d2ada031e5c8e2,0xb32c543eb4eb5992,0x3548816734c0fed7,0x34a10e0bb3f40934,0x3590fcfd353ca791
.quad 0x3612492536124925,0x3612492536124925,0x360fe55136100dfd,0x360f8fcf360fbb41,0x3608cdd236096df1,0x36077dc83608286d,0x35fa7bf835fd397d,0x35f4bffe35f7a8b8
.quad 0x35db2d0835dfddb7,0x35d1670335d65a8d,0x35b4b4b935bbadd4,0x35a6419f35ad9015,0x358854d73591c466,0x3569d656357d6bf8,0x352f01223546d16a,0x34fce81d3516de37
.quad 0x348f416634c81302,0x3365c312342c2ee1,0xb4085b8eb1e5c8e2,0xb4c48929b4848f33,0xb50ab153b4cf2540,0xb54f3c7bb52d4a63,0xb56ec39eb54a30e8,0xb59a3e50b5891ffd
.quad 0xb5a58458b5935229,0xb5c71fd9b5b6d0e8,0xb5ce3e5bb5bd0d7a,0xb5ec96f6b5de1f77,0xb5f03b2cb5e10486,0xb6049f3bb5fdac47,0xb6052f3fb5fe1e75,0xb60e0296b60a2ea4
.quad 0xb60de6d7b609bc05,0xb6121c09b610b3d0,0xb611fb72b6103546,0xb610c47fb6122b5d,0xb6114af0b6124870,0xb60a08c4b60e882d,0xb60bdb13b60fe551,0xb5fc5213b605eac5
.quad 0xb601d958b6091e8b,0xb5db2d08b5f14053,0xb5e732e4b5fc5213,0xb5b1de66b5ce3e5b,0xb5c32527b5deb4c1,0xb581effdb5a40897,0xb598b70eb5ba4c5f,0xb51a558cb56830c7
.quad 0xb552970bb590353b,0xb42c2ee1b500349d,0xb4d9bcd9b5437001,0x348bb100b39df27f,0xb265c89bb4c0fed7,0x353422d234b2d0fd,0x34cb9c6032ac561c,0x358ddbe035437001
.quad 0x354bdfec34d6357f,0x35bc5de135935229,0x3595a424354d8e73,0x35e3dc0635bfc74a,0x35c074983594de81,0x36016ee535e589f2,0x35e4fb3035be6b4d,0x360c1dc73601a446
.quad 0x0,0x0,0x32ac561c31e5c8e2,0x33490be6330f9c2b,0x332c543e3265c89b,0x33c90008338f97d8,0x33813cd832ac561c,0x3416b13133d758f4
.quad 0x33ac4cc432e5c780,0x3448d093340f868b,0x33d758f4330f9c2b,0x347ad83f343357f8,0x3401303c332c543e,0x3496612734571e96,0x3416b13133490be6,0x34af446d347ad83f
.quad 0x342c2ee13365c312,0x34c81302348f4166,0x3441a8d533813cd8,0x34e0c9f834a10e0b,0x34571e96338f97d8,0x34f9666434b2d0fd,0x346c8fad339df27f,0x3508f2af34c48929
.quad 0x3480fdd133ac4cc4,0x3515220134d6357f,0x348bb10033baa69f,0x35213fb734e7d4ed,0x3496612733c90008,0x352d4a6334f96664,0x34a10e0b33d758f4,0x3539409a3505746b
.quad 0x34abb77233e5b15b,0x354520f2350e2d99,0x34b65d1f33f40934,0x3550ea043516de37,0x34c0fed73401303c,0x355c9a6b351f85bf,0x34cb9c6034085b8e,0x356830c7352823aa
.quad 0x34d6357f340f868b,0x3573abb83530b775,0x34e0c9f83416b131,0x357f09e53539409a,0x34eb5992341ddb79,0x358524fb3541be97,0x34f5e41134250560,0x358ab54b354a30e8
.quad 0x3500349d342c2ee1,0x3590353b3552970b,0x3505746b343357f8,0x3595a424355af07e,0x350ab153343a80a0,0x359b016235633cc2,0x350feb393441a8d5,0x35a04c53356b7b55
.quad 0x351522013448d093,0x35a584583573abb8,0x351a558c344ff7d5,0x35aaa8d1357bcd6e,0x351f85bf34571e96,0x35afb9253581effd,0x3524b27c345e44d3,0x35b4b4b93585f16e
.quad 0x0,0x0,0x339df27f33813cd8,0x33d758f433baa69f,0x341ddb793401303c,0x34571e96343a80a0,0x346c8fad3441a8d5,0x34a10e0b348bb100
.quad 0x349d7f753480fdd1,0x34d6357f34b9e8cf,0x34c4892934a10e0b,0x3505746b34e7d4ed,0x34eb599234c0fed7,0x351f85bf350ab153,0x3508f2af34e0c9f8,0x3539409a35213fb7
.quad 0x351c10a83500349d,0x3552970b35378c73,0x352f0122350feb39,0x356b7b55354d8e73,0x3541be97351f85bf,0x3581effd35633cc2,0x35544390352f0122,0x358ddbe035788e8a
.quad 0x35668aa8353e5a5e,0x35997ade3586bd8f,0x35788e8a354d8e73,0x35a4c6aa3590fcfd,0x358524fb355c9a6b,0x35afb925359b0162,0x358ddbe0356b7b55,0x35ba4c5f35a4c6aa
.quad 0x3596696a357a2e49,0x35c47a9d35ae48db,0x359ecb1a35845835,0x35ce3e5b35b78416,0x35a6fe80358b7f72,0x35d7924c35c07498,0x35af013635928b75,0x35e0716435c916be
.quad 0x35b6d0e835997ade,0x35e8d6d235d16703,0x35be6b4d35a04c53,0x35f0be0a35d96206,0x35c5ce2f35a6fe80,0x35f822c335e10486,0x35ccf76735ad9015,0x35ff00fa35e84b67
.quad 0x35d3e4dd35b3ffcb,0x3602aa7c35ef33b3,0x35da948e35ba4c5f,0x36058da735f5ba9b,0x35e1048635c07498,0x3608286d35fbdd75,0x35e732e435c67741,0x360a79653600cce1
.quad 0x35ed1ddb35cc532f,0x360c7f4d36037697,0x35f2c3b235d2073c,0x360e390d3605eac5,0x35f822c335d7924c,0x360fa5b53608286d,0x35fd397d35dcf34a,0x3610c47f360a2ea4
.quad 0x0,0x0,0x34085b8e33f40934,0x342505603416b131,0x348820443473b441,0x34a49c3e34966127,0x34cb9c6034b65d1f,0x34f5e41134e0c9f8
.quad 0x350733b634f26126,0x3522f94b35152201,0x352823aa3516de37,0x354a30e83539409a,0x35488167353422d2,0x357066e6355c9a6b,0x356830c73550ea04,0x358ab54b357f09e5
.quad 0x35838b1e356d1fc2,0x359c86683590353b,0x35928b7535845835,0x35ad901535a04c53,0x35a10c5c3591c466,0x35bdbc9e35afb925,0x35af0136359ecb1a,0x35ccf76735be6b4d
.quad 0x35bc5de135ab6341,0x35db2d0835cc532f,0x35c916be35b78416,0x35e84b6735d96206,0x35d520bc35c32527,0x35f441cc35e589f2,0x35e0716435ce3e5b,0x35ff00fa35f0be0a
.quad 0x35eafede35d8c7f8,0x36043da035faf267,0x35f4bffe35e2baa9,0x3608524436020e19,0x35fdac4735ec0f80,0x360bb938360618d8,0x3602ddfc35f4bffe,0x360e6e2536099525
.quad 0x3606740735fcc616,0x36106d98360c7f4d,0x3609952536020e19,0x3611b505360ed436,0x360c3ea036055e9c,0x361242cc36109166,0x360e6e2536085244,0x361216383611b505
.quad 0x361021ce360ae704,0x36112f8236123ddd,0x36115820360d1b10,0x360f8fcf36122b5d,0x3612100e360eecde,0x360d393236117d97,0x361248f736105b2b,0x360a2ea436103546
.quad 0x361202ab361164f7,0x36067407360e53c4,0x36113d663612098a,0x36020e19360bdb13,0x360ff9d336124870,0x35fa04ee3608cdd2,0x360e390d3612217f,0x35eeaf1a36052f3f
.quad 0x0,0x0,0x3441a8d5343357f8,0x345e44d3344ff7d5,0x34c0fed734b2d0fd,0x34dd43ad34cf2540,0x350feb393505746b,0x3524b27c351a558c
.quad 0x353e5a5e3530b775,0x3559460b354bdfec,0x356b7b55355af07e,0x3585f16e357bcd6e,0x358b7f723581effd,0x359e09eb3594de81,0x35a04c533595a424,0x35b4b4b935aaa8d1
.quad 0x35b3ffcb35a8770c,0x35c9bd6835bf1987,0x35c6774135ba4c5f,0x35dcf34a35d2073c,0x35d7924c35cb0946,0x35ee29ed35e34b9d,0x35e732e435da948e,0x35fd397d35f2c3b2
.quad 0x35f53d9835e8d6d2,0x3604ff9036002813,0x3600cce135f5ba9b,0x360a2ea43605eac5,0x360618d836009641,0x360e1dfd360a9e45,0x360a796536058da7,0x3610c47f360e390d
.quad 0x360de6d73609bc05,0x36121c093610b3d0,0x36105b2b360d1b10,0x3612217f3612098a,0x3611d211360fa5b5,0x3610d4d536123785,0x361248f736115820,0x360e390d36113d66
.quad 0x3611bf0e36122fc4,0x360a542f360f1d26,0x3610354636122b5d,0x36052f3f360bdb13,0x360dae5336114af0,0x35fdac4736077dc8,0x360a2ea4360f8fcf,0x35eeaf1a36020e19
.quad 0x3605bc5f360cfc96,0x35dd89a535f72e15,0x36005f5236099525,0x35ca639535e84b67,0x35f441cc36055e9c,0x35b5693935d7924c,0x35e6182636005f52,0x359ecb1a35c524a3
.quad 0x35d65a8d35f53d98,0x3586bd8f35b127bd,0x35c524a335e84b67,0x355af07e359bc415,0x35b294a035d9fb8d,0x35266b46358524fb,0x359ecb1a35ca6395,0x34e0c9f8355af07e
.quad 0x0,0x0,0x347ad83f346c8fad,0x348bb10034848f33,0x34f9666434eb5992,0x350ab1533503b4cc,0x3539409a352f0122,0x354d8e7335437001
.quad 0x3573abb835668aa8,0x3586bd8f3580539b,0x3595a424358ddbe0,0x35a4c6aa359d485a,0x35afb92535a6fe80,0x35c0749835b836d3,0x35c7c7f635be6b4d,0x35d9620635d0c649
.quad 0x35dd89a535d3e4dd,0x35ef33b335e6a5cc,0x35f0be0a35e732e4,0x3600cce135f98d49,0x3600964135f822c3,0x3608286d36049f3b,0x3607524d36034409,0x360d918d360ac2cf
.quad 0x360c7f4d36091e8b,0x3610f474360f1d26,0x36100dfd360d918d,0x361244bd36119fe7,0x3611f3e036109166,0x36117d97361242cc,0x36122b5d36121638,0x360ea1dd361103be
.quad 0x3610b3d036121c09,0x3609bc05360de6d7,0x360d918d3610a2c8,0x3602ddfc3608f659,0x3608cdd2360dae53,0x35f441cc3602428b,0x360276ac36094668,0x35df498135f3c304
.quad 0x35f53d9836037697,0x35c71fd935dfddb7,0x35e2baa935f89c34,0x35ac1d4835c916be,0x35cd9b2035e7bf6d,0x358ea4ac35afb925,0x35b61d4835d4830e,0x355e43cf35941883
.quad 0x359c866835bf1987,0x351c10a8356d1fc2,0x358121f435a7bafa,0x34af446d352f0122,0x35488167358ea4ac,0x338f97d834dd43ad,0x350c6fa1356830c7,0xb44ff7d5343357f8
.quad 0x349d7f753530b775,0xb4f26126b3ac4cc4,0x33813cd834eedda6,0xb53ca791b4af446d,0xb43a80a03473b441,0xb57d6bf8b5189a11,0xb4d9bcd931e5c8e2,0xb59d485ab5579b11
.quad 0x0,0x0,0x3499f07e3492d174,0x34a82a0c34a10e0b,0x35189a113511a880,0x35266b46351f85bf,0x356194fc35579b11,0x35754d41356b7b55
.quad 0x35935229358d12bd,0x359f8be835997ade,0x35b34a6d35ac1d48,0x35c1216f35ba4c5f,0x35d0250d35c86f98,0x35deb4c135d7924c,0x35e961ad35e1971d,0x35f7a8b835f0be0a
.quad 0x35fe900635f72e15,0x3605bc5f3602aa7c,0x3607a8ef36046e96,0x360cddc6360a7965,0x360dae53360b2e6d,0x361112ae360fa5b5,0x36113d66360fbb41,0x361244bd36121638
.quad 0x36124653361202ab,0x36106d983611bf0e,0x3610c47f3611fb72,0x360b9706360ea1dd,0x360cbe9f360fa5b5,0x3603dabe3608cdd2,0x36064699360b0ae4,0x35f2c3b236005f52
.quad 0x35faf26736043da0,0x35d8c7f835eafede,0x35e4fb3035f6b2da,0x35ba4c5f35d0c649,0x35cb094635e10486,0x3597f2e035b294a0,0x35ad901535c7c7f6,0x3564e3fb3590fcfd
.quad 0x358d12bd35ab6341,0x351522013559460b,0x35544390358c4943,0x34848f33350c6fa1,0x350ab1533555ef93,0xb38f97d83473b441,0x347ad83f350feb39,0xb4cb9c60b39df27f
.quad 0xb365c312348f4166,0xb5378c73b4c81302,0xb4b65d1fb1e5c8e2,0xb582bdb6b5326d5a,0xb5266b46b4966127,0xb5a6fe80b57d6bf8,0xb56ec39eb513656e,0xb5c7c7f6b5a1cc01
.quad 0xb5997adeb559460b,0xb5e46be1b5c1cdce,0xb5b8e91fb58ddbe0,0xb5fc5213b5de1f77,0xb5d520bcb5acd6e4,0xb6077dc8b5f63706,0xb5eda42db5c916be,0xb60e0296b604cf8f
.quad 0x0,0x0,0x34b65d1f34af446d,0x34c4892934bd740e,0x353422d2352d4a63,0x3541be97353af44f,0x35845835357f09e5,0x358ddbe035891ffd
.quad 0x35ab634135a58458,0x35b6d0e835b127bd,0x35ce3e5b35c7c7f6,0x35da948e35d4830e,0x35ec0f8035e589f2,0x35f822c335f24328,0x36020e1935fe1e75,0x3607524d3604cf8f
.quad 0x360ae70436087bc8,0x360ebb35360cfc96,0x36105b2b360ed436,0x3612163836117174,0x361248703611f3e0,0x36114af03612100e,0x3610a2c83611c8bc,0x360c5f21360ed436
.quad 0x360b747e360e53c4,0x360376973607d3c2,0x3602ddfc3607a8ef,0x35eda42d35fa7bf8,0x35ee29ed35fbdd75,0x35cd9b2035deb4c1,0x35d0c64935e2baa9,0x35a7bafa35bd0d7a
.quad 0x35ae48db35c47a9d,0x357a2e493596696a,0x3587895d35a1cc01,0x351dcb6435579b11,0x353af44f3576ee32,0x3473b44134f96664,0x34c489293524b27c,0xb416b13133f40934
.quad 0x32e5c780349d7f75,0xb50733b6b480fdd1,0xb4a82a0cb30f9c2b,0xb564e3fbb51dcb64,0xb52d4a63b4c0fed7,0xb59e09ebb576ee32,0xb58121f4b535d7db,0xb5c524a3b5a4c6aa
.quad 0xb5a8770cb5838b1e,0xb5e6a5ccb5c9bd68,0xb5cbae79b5a932b6,0xb600cce1b5e961ad,0xb5e9ebf9b5cb0946,0xb60a9e45b6016ee5,0xb6013933b5e84b67,0xb6107fabb60ac2cf
.quad 0xb60a542fb6002813,0xb6124653b6106d98,0xb6100dfdb6094668,0xb60fe551b61248f7,0xb61242ccb60f4c0c,0xb6096df1b6104865,0xb610e4d1b6121638,0xb5fe1e75b60a7965
.quad 0x0,0x0,0x34d2ada034cb9c60,0x34e0c9f834d9bcd9,0x354f3c7b35488167,0x355c9a6b3555ef93,0x35972e5335928b75,0x35a04c53359bc415
.quad 0x35c1cdce35bc5de1,0x35cc532f35c71fd9,0x35e6182635e07164,0x35f0be0a35eb8777,0x36016ee535fdac47,0x360618d83603dabe,0x360b970636099525,0x360ed436360d56fd
.quad 0x36112f82361021ce,0x36123ddd3611e3ac,0x3612098a361248f7,0x3610354636115820,0x360e1dfd360ff9d3,0x3608cdd2360bb938,0x36058da736094668,0x35f89c3436013933
.quad 0x35f1405335fcc616,0x35d65a8d35e46be1,0x35cf835235df4981,0x35ac1d4835be6b4d,0x35a6fe8035bafd53,0x3576ee323591c466,0x3572099a3590fcfd,0x350c6fa135400cb6
.quad 0x350e2d99354520f2,0x33e5b15b34abb772,0x3416b13134c48929,0xb4a82a0cb3baa69f,0xb4882044b265c89b,0xb541be97b503b4cc,0xb52b933ab4d2ada0,0xb5941883b56b7b55
.quad 0xb586bd8fb54bdfec,0xb5c1cdceb5a58458,0xb5b34a6db5941883,0xb5e84b67b5cf8352,0xb5d9fb8db5bdbc9e,0xb603112bb5f24328,0xb5f98d49b5e1971d,0xb60d1b10b6064699
.quad 0xb6087bc8b5fe9006,0xb611e3acb60ebb35,0xb60fbb41b609e28f,0xb6113d66b61233d2,0xb6124870b6104865,0xb60b2e6db6109166,0xb6100dfdb612478f,0xb5ffe10ab609e28f
.quad 0xb6091e8bb60fd075,0xb5dfddb7b5fcc616,0xb5fb683cb608f659,0xb5b78416b5dcf34a,0xb5dc5c66b5fbdd75,0xb58854d7b5b56939,0xb5b61d48b5de1f77,0xb52823aab587895d
.quad 0x3f803f803f803f80,0x3f803f803f803f80,0x3f463f623f753f7f,0xbf22bef1be95bdc9,0x3e483f0e3f553f7b,0xbe48bf0ebf55bf7b,0xbef13dc93f223f75,0x3f623f7f3f463e95
.quad 0xbf6dbec43ec43f6d,0xbf6dbec43ec43f6d,0xbf75bf463dc93f62,0x3e95bf22bf7fbef1,0xbf0ebf7bbe483f55,0x3f0e3f7b3e48bf55,0x3dc9bf75bef13f46,0xbf7fbe953f623f22
.quad 0x3f35bf35bf353f35,0x3f35bf35bf353f35,0x3f7fbe95bf623f22,0x3dc93f75bef1bf46,0x3f553e48bf7b3f0e,0xbf55be483f7bbf0e,0x3e953f22bf7f3ef1,0x3f75bf46bdc93f62
.quad 0xbec43f6dbf6d3ec4,0xbec43f6dbf6d3ec4,0xbf623f7fbf463e95,0xbef1bdc93f22bf75,0xbf7b3f55bf0e3e48,0x3f7bbf553f0ebe48,0xbf223ef1be953dc9,0xbf463f62bf753f7f
.quad 0xa5f725b0a554248d,0xa765a60da754a654,0x3f22bef13e95bdc9,0x3f46bf623f75bf7f,0x3f7bbf553f0ebe48,0xbf7b3f55bf0e3e48,0x3f62bf7f3f46be95,0x3ef13dc9bf223f75
.quad 0x3ec4bf6d3f6dbec4,0x3ec4bf6d3f6dbec4,0xbe95bf223f7fbef1,0xbf753f463dc9bf62,0xbf55be483f7bbf0e,0x3f553e48bf7b3f0e,0xbf7f3e953f62bf22,0xbdc9bf753ef13f46
.quad 0xbf353f353f35bf35,0xbf353f353f35bf35,0xbdc93f753ef1bf46,0x3f7f3e95bf62bf22,0x3f0e3f7b3e48bf55,0xbf0ebf7bbe483f55,0x3f753f46bdc9bf62,0xbe953f223f7f3ef1
.quad 0x3f6d3ec4bec4bf6d,0x3f6d3ec4bec4bf6d,0x3ef1bdc9bf22bf75,0xbf62bf7fbf46be95,0xbe48bf0ebf55bf7b,0x3e483f0e3f553f7b,0xbf46bf62bf75bf7f,0x3f223ef13e953dc9
.quad 0x3f803f803f803f80,0x3f803f803f803f80,0x3dc93e953ef13f22,0xbf7fbf75bf62bf46,0xbf7bbf55bf0ebe48,0x3f7b3f553f0e3e48,0xbe95bf46bf7fbf62,0xbf75bf22bdc93ef1
.quad 0x3f6d3ec4bec4bf6d,0x3f6d3ec4bec4bf6d,0x3ef13f7f3f22be95,0xbf62bdc93f463f75,0xbf553e483f7b3f0e,0x3f55be48bf7bbf0e,0xbf22bf623e953f7f,0xbf463ef13f75bdc9
.quad 0x3f35bf35bf353f35,0x3f35bf35bf353f35,0x3f463ef1bf75bdc9,0xbf223f623e95bf7f,0xbf0e3f7bbe48bf55,0x3f0ebf7b3e483f55,0xbf623dc93f46bf75,0xbef13f7fbf22be95
.quad 0x3ec4bf6d3f6dbec4,0x3ec4bf6d3f6dbec4,0x3f75bf223dc93ef1,0xbe953f46bf7f3f62,0xbe483f0ebf553f7b,0x3e48bf0e3f55bf7b,0xbf7f3f75bf623f46,0xbdc93e95bef13f22
.quad 0xa742a68da731261f,0xa784a137a777a58e,0x3f7fbf753f62bf46,0x3dc9be953ef1bf22,0x3e48bf0e3f55bf7b,0xbe483f0ebf553f7b,0xbf753f22bdc9bef1,0x3e95bf463f7fbf62
.quad 0xbec43f6dbf6d3ec4,0xbec43f6dbf6d3ec4,0x3f62bdc9bf463f75,0x3ef1bf7f3f223e95,0x3f0ebf7b3e483f55,0xbf0e3f7bbe48bf55,0xbf46bef13f753dc9,0x3f22bf62be953f7f
.quad 0xbf353f353f35bf35,0xbf353f353f35bf35,0x3f223f62be95bf7f,0x3f46bef1bf753dc9,0x3f55be48bf7bbf0e,0xbf553e483f7b3f0e,0xbef1bf7fbf223e95,0x3f623dc9bf46bf75
.quad 0xbf6dbec43ec43f6d,0xbf6dbec43ec43f6d,0x3e953f463f7f3f62,0x3f753f223dc9bef1,0x3f7b3f553f0e3e48,0xbf7bbf55bf0ebe48,0xbdc9be95bef1bf22,0x3f7f3f753f623f46
.quad 0x3f803f803f803f80,0x3f803f803f803f80,0xbf46bf62bf75bf7f,0x3f223ef13e953dc9,0x3e483f0e3f553f7b,0xbe48bf0ebf55bf7b,0x3ef1bdc9bf22bf75,0xbf62bf7fbf46be95
.quad 0xbf6dbec43ec43f6d,0xbf6dbec43ec43f6d,0x3f753f46bdc9bf62,0xbe953f223f7f3ef1,0xbf0ebf7bbe483f55,0x3f0e3f7b3e48bf55,0xbdc93f753ef1bf46,0x3f7f3e95bf62bf22
.quad 0x3f35bf35bf353f35,0x3f35bf35bf353f35,0xbf7f3e953f62bf22,0xbdc9bf753ef13f46,0x3f553e48bf7b3f0e,0xbf55be483f7bbf0e,0xbe95bf223f7fbef1,0xbf753f463dc9bf62
.quad 0xbec43f6dbf6d3ec4,0xbec43f6dbf6d3ec4,0x3f62bf7f3f46be95,0x3ef13dc9bf223f75,0xbf7b3f55bf0e3e48,0x3f7bbf553f0ebe48,0x3f22bef13e95bdc9,0x3f46bf623f75bf7f
.quad 0xa796260da78d258d,0x270d26d4a7b12816,0xbf223ef1be953dc9,0xbf463f62bf753f7f,0x3f7bbf553f0ebe48,0xbf7b3f55bf0e3e48,0xbf623f7fbf463e95,0xbef1bdc93f22bf75
.quad 0x3ec4bf6d3f6dbec4,0x3ec4bf6d3f6dbec4,0x3e953f22bf7f3ef1,0x3f75bf46bdc93f62,0xbf55be483f7bbf0e,0x3f553e48bf7b3f0e,0x3f7fbe95bf623f22,0x3dc93f75bef1bf46
.quad 0xbf353f353f35bf35,0xbf353f353f35bf35,0x3dc9bf75bef13f46,0xbf7fbe953f623f22,0x3f0e3f7b3e48bf55,0xbf0ebf7bbe483f55,0xbf75bf463dc93f62,0x3e95bf22bf7fbef1
.quad 0x3f6d3ec4bec4bf6d,0x3f6d3ec4bec4bf6d,0xbef13dc93f223f75,0x3f623f7f3f463e95,0xbe48bf0ebf55bf7b,0x3e483f0e3f553f7b,0x3f463f623f753f7f,0xbf22bef1be95bdc9
.quad 0x3f803f803f803f80,0x3f803f803f803f80,0xbdc9be95bef1bf22,0x3f7f3f753f623f46,0xbf7bbf55bf0ebe48,0x3f7b3f553f0e3e48,0x3e953f463f7f3f62,0x3f753f223dc9bef1
.quad 0x3f6d3ec4bec4bf6d,0x3f6d3ec4bec4bf6d,0xbef1bf7fbf223e95,0x3f623dc9bf46bf75,0xbf553e483f7b3f0e,0x3f55be48bf7bbf0e,0x3f223f62be95bf7f,0x3f46bef1bf753dc9
.quad 0x3f35bf35bf353f35,0x3f35bf35bf353f35,0xbf46bef13f753dc9,0x3f22bf62be953f7f,0xbf0e3f7bbe48bf55,0x3f0ebf7b3e483f55,0x3f62bdc9bf463f75,0x3ef1bf7f3f223e95
.quad 0x3ec4bf6d3f6dbec4,0x3ec4bf6d3f6dbec4,0xbf753f22bdc9bef1,0x3e95bf463f7fbf62,0xbe483f0ebf553f7b,0x3e48bf0e3f55bf7b,0x3f7fbf753f62bf46,0x3dc9be953ef1bf22
.quad 0x2731268da79f280d,0x26d4270da7c2281f,0xbf7f3f75bf623f46,0xbdc93e95bef13f22,0x3e48bf0e3f55bf7b,0xbe483f0ebf553f7b,0x3f75bf223dc93ef1,0xbe953f46bf7f3f62
.quad 0xbec43f6dbf6d3ec4,0xbec43f6dbf6d3ec4,0xbf623dc93f46bf75,0xbef13f7fbf22be95,0x3f0ebf7b3e483f55,0xbf0e3f7bbe48bf55,0x3f463ef1bf75bdc9,0xbf223f623e95bf7f
.quad 0xbf353f353f35bf35,0xbf353f353f35bf35,0xbf22bf623e953f7f,0xbf463ef13f75bdc9,0x3f55be48bf7bbf0e,0xbf553e483f7b3f0e,0x3ef13f7f3f22be95,0xbf62bdc93f463f75
.quad 0xbf6dbec43ec43f6d,0xbf6dbec43ec43f6d,0xbe95bf46bf7fbf62,0xbf75bf22bdc93ef1,0x3f7b3f553f0e3e48,0xbf7bbf55bf0ebe48,0x3dc93e953ef13f22,0xbf7fbf75bf62bf46
.quad 0x0,0x0,0x3f223ef13e953dc9,0x3f463f623f753f7f,0x3f7b3f553f0e3e48,0xbf7bbf55bf0ebe48,0x3f623f7f3f463e95,0x3ef1bdc9bf22bf75
.quad 0x3ec43f6d3f6d3ec4,0x3ec43f6d3f6d3ec4,0xbe953f223f7f3ef1,0xbf75bf463dc93f62,0xbf553e483f7b3f0e,0x3f55be48bf7bbf0e,0xbf7fbe953f623f22,0xbdc93f753ef1bf46
.quad 0xbf35bf353f353f35,0xbf35bf353f353f35,0xbdc9bf753ef13f46,0x3f7fbe95bf623f22,0x3f0ebf7b3e483f55,0xbf0e3f7bbe48bf55,0x3f75bf46bdc93f62,0xbe95bf223f7fbef1
.quad 0x3f6dbec4bec43f6d,0x3f6dbec4bec43f6d,0x3ef13dc9bf223f75,0xbf623f7fbf463e95,0xbe483f0ebf553f7b,0x3e48bf0e3f55bf7b,0xbf463f62bf753f7f,0x3f22bef13e95bdc9
.quad 0xbf803f80bf803f80,0xbf803f80bf803f80,0xbf463f62bf753f7f,0x3f22bef13e95bdc9,0xbe483f0ebf553f7b,0x3e48bf0e3f55bf7b,0x3ef13dc9bf223f75,0xbf623f7fbf463e95
.quad 0x3f6dbec4bec43f6d,0x3f6dbec4bec43f6d,0x3f75bf46bdc93f62,0xbe95bf223f7fbef1,0x3f0ebf7b3e483f55,0xbf0e3f7bbe48bf55,0xbdc9bf753ef13f46,0x3f7fbe95bf623f22
.quad 0xbf35bf353f353f35,0xbf35bf353f353f35,0xbf7fbe953f623f22,0xbdc93f753ef1bf46,0xbf553e483f7b3f0e,0x3f55be48bf7bbf0e,0xbe953f223f7f3ef1,0xbf75bf463dc93f62
.quad 0x3ec43f6d3f6d3ec4,0x3ec43f6d3f6d3ec4,0x3f623f7f3f463e95,0x3ef1bdc9bf22bf75,0x3f7b3f553f0e3e48,0xbf7bbf55bf0ebe48,0x3f223ef13e953dc9,0x3f463f623f753f7f
.quad 0x0,0x0,0x3f7f3f753f623f46,0x3dc93e953ef13f22,0x3e483f0e3f553f7b,0xbe48bf0ebf55bf7b,0xbf75bf22bdc93ef1,0x3e953f463f7f3f62
.quad 0xbec4bf6dbf6dbec4,0xbec4bf6dbf6dbec4,0x3f623dc9bf46bf75,0x3ef13f7f3f22be95,0x3f0e3f7b3e48bf55,0xbf0ebf7bbe483f55,0xbf463ef13f75bdc9,0x3f223f62be95bf7f
.quad 0xbf35bf353f353f35,0xbf35bf353f353f35,0x3f22bf62be953f7f,0x3f463ef1bf75bdc9,0x3f553e48bf7b3f0e,0xbf55be483f7bbf0e,0xbef13f7fbf22be95,0x3f62bdc9bf463f75
.quad 0xbf6d3ec43ec4bf6d,0xbf6d3ec43ec4bf6d,0x3e95bf463f7fbf62,0x3f75bf223dc93ef1,0x3f7bbf553f0ebe48,0xbf7b3f55bf0e3e48,0xbdc93e95bef13f22,0x3f7fbf753f62bf46
.quad 0xbf803f80bf803f80,0xbf803f80bf803f80,0xbdc93e95bef13f22,0x3f7fbf753f62bf46,0x3f7bbf553f0ebe48,0xbf7b3f55bf0e3e48,0x3e95bf463f7fbf62,0x3f75bf223dc93ef1
.quad 0xbf6d3ec43ec4bf6d,0xbf6d3ec43ec4bf6d,0xbef13f7fbf22be95,0x3f62bdc9bf463f75,0x3f553e48bf7b3f0e,0xbf55be483f7bbf0e,0x3f22bf62be953f7f,0x3f463ef1bf75bdc9
.quad 0xbf35bf353f353f35,0xbf35bf353f353f35,0xbf463ef13f75bdc9,0x3f223f62be95bf7f,0x3f0e3f7b3e48bf55,0xbf0ebf7bbe483f55,0x3f623dc9bf46bf75,0x3ef13f7f3f22be95
.quad 0xbec4bf6dbf6dbec4,0xbec4bf6dbf6dbec4,0xbf75bf22bdc93ef1,0x3e953f463f7f3f62,0x3e483f0e3f553f7b,0xbe48bf0ebf55bf7b,0x3f7f3f753f623f46,0x3dc93e953ef13f22
.quad 0x0,0x0,0xbf22bef1be95bdc9,0xbf46bf62bf75bf7f,0x3f7b3f553f0e3e48,0xbf7bbf55bf0ebe48,0xbf62bf7fbf46be95,0xbef13dc93f223f75
.quad 0x3ec43f6d3f6d3ec4,0x3ec43f6d3f6d3ec4,0x3e95bf22bf7fbef1,0x3f753f46bdc9bf62,0xbf553e483f7b3f0e,0x3f55be48bf7bbf0e,0x3f7f3e95bf62bf22,0x3dc9bf75bef13f46
.quad 0xbf35bf353f353f35,0xbf35bf353f353f35,0x3dc93f75bef1bf46,0xbf7f3e953f62bf22,0x3f0ebf7b3e483f55,0xbf0e3f7bbe48bf55,0xbf753f463dc9bf62,0x3e953f22bf7f3ef1
.quad 0x3f6dbec4bec43f6d,0x3f6dbec4bec43f6d,0xbef1bdc93f22bf75,0x3f62bf7f3f46be95,0xbe483f0ebf553f7b,0x3e48bf0e3f55bf7b,0x3f46bf623f75bf7f,0xbf223ef1be953dc9
.quad 0xbf803f80bf803f80,0xbf803f80bf803f80,0x3f46bf623f75bf7f,0xbf223ef1be953dc9,0xbe483f0ebf553f7b,0x3e48bf0e3f55bf7b,0xbef1bdc93f22bf75,0x3f62bf7f3f46be95
.quad 0x3f6dbec4bec43f6d,0x3f6dbec4bec43f6d,0xbf753f463dc9bf62,0x3e953f22bf7f3ef1,0x3f0ebf7b3e483f55,0xbf0e3f7bbe48bf55,0x3dc93f75bef1bf46,0xbf7f3e953f62bf22
.quad 0xbf35bf353f353f35,0xbf35bf353f353f35,0x3f7f3e95bf62bf22,0x3dc9bf75bef13f46,0xbf553e483f7b3f0e,0x3f55be48bf7bbf0e,0x3e95bf22bf7fbef1,0x3f753f46bdc9bf62
.quad 0x3ec43f6d3f6d3ec4,0x3ec43f6d3f6d3ec4,0xbf62bf7fbf46be95,0xbef13dc93f223f75,0x3f7b3f553f0e3e48,0xbf7bbf55bf0ebe48,0xbf22bef1be95bdc9,0xbf46bf62bf75bf7f
.quad 0x0,0x0,0xbf7fbf75bf62bf46,0xbdc9be95bef1bf22,0x3e483f0e3f553f7b,0xbe48bf0ebf55bf7b,0x3f753f223dc9bef1,0xbe95bf46bf7fbf62
.quad 0xbec4bf6dbf6dbec4,0xbec4bf6dbf6dbec4,0xbf62bdc93f463f75,0xbef1bf7fbf223e95,0x3f0e3f7b3e48bf55,0xbf0ebf7bbe483f55,0x3f46bef1bf753dc9,0xbf22bf623e953f7f
.quad 0xbf35bf353f353f35,0xbf35bf353f353f35,0xbf223f623e95bf7f,0xbf46bef13f753dc9,0x3f553e48bf7b3f0e,0xbf55be483f7bbf0e,0x3ef1bf7f3f223e95,0xbf623dc93f46bf75
.quad 0xbf6d3ec43ec4bf6d,0xbf6d3ec43ec4bf6d,0xbe953f46bf7f3f62,0xbf753f22bdc9bef1,0x3f7bbf553f0ebe48,0xbf7b3f55bf0e3e48,0x3dc9be953ef1bf22,0xbf7f3f75bf623f46
.quad 0xbf803f80bf803f80,0xbf803f80bf803f80,0x3dc9be953ef1bf22,0xbf7f3f75bf623f46,0x3f7bbf553f0ebe48,0xbf7b3f55bf0e3e48,0xbe953f46bf7f3f62,0xbf753f22bdc9bef1
.quad 0xbf6d3ec43ec4bf6d,0xbf6d3ec43ec4bf6d,0x3ef1bf7f3f223e95,0xbf623dc93f46bf75,0x3f553e48bf7b3f0e,0xbf55be483f7bbf0e,0xbf223f623e95bf7f,0xbf46bef13f753dc9
.quad 0xbf35bf353f353f35,0xbf35bf353f353f35,0x3f46bef1bf753dc9,0xbf22bf623e953f7f,0x3f0e3f7b3e48bf55,0xbf0ebf7bbe483f55,0xbf62bdc93f463f75,0xbef1bf7fbf223e95
.quad 0xbec4bf6dbf6dbec4,0xbec4bf6dbf6dbec4,0x3f753f223dc9bef1,0xbe95bf46bf7fbf62,0x3e483f0e3f553f7b,0xbe48bf0ebf55bf7b,0xbf7fbf75bf62bf46,0xbdc9be95bef1bf22
.quad 0x8000800080008000,0x8000800080008000,0xbf22bef1be95bdc9,0xbf46bf62bf75bf7f,0xbf7bbf55bf0ebe48,0x3f7b3f553f0e3e48,0xbf62bf7fbf46be95,0xbef13dc93f223f75
.quad 0xbec4bf6dbf6dbec4,0xbec4bf6dbf6dbec4,0x3e95bf22bf7fbef1,0x3f753f46bdc9bf62,0x3f55be48bf7bbf0e,0xbf553e483f7b3f0e,0x3f7f3e95bf62bf22,0x3dc9bf75bef13f46
.quad 0x3f353f35bf35bf35,0x3f353f35bf35bf35,0x3dc93f75bef1bf46,0xbf7f3e953f62bf22,0xbf0e3f7bbe48bf55,0x3f0ebf7b3e483f55,0xbf753f463dc9bf62,0x3e953f22bf7f3ef1
.quad 0xbf6d3ec43ec4bf6d,0xbf6d3ec43ec4bf6d,0xbef1bdc93f22bf75,0x3f62bf7f3f46be95,0x3e48bf0e3f55bf7b,0xbe483f0ebf553f7b,0x3f46bf623f75bf7f,0xbf223ef1be953dc9
.quad 0x3f80bf803f80bf80,0x3f80bf803f80bf80,0x3f46bf623f75bf7f,0xbf223ef1be953dc9,0x3e48bf0e3f55bf7b,0xbe483f0ebf553f7b,0xbef1bdc93f22bf75,0x3f62bf7f3f46be95
.quad 0xbf6d3ec43ec4bf6d,0xbf6d3ec43ec4bf6d,0xbf753f463dc9bf62,0x3e953f22bf7f3ef1,0xbf0e3f7bbe48bf55,0x3f0ebf7b3e483f55,0x3dc93f75bef1bf46,0xbf7f3e953f62bf22
.quad 0x3f353f35bf35bf35,0x3f353f35bf35bf35,0x3f7f3e95bf62bf22,0x3dc9bf75bef13f46,0x3f55be48bf7bbf0e,0xbf553e483f7b3f0e,0x3e95bf22bf7fbef1,0x3f753f46bdc9bf62
.quad 0xbec4bf6dbf6dbec4,0xbec4bf6dbf6dbec4,0xbf62bf7fbf46be95,0xbef13dc93f223f75,0xbf7bbf55bf0ebe48,0x3f7b3f553f0e3e48,0xbf22bef1be95bdc9,0xbf46bf62bf75bf7f
.quad 0x8000800080008000,0x8000800080008000,0xbf7fbf75bf62bf46,0xbdc9be95bef1bf22,0xbe48bf0ebf55bf7b,0x3e483f0e3f553f7b,0x3f753f223dc9bef1,0xbe95bf46bf7fbf62
.quad 0x3ec43f6d3f6d3ec4,0x3ec43f6d3f6d3ec4,0xbf62bdc93f463f75,0xbef1bf7fbf223e95,0xbf0ebf7bbe483f55,0x3f0e3f7b3e48bf55,0x3f46bef1bf753dc9,0xbf22bf623e953f7f
.quad 0x3f353f35bf35bf35,0x3f353f35bf35bf35,0xbf223f623e95bf7f,0xbf46bef13f753dc9,0xbf55be483f7bbf0e,0x3f553e48bf7b3f0e,0x3ef1bf7f3f223e95,0xbf623dc93f46bf75
.quad 0x3f6dbec4bec43f6d,0x3f6dbec4bec43f6d,0xbe953f46bf7f3f62,0xbf753f22bdc9bef1,0xbf7b3f55bf0e3e48,0x3f7bbf553f0ebe48,0x3dc9be953ef1bf22,0xbf7f3f75bf623f46
.quad 0x3f80bf803f80bf80,0x3f80bf803f80bf80,0x3dc9be953ef1bf22,0xbf7f3f75bf623f46,0xbf7b3f55bf0e3e48,0x3f7bbf553f0ebe48,0xbe953f46bf7f3f62,0xbf753f22bdc9bef1
.quad 0x3f6dbec4bec43f6d,0x3f6dbec4bec43f6d,0x3ef1bf7f3f223e95,0xbf623dc93f46bf75,0xbf55be483f7bbf0e,0x3f553e48bf7b3f0e,0xbf223f623e95bf7f,0xbf46bef13f753dc9
.quad 0x3f353f35bf35bf35,0x3f353f35bf35bf35,0x3f46bef1bf753dc9,0xbf22bf623e953f7f,0xbf0ebf7bbe483f55,0x3f0e3f7b3e48bf55,0xbf62bdc93f463f75,0xbef1bf7fbf223e95
.quad 0x3ec43f6d3f6d3ec4,0x3ec43f6d3f6d3ec4,0x3f753f223dc9bef1,0xbe95bf46bf7fbf62,0xbe48bf0ebf55bf7b,0x3e483f0e3f553f7b,0xbf7fbf75bf62bf46,0xbdc9be95bef1bf22
.quad 0x8000800080008000,0x8000800080008000,0x3f223ef13e953dc9,0x3f463f623f753f7f,0xbf7bbf55bf0ebe48,0x3f7b3f553f0e3e48,0x3f623f7f3f463e95,0x3ef1bdc9bf22bf75
.quad 0xbec4bf6dbf6dbec4,0xbec4bf6dbf6dbec4,0xbe953f223f7f3ef1,0xbf75bf463dc93f62,0x3f55be48bf7bbf0e,0xbf553e483f7b3f0e,0xbf7fbe953f623f22,0xbdc93f753ef1bf46
.quad 0x3f353f35bf35bf35,0x3f353f35bf35bf35,0xbdc9bf753ef13f46,0x3f7fbe95bf623f22,0xbf0e3f7bbe48bf55,0x3f0ebf7b3e483f55,0x3f75bf46bdc93f62,0xbe95bf223f7fbef1
.quad 0xbf6d3ec43ec4bf6d,0xbf6d3ec43ec4bf6d,0x3ef13dc9bf223f75,0xbf623f7fbf463e95,0x3e48bf0e3f55bf7b,0xbe483f0ebf553f7b,0xbf463f62bf753f7f,0x3f22bef13e95bdc9
.quad 0x3f80bf803f80bf80,0x3f80bf803f80bf80,0xbf463f62bf753f7f,0x3f22bef13e95bdc9,0x3e48bf0e3f55bf7b,0xbe483f0ebf553f7b,0x3ef13dc9bf223f75,0xbf623f7fbf463e95
.quad 0xbf6d3ec43ec4bf6d,0xbf6d3ec43ec4bf6d,0x3f75bf46bdc93f62,0xbe95bf223f7fbef1,0xbf0e3f7bbe48bf55,0x3f0ebf7b3e483f55,0xbdc9bf753ef13f46,0x3f7fbe95bf623f22
.quad 0x3f353f35bf35bf35,0x3f353f35bf35bf35,0xbf7fbe953f623f22,0xbdc93f753ef1bf46,0x3f55be48bf7bbf0e,0xbf553e483f7b3f0e,0xbe953f223f7f3ef1,0xbf75bf463dc93f62
.quad 0xbec4bf6dbf6dbec4,0xbec4bf6dbf6dbec4,0x3f623f7f3f463e95,0x3ef1bdc9bf22bf75,0xbf7bbf55bf0ebe48,0x3f7b3f553f0e3e48,0x3f223ef13e953dc9,0x3f463f623f753f7f
.quad 0x8000800080008000,0x8000800080008000,0x3f7f3f753f623f46,0x3dc93e953ef13f22,0xbe48bf0ebf55bf7b,0x3e483f0e3f553f7b,0xbf75bf22bdc93ef1,0x3e953f463f7f3f62
.quad 0x3ec43f6d3f6d3ec4,0x3ec43f6d3f6d3ec4,0x3f623dc9bf46bf75,0x3ef13f7f3f22be95,0xbf0ebf7bbe483f55,0x3f0e3f7b3e48bf55,0xbf463ef13f75bdc9,0x3f223f62be95bf7f
.quad 0x3f353f35bf35bf35,0x3f353f35bf35bf35,0x3f22bf62be953f7f,0x3f463ef1bf75bdc9,0xbf55be483f7bbf0e,0x3f553e48bf7b3f0e,0xbef13f7fbf22be95,0x3f62bdc9bf463f75
.quad 0x3f6dbec4bec43f6d,0x3f6dbec4bec43f6d,0x3e95bf463f7fbf62,0x3f75bf223dc93ef1,0xbf7b3f55bf0e3e48,0x3f7bbf553f0ebe48,0xbdc93e95bef13f22,0x3f7fbf753f62bf46
.quad 0x3f80bf803f80bf80,0x3f80bf803f80bf80,0xbdc93e95bef13f22,0x3f7fbf753f62bf46,0xbf7b3f55bf0e3e48,0x3f7bbf553f0ebe48,0x3e95bf463f7fbf62,0x3f75bf223dc93ef1
.quad 0x3f6dbec4bec43f6d,0x3f6dbec4bec43f6d,0xbef13f7fbf22be95,0x3f62bdc9bf463f75,0xbf55be483f7bbf0e,0x3f553e48bf7b3f0e,0x3f22bf62be953f7f,0x3f463ef1bf75bdc9
.quad 0x3f353f35bf35bf35,0x3f353f35bf35bf35,0xbf463ef13f75bdc9,0x3f223f62be95bf7f,0xbf0ebf7bbe483f55,0x3f0e3f7b3e48bf55,0x3f623dc9bf46bf75,0x3ef13f7f3f22be95
.quad 0x3ec43f6d3f6d3ec4,0x3ec43f6d3f6d3ec4,0xbf75bf22bdc93ef1,0x3e953f463f7f3f62,0xbe48bf0ebf55bf7b,0x3e483f0e3f553f7b,0x3f7f3f753f623f46,0x3dc93e953ef13f22
.set FC0, 0x3f80
.set FC1, 0x3f80
.set FC2, 0x3f80
.set FC3, 0x3f80
.set FC4, 0x3f80
.set FC5, 0x3f7f
.set FC6, 0x3f7f
.set FC7, 0x3f7f
.set FC8, 0x3f7e
.set FC9, 0x3f7e
.set FC10, 0x3f7d
.set FC11, 0x3f7d
.set FC12, 0x3f7c
.set FC13, 0x3f7c
.set FC14, 0x3f7b
.set FC15, 0x3f7a
.set FC16, 0x3f7a
.set FC17, 0x3f79
.set FC18, 0x3f78
.set FC19, 0x3f77
.set FC20, 0x3f76
.set FC21, 0x3f75
.set FC22, 0x3f74
.set FC23, 0x3f73
.set FC24, 0x3f72
.set FC25, 0x3f70
.set FC26, 0x3f6f
.set FC27, 0x3f6e
.set FC28, 0x3f6d
.set FC29, 0x3f6b
.set FC30, 0x3f6a
.set FC31, 0x3f68
.set FC32, 0x3f67
.set FC33, 0x3f65
.set FC34, 0x3f63
.set FC35, 0x3f62
.set FC36, 0x3f60
.set FC37, 0x3f5e
.set FC38, 0x3f5c
.set FC39, 0x3f5b
.set FC40, 0x3f59
.set FC41, 0x3f57
.set FC42, 0x3f55
.set FC43, 0x3f53
.set FC44, 0x3f51
.set FC45, 0x3f4f
.set FC46, 0x3f4d
.set FC47, 0x3f4a
.set FC48, 0x3f48
.set FC49, 0x3f46
.set FC50, 0x3f44
.set FC51, 0x3f41
.set FC52, 0x3f3f
.set FC53, 0x3f3c
.set FC54, 0x3f3a
.set FC55, 0x3f38
.set FC56, 0x3f35
.set FC57, 0x3f32
.set FC58, 0x3f30
.set FC59, 0x3f2d
.set FC60, 0x3f2b
.set FC61, 0x3f28
.set FC62, 0x3f25
.set FC63, 0x3f22
.set FC64, 0x3f20
.set FC65, 0x3f1d
.set FC66, 0x3f1a
.set FC67, 0x3f17
.set FC68, 0x3f14
.set FC69, 0x3f11
.set FC70, 0x3f0e
.set FC71, 0x3f0b
.set FC72, 0x3f08
.set FC73, 0x3f05
.set FC74, 0x3f02
.set FC75, 0x3efe
.set FC76, 0x3ef8
.set FC77, 0x3ef1
.set FC78, 0x3eeb
.set FC79, 0x3ee5
.set FC80, 0x3ede
.set FC81, 0x3ed8
.set FC82, 0x3ed1
.set FC83, 0x3ecb
.set FC84, 0x3ec4
.set FC85, 0x3ebd
.set FC86, 0x3eb7
.set FC87, 0x3eb0
.set FC88, 0x3ea9
.set FC89, 0x3ea2
.set FC90, 0x3e9b
.set FC91, 0x3e95
.set FC92, 0x3e8e
.set FC93, 0x3e87
.set FC94, 0x3e80
.set FC95, 0x3e72
.set FC96, 0x3e64
.set FC97, 0x3e56
.set FC98, 0x3e48
.set FC99, 0x3e3a
.set FC100, 0x3e2c
.set FC101, 0x3e1d
.set FC102, 0x3e0f
.set FC103, 0x3e01
.set FC104, 0x3de5
.set FC105, 0x3dc9
.set FC106, 0x3dac
.set FC107, 0x3d8f
.set FC108, 0x3d66
.set FC109, 0x3d2c
.set FC110, 0x3ce6
.set FC111, 0x3c66
.set FC112, 0x248d
.set FC113, 0xbc66
.set FC114, 0xbce6
.set FC115, 0xbd2c
.set FC116, 0xbd66
.set FC117, 0xbd8f
.set FC118, 0xbdac
.set FC119, 0xbdc9
.set FC120, 0xbde5
.set FC121, 0xbe01
.set FC122, 0xbe0f
.set FC123, 0xbe1d
.set FC124, 0xbe2c
.set FC125, 0xbe3a
.set FC126, 0xbe48
.set FC127, 0xbe56
.set FC128, 0xbe64
.set FC129, 0xbe72
.set FC130, 0xbe80
.set FC131, 0xbe87
.set FC132, 0xbe8e
.set FC133, 0xbe95
.set FC134, 0xbe9b
.set FC135, 0xbea2
.set FC136, 0xbea9
.set FC137, 0xbeb0
.set FC138, 0xbeb7
.set FC139, 0xbebd
.set FC140, 0xbec4
.set FC141, 0xbecb
.set FC142, 0xbed1
.set FC143, 0xbed8
.set FC144, 0xbede
.set FC145, 0xbee5
.set FC146, 0xbeeb
.set FC147, 0xbef1
.set FC148, 0xbef8
.set FC149, 0xbefe
.set FC150, 0xbf02
.set FC151, 0xbf05
.set FC152, 0xbf08
.set FC153, 0xbf0b
.set FC154, 0xbf0e
.set FC155, 0xbf11
.set FC156, 0xbf14
.set FC157, 0xbf17
.set FC158, 0xbf1a
.set FC159, 0xbf1d
.set FC160, 0xbf20
.set FC161, 0xbf22
.set FC162, 0xbf25
.set FC163, 0xbf28
.set FC164, 0xbf2b
.set FC165, 0xbf2d
.set FC166, 0xbf30
.set FC167, 0xbf32
.set FC168, 0xbf35
.set FC169, 0xbf38
.set FC170, 0xbf3a
.set FC171, 0xbf3c
.set FC172, 0xbf3f
.set FC173, 0xbf41
.set FC174, 0xbf44
.set FC175, 0xbf46
.set FC176, 0xbf48
.set FC177, 0xbf4a
.set FC178, 0xbf4d
.set FC179, 0xbf4f
.set FC180, 0xbf51
.set FC181, 0xbf53
.set FC182, 0xbf55
.set FC183, 0xbf57
.set FC184, 0xbf59
.set FC185, 0xbf5b
.set FC186, 0xbf5c
.set FC187, 0xbf5e
.set FC188, 0xbf60
.set FC189, 0xbf62
.set FC190, 0xbf63
.set FC191, 0xbf65
.set FC192, 0xbf67
.set FC193, 0xbf68
.set FC194, 0xbf6a
.set FC195, 0xbf6b
.set FC196, 0xbf6d
.set FC197, 0xbf6e
.set FC198, 0xbf6f
.set FC199, 0xbf70
.set FC200, 0xbf72
.set FC201, 0xbf73
.set FC202, 0xbf74
.set FC203, 0xbf75
.set FC204, 0xbf76
.set FC205, 0xbf77
.set FC206, 0xbf78
.set FC207, 0xbf79
.set FC208, 0xbf7a
.set FC209, 0xbf7a
.set FC210, 0xbf7b
.set FC211, 0xbf7c
.set FC212, 0xbf7c
.set FC213, 0xbf7d
.set FC214, 0xbf7d
.set FC215, 0xbf7e
.set FC216, 0xbf7e
.set FC217, 0xbf7f
.set FC218, 0xbf7f
.set FC219, 0xbf7f
.set FC220, 0xbf80
.set FC221, 0xbf80
.set FC222, 0xbf80
.set FC223, 0xbf80
.set FC224, 0xbf80
.set FC225, 0xbf80
.set FC226, 0xbf80
.set FC227, 0xbf80
.set FC228, 0xbf80
.set FC229, 0xbf7f
.set FC230, 0xbf7f
.set FC231, 0xbf7f
.set FC232, 0xbf7e
.set FC233, 0xbf7e
.set FC234, 0xbf7d
.set FC235, 0xbf7d
.set FC236, 0xbf7c
.set FC237, 0xbf7c
.set FC238, 0xbf7b
.set FC239, 0xbf7a
.set FC240, 0xbf7a
.set FC241, 0xbf79
.set FC242, 0xbf78
.set FC243, 0xbf77
.set FC244, 0xbf76
.set FC245, 0xbf75
.set FC246, 0xbf74
.set FC247, 0xbf73
.set FC248, 0xbf72
.set FC249, 0xbf70
.set FC250, 0xbf6f
.set FC251, 0xbf6e
.set FC252, 0xbf6d
.set FC253, 0xbf6b
.set FC254, 0xbf6a
.set FC255, 0xbf68
.set FC256, 0xbf67
.set FC257, 0xbf65
.set FC258, 0xbf63
.set FC259, 0xbf62
.set FC260, 0xbf60
.set FC261, 0xbf5e
.set FC262, 0xbf5c
.set FC263, 0xbf5b
.set FC264, 0xbf59
.set FC265, 0xbf57
.set FC266, 0xbf55
.set FC267, 0xbf53
.set FC268, 0xbf51
.set FC269, 0xbf4f
.set FC270, 0xbf4d
.set FC271, 0xbf4a
.set FC272, 0xbf48
.set FC273, 0xbf46
.set FC274, 0xbf44
.set FC275, 0xbf41
.set FC276, 0xbf3f
.set FC277, 0xbf3c
.set FC278, 0xbf3a
.set FC279, 0xbf38
.set FC280, 0xbf35
.set FC281, 0xbf32
.set FC282, 0xbf30
.set FC283, 0xbf2d
.set FC284, 0xbf2b
.set FC285, 0xbf28
.set FC286, 0xbf25
.set FC287, 0xbf22
.set FC288, 0xbf20
.set FC289, 0xbf1d
.set FC290, 0xbf1a
.set FC291, 0xbf17
.set FC292, 0xbf14
.set FC293, 0xbf11
.set FC294, 0xbf0e
.set FC295, 0xbf0b
.set FC296, 0xbf08
.set FC297, 0xbf05
.set FC298, 0xbf02
.set FC299, 0xbefe
.set FC300, 0xbef8
.set FC301, 0xbef1
.set FC302, 0xbeeb
.set FC303, 0xbee5
.set FC304, 0xbede
.set FC305, 0xbed8
.set FC306, 0xbed1
.set FC307, 0xbecb
.set FC308, 0xbec4
.set FC309, 0xbebd
.set FC310, 0xbeb7
.set FC311, 0xbeb0
.set FC312, 0xbea9
.set FC313, 0xbea2
.set FC314, 0xbe9b
.set FC315, 0xbe95
.set FC316, 0xbe8e
.set FC317, 0xbe87
.set FC318, 0xbe80
.set FC319, 0xbe72
.set FC320, 0xbe64
.set FC321, 0xbe56
.set FC322, 0xbe48
.set FC323, 0xbe3a
.set FC324, 0xbe2c
.set FC325, 0xbe1d
.set FC326, 0xbe0f
.set FC327, 0xbe01
.set FC328, 0xbde5
.set FC329, 0xbdc9
.set FC330, 0xbdac
.set FC331, 0xbd8f
.set FC332, 0xbd66
.set FC333, 0xbd2c
.set FC334, 0xbce6
.set FC335, 0xbc66
.set FC336, 0xa554
.set FC337, 0x3c66
.set FC338, 0x3ce6
.set FC339, 0x3d2c
.set FC340, 0x3d66
.set FC341, 0x3d8f
.set FC342, 0x3dac
.set FC343, 0x3dc9
.set FC344, 0x3de5
.set FC345, 0x3e01
.set FC346, 0x3e0f
.set FC347, 0x3e1d
.set FC348, 0x3e2c
.set FC349, 0x3e3a
.set FC350, 0x3e48
.set FC351, 0x3e56
.set FC352, 0x3e64
.set FC353, 0x3e72
.set FC354, 0x3e80
.set FC355, 0x3e87
.set FC356, 0x3e8e
.set FC357, 0x3e95
.set FC358, 0x3e9b
.set FC359, 0x3ea2
.set FC360, 0x3ea9
.set FC361, 0x3eb0
.set FC362, 0x3eb7
.set FC363, 0x3ebd
.set FC364, 0x3ec4
.set FC365, 0x3ecb
.set FC366, 0x3ed1
.set FC367, 0x3ed8
.set FC368, 0x3ede
.set FC369, 0x3ee5
.set FC370, 0x3eeb
.set FC371, 0x3ef1
.set FC372, 0x3ef8
.set FC373, 0x3efe
.set FC374, 0x3f02
.set FC375, 0x3f05
.set FC376, 0x3f08
.set FC377, 0x3f0b
.set FC378, 0x3f0e
.set FC379, 0x3f11
.set FC380, 0x3f14
.set FC381, 0x3f17
.set FC382, 0x3f1a
.set FC383, 0x3f1d
.set FC384, 0x3f20
.set FC385, 0x3f22
.set FC386, 0x3f25
.set FC387, 0x3f28
.set FC388, 0x3f2b
.set FC389, 0x3f2d
.set FC390, 0x3f30
.set FC391, 0x3f32
.set FC392, 0x3f35
.set FC393, 0x3f38
.set FC394, 0x3f3a
.set FC395, 0x3f3c
.set FC396, 0x3f3f
.set FC397, 0x3f41
.set FC398, 0x3f44
.set FC399, 0x3f46
.set FC400, 0x3f48
.set FC401, 0x3f4a
.set FC402, 0x3f4d
.set FC403, 0x3f4f
.set FC404, 0x3f51
.set FC405, 0x3f53
.set FC406, 0x3f55
.set FC407, 0x3f57
.set FC408, 0x3f59
.set FC409, 0x3f5b
.set FC410, 0x3f5c
.set FC411, 0x3f5e
.set FC412, 0x3f60
.set FC413, 0x3f62
.set FC414, 0x3f63
.set FC415, 0x3f65
.set FC416, 0x3f67
.set FC417, 0x3f68
.set FC418, 0x3f6a
.set FC419, 0x3f6b
.set FC420, 0x3f6d
.set FC421, 0x3f6e
.set FC422, 0x3f6f
.set FC423, 0x3f70
.set FC424, 0x3f72
.set FC425, 0x3f73
.set FC426, 0x3f74
.set FC427, 0x3f75
.set FC428, 0x3f76
.set FC429, 0x3f77
.set FC430, 0x3f78
.set FC431, 0x3f79
.set FC432, 0x3f7a
.set FC433, 0x3f7a
.set FC434, 0x3f7b
.set FC435, 0x3f7c
.set FC436, 0x3f7c
.set FC437, 0x3f7d
.set FC438, 0x3f7d
.set FC439, 0x3f7e
.set FC440, 0x3f7e
.set FC441, 0x3f7f
.set FC442, 0x3f7f
.set FC443, 0x3f7f
.set FC444, 0x3f80
.set FC445, 0x3f80
.set FC446, 0x3f80
.set FC447, 0x3f80
.altmacro
.macro fone a
.short FC\a
.endm
.p2align 8
ftab:
.set fd, 0
.rept 448
.set fi, 0
.rept 225
fone %fi
.set fi, (fi + fd) % 448
.endr
.set fi, (112 + fd) % 448
.rept 223
fone %fi
.set fi, (fi + fd) % 448
.endr
.set fd, fd+1
.endr
.p2align 8
ftab2:
.set fb, 0
.rept 28
.set fk, 0
.rept 56
.set fd, fb
.rept 16
.set ff, fk
.rept 8
.if ff < 225
fone %((fd * ff) % 448)
.else
fone %((fd * (ff - 224) + 112) % 448)
.endif
.set ff, ff+1
.endr
.set fd, fd+1
.endr
.set fk, fk+8
.endr
.set fb, fb+16
.endr
.noaltmacro
```
